```python
import torch

def _softmax(x, axis=-1):
    return torch.softmax(x, dim=axis)
def _gelu(x):
    return torch.nn.functional.gelu(x, approximate="tanh")
def _silu(x):
    return torch.nn.functional.silu(x)
def _sigmoid(x):
    return torch.sigmoid(x)
def _layernorm(x, axis=-1, eps=1e-5):
    m = x.mean(dim=axis, keepdim=True)
    v = x.var(dim=axis, keepdim=True, unbiased=False)
    return (x - m) / torch.sqrt(v + eps)
def _scatter_add(tgt, idx, src, axis=0):
    return tgt.clone().index_add_(axis, idx, src)
def _segment_sum(src, seg, n):
    out = torch.zeros((n,) + src.shape[1:], dtype=src.dtype)
    return out.index_add_(0, seg, src)
def _pad(x, pw):
    flat = tuple(v for pair in reversed(pw) for v in pair)
    return torch.nn.functional.pad(x, flat)

kernel_name = 'parallel_sum__ssm_conv_s4__glu_gated_geglu__prompt'

def setup_inputs():

    _w = (lambda a: (lambda t: t.to(torch.bfloat16) if t.is_floating_point() else t)(torch.as_tensor(a)))
    def _A_setup():
        B, L, D, N = 1, 2048, 448, 256
        A_re = -(lambda _x: torch.exp(torch.as_tensor(_x)))((lambda *s: torch.randn(*s, dtype=torch.bfloat16) * 6.4)(D, N))
        A_im = torch.pi * (lambda *s: torch.randn(*s, dtype=torch.bfloat16) * 0.05)(D, N)
        B_re = (lambda *s: torch.randn(*s, dtype=torch.bfloat16) * 0.1)(D, N)
        B_im = (lambda *s: torch.randn(*s, dtype=torch.bfloat16) * 0.1)(D, N)
        C_re = (lambda *s: torch.randn(*s, dtype=torch.bfloat16) * 0.1)(D, N)
        C_im = (lambda *s: torch.randn(*s, dtype=torch.bfloat16) * 0.1)(D, N)
        log_dt = (lambda *s: torch.randn(*s, dtype=torch.bfloat16) * 0.05)(D) * 0.5 - 4.0
        Dskip = (lambda *s: torch.randn(*s, dtype=torch.bfloat16) * 0.05)(D)
        return {
            "u": _w((lambda *s: torch.randn(*s, dtype=torch.bfloat16) * 0.05)(B, L, D)),
            "A_re": _w(A_re),
            "A_im": _w(A_im),
            "B_re": _w(B_re),
            "B_im": _w(B_im),
            "C_re": _w(C_re),
            "C_im": _w(C_im),
            "log_dt": _w(log_dt),
            "Dskip": _w(Dskip),
        }
    _A_in = _A_setup()

    def _B_setup():
        B, S, Dm, Df = 1, 2048, 448, 1792
        return {
            "x": _w((lambda *s: torch.randn(*s, dtype=torch.bfloat16) * 0.05)(B, S, Dm)),
            "w_gate": _w((lambda *s: torch.randn(*s, dtype=torch.bfloat16) * 0.4)(Dm, Df) * (Dm ** -0.5)),
            "w_up": _w((lambda *s: torch.randn(*s, dtype=torch.bfloat16) * 0.4)(Dm, Df) * (Dm ** -0.5)),
            "w_down": _w((lambda *s: torch.randn(*s, dtype=torch.bfloat16) * 0.4)(Df, Dm) * (Df ** -0.5)),
        }
    _B_in = _B_setup()

    return {
        "A_u": _A_in["u"],
        "A_A_re": _A_in["A_re"],
        "A_A_im": _A_in["A_im"],
        "A_B_re": _A_in["B_re"],
        "A_B_im": _A_in["B_im"],
        "A_C_re": _A_in["C_re"],
        "A_C_im": _A_in["C_im"],
        "A_log_dt": _A_in["log_dt"],
        "A_Dskip": _A_in["Dskip"],
        "B_x": _B_in["x"],
        "B_w_gate": _B_in["w_gate"],
        "B_w_up": _B_in["w_up"],
        "B_w_down": _B_in["w_down"],
    }

def reference(A_u, A_A_re, A_A_im, A_B_re, A_B_im, A_C_re, A_C_im, A_log_dt, A_Dskip, B_x, B_w_gate, B_w_up, B_w_down):
    def _A_ref(u, A_re, A_im, B_re, B_im, C_re, C_im, log_dt, Dskip):
        Bsz, L, D = u.shape
        dt = torch.exp(log_dt)[:, None]
        A = A_re + 1j * A_im
        Bc = B_re + 1j * B_im
        Cc = C_re + 1j * C_im
        logdA = dt * A
        dB = dt * Bc
        l = (lambda x, dt: x.to(dt))(torch.arange(L), A_re.dtype)
        P = torch.exp(logdA[:, :, None] * l[None, None, :])
        K = torch.einsum("dn,dnl,dn->dl", Cc, P, dB).real
        L2 = 2 * L
        Kp = _pad(K, ((0, 0), (0, L)))
        up = (lambda x, *d: x.permute(*d))(u, 0, 2, 1)
        up = _pad(up, ((0, 0), (0, 0), (0, L)))
        Kf = (lambda x, axes=(-2,-1): torch.fft.rfft2(x.float(), dim=axes))(Kp[:, None, :], axes=(-2, -1))
        Uf = (lambda x, axes=(-2,-1): torch.fft.rfft2(x.float(), dim=axes))(up[:, :, None, :], axes=(-2, -1))
        Yf = Uf * Kf[None, :, :, :]
        y = (lambda x, s, axes=(-2,-1): torch.fft.irfft2(x, s=s, dim=axes).to(torch.bfloat16))(Yf, (1, L2), axes=(-2, -1))[:, :, 0, :L]
        y = (lambda x, *d: x.permute(*d))(y, 0, 2, 1) + u * Dskip[None, None, :]
        return y

    def _B_ref(x, w_gate, w_up, w_down):
        g = torch.einsum("bsd,df->bsf", x, w_gate)
        u = torch.einsum("bsd,df->bsf", x, w_up)
        h = _gelu(g) * u
        return torch.einsum("bsf,fd->bsd", h, w_down)

    x = A_u
    xn = _layernorm(x, axis=-1)
    return x + _A_ref(xn, A_A_re, A_A_im, A_B_re, A_B_im, A_C_re, A_C_im, A_log_dt, A_Dskip) + _B_ref(xn, B_w_gate, B_w_up, B_w_down)
```

```asm
; @launch grid=(256,1,1) block=(512,1,1) lds=163840
.amdgcn_target "amdgcn-amd-amdhsa--gfx950"
.text
.globl parallel_sum__ssm_conv_s4__glu_gated_geglu__prompt_kernel
.p2align 8
.type parallel_sum__ssm_conv_s4__glu_gated_geglu__prompt_kernel,@function
parallel_sum__ssm_conv_s4__glu_gated_geglu__prompt_kernel:
    s_cmp_ge_u32 s2, 256
    s_cbranch_scc1 k_exit
    s_load_dwordx16 s[40:55], s[0:1], 0
    s_load_dwordx16 s[56:71], s[0:1], 64
    s_getpc_b64 s[36:37]
    s_bfe_u32 s38, s2, 0x20003
    s_mul_i32 s38, s38, 12288
    v_lshrrev_b32 v2, 2, v0
    v_min_u32 v2, 95, v2
    v_lshl_add_u32 v2, v2, 7, s38
    v_min_u32 v2, kend-parallel_sum__ssm_conv_s4__glu_gated_geglu__prompt_kernel-64, v2
    global_load_dword v255, v2, s[36:37]
    s_add_u32 s2, s2, 224
    s_and_b32 s2, s2, 255
    v_and_b32 v1, 63, v0
    v_lshrrev_b32 v2, 6, v0
    s_nop 0
    v_readfirstlane_b32 s3, v2
    s_cmp_ge_u32 s2, 224
    s_cbranch_scc1 k_helper
    s_and_b32 s36, s2, 7
    s_lshr_b32 s37, s2, 3
    s_and_b32 s28, s36, 3
    s_lshl_b32 s28, s28, 2
    s_and_b32 s38, s37, 3
    s_add_u32 s28, s28, s38
    s_lshr_b32 s29, s36, 2
    s_mul_i32 s29, s29, 7
    s_lshr_b32 s38, s37, 2
    s_add_u32 s29, s29, s38
    s_and_b32 s39, s37, 3
    s_lshl_b32 s39, s39, 1
    s_add_u32 s39, s39, s38
    s_sub_u32 s38, s39, 7
    s_cselect_b32 s34, s39, s38
    s_and_b32 s31, s3, 3
    s_and_b32 s30, s3, 3
    s_cmp_lt_u32 s3, 4
    s_cbranch_scc1 k_A
    s_setprio 2
    s_lshr_b32 s36, s30, 1
    s_lshl_b32 s38, s2, 1
    s_add_u32 s38, s38, s36
    v_and_b32 v120, 127, v0
    v_lshlrev_b32 v121, 5, v120
    s_lshl_b32 s39, s38, 9
    v_lshlrev_b32 v115, 2, v120
    v_add_u32 v115, s39, v115
    s_lshl_b32 s38, s38, 1
    v_mov_b32 v116, s38
    s_getpc_b64 s[38:39]
kg_pc:
    s_add_u32 s38, s38, ktab-kg_pc
    s_addc_u32 s39, s39, 0
    s_waitcnt lgkmcnt(0)
    global_load_ushort v117, v116, s[54:55]
    global_load_dword v192, v115, s[42:43] nt
    global_load_dword v193, v115, s[44:45] nt
    global_load_dword v194, v115, s[46:47] nt
    global_load_dword v195, v115, s[48:49] nt
    global_load_dword v196, v115, s[50:51] nt
    global_load_dword v197, v115, s[52:53] nt
    global_load_ushort v118, v116, s[56:57]
    global_load_dwordx4 v[8:11], v121, s[38:39]
    global_load_dwordx4 v[12:15], v121, s[38:39] offset:16
    s_branch k_B
k_A:
    s_setprio 1
    v_lshrrev_b32 v12, 3, v1
    s_lshl_b32 s37, s28, 7
    s_lshl_b32 s38, s31, 5
    s_add_u32 s37, s37, s38
    v_bfe_u32 v14, v12, 3, 1
    v_lshlrev_b32 v13, 4, v14
    v_bfe_u32 v14, v12, 1, 1
    v_lshl_or_b32 v13, v14, 3, v13
    v_and_b32 v14, 1, v12
    v_lshl_or_b32 v13, v14, 2, v13
    v_bfe_u32 v14, v12, 2, 1
    v_lshl_or_b32 v13, v14, 1, v13
    v_bfe_u32 v14, v12, 4, 1
    v_or_b32 v13, v14, v13
    v_add_u32 v13, s37, v13
    v_mul_u32_u24 v242, 896, v13
    v_bfe_u32 v13, v12, 1, 3
    v_and_b32 v14, 7, v1
    v_xor_b32 v13, v13, v14
    v_lshl_add_u32 v242, v13, 4, v242
    v_add_u32 v12, 8, v12
    v_bfe_u32 v14, v12, 3, 1
    v_lshlrev_b32 v13, 4, v14
    v_bfe_u32 v14, v12, 1, 1
    v_lshl_or_b32 v13, v14, 3, v13
    v_and_b32 v14, 1, v12
    v_lshl_or_b32 v13, v14, 2, v13
    v_bfe_u32 v14, v12, 2, 1
    v_lshl_or_b32 v13, v14, 1, v13
    v_bfe_u32 v14, v12, 4, 1
    v_or_b32 v13, v14, v13
    v_add_u32 v13, s37, v13
    v_mul_u32_u24 v243, 896, v13
    v_bfe_u32 v13, v12, 1, 3
    v_and_b32 v14, 7, v1
    v_xor_b32 v13, v13, v14
    v_lshl_add_u32 v243, v13, 4, v243
    v_add_u32 v12, 8, v12
    v_bfe_u32 v14, v12, 3, 1
    v_lshlrev_b32 v13, 4, v14
    v_bfe_u32 v14, v12, 1, 1
    v_lshl_or_b32 v13, v14, 3, v13
    v_and_b32 v14, 1, v12
    v_lshl_or_b32 v13, v14, 2, v13
    v_bfe_u32 v14, v12, 2, 1
    v_lshl_or_b32 v13, v14, 1, v13
    v_bfe_u32 v14, v12, 4, 1
    v_or_b32 v13, v14, v13
    v_add_u32 v13, s37, v13
    v_mul_u32_u24 v244, 896, v13
    v_bfe_u32 v13, v12, 1, 3
    v_and_b32 v14, 7, v1
    v_xor_b32 v13, v13, v14
    v_lshl_add_u32 v244, v13, 4, v244
    v_add_u32 v12, 8, v12
    v_bfe_u32 v14, v12, 3, 1
    v_lshlrev_b32 v13, 4, v14
    v_bfe_u32 v14, v12, 1, 1
    v_lshl_or_b32 v13, v14, 3, v13
    v_and_b32 v14, 1, v12
    v_lshl_or_b32 v13, v14, 2, v13
    v_bfe_u32 v14, v12, 2, 1
    v_lshl_or_b32 v13, v14, 1, v13
    v_bfe_u32 v14, v12, 4, 1
    v_or_b32 v13, v14, v13
    v_add_u32 v13, s37, v13
    v_mul_u32_u24 v245, 896, v13
    v_bfe_u32 v13, v12, 1, 3
    v_and_b32 v14, 7, v1
    v_xor_b32 v13, v13, v14
    v_lshl_add_u32 v245, v13, 4, v245
    v_lshrrev_b32 v12, 5, v1
    v_and_b32 v13, 3, v1
    v_lshl_add_u32 v13, v12, 2, v13
    v_lshlrev_b32 v13, 4, v13
    s_lshl_b32 s37, s29, 8
    v_add_u32 v13, s37, v13
    v_bfe_u32 v12, v1, 2, 3
    v_mul_u32_u24 v246, 3584, v12
    v_add_u32 v246, v246, v13
    v_xor_b32 v247, 32, v246
    s_mul_i32 s32, s31, 28672
    s_lshl_b32 s33, s31, 12
    s_and_b32 s37, s31, 1
    s_lshl_b32 s37, s37, 5
    v_xor_b32 v246, s37, v246
    v_mov_b32 v247, v246
    s_waitcnt lgkmcnt(0)
    s_mov_b32 s4, s40
    s_mov_b32 s5, s41
    s_mov_b32 s6, 1835008
    s_mov_b32 s7, 0x00020000
    s_mov_b32 s8, s60
    s_mov_b32 s9, s61
    s_mov_b32 s10, 1605632
    s_mov_b32 s11, 0x00020000
    s_mov_b32 s12, s62
    s_mov_b32 s13, s63
    s_mov_b32 s14, 1605632
    s_mov_b32 s15, 0x00020000
    s_add_u32 m0, s33, 0
    s_movk_i32 s35, 0
    buffer_load_dwordx4 v242, s[4:7], s35 offen lds
    s_add_u32 m0, s33, 1024
    s_movk_i32 s35, 0
    buffer_load_dwordx4 v243, s[4:7], s35 offen lds
    s_add_u32 m0, s33, 2048
    s_movk_i32 s35, 0
    buffer_load_dwordx4 v244, s[4:7], s35 offen lds
    s_add_u32 m0, s33, 3072
    s_movk_i32 s35, 0
    buffer_load_dwordx4 v245, s[4:7], s35 offen lds
    s_add_u32 m0, s33, 49152
    s_add_u32 s35, s32, 0
    buffer_load_dwordx4 v246, s[8:11], s35 offen lds
    s_add_u32 m0, s33, 50176
    s_nop 0
    buffer_load_dwordx4 v247, s[12:15], s35 offen lds
    s_add_u32 m0, s33, 51200
    s_add_u32 s35, s32, 128
    buffer_load_dwordx4 v246, s[8:11], s35 offen lds
    s_add_u32 m0, s33, 52224
    s_nop 0
    buffer_load_dwordx4 v247, s[12:15], s35 offen lds
    s_add_u32 m0, s33, 65536
    s_add_u32 s35, s32, 114688
    buffer_load_dwordx4 v246, s[8:11], s35 offen lds
    s_add_u32 m0, s33, 66560
    s_nop 0
    buffer_load_dwordx4 v247, s[12:15], s35 offen lds
    s_add_u32 m0, s33, 67584
    s_add_u32 s35, s32, 114816
    buffer_load_dwordx4 v246, s[8:11], s35 offen lds
    s_add_u32 m0, s33, 68608
    s_nop 0
    buffer_load_dwordx4 v247, s[12:15], s35 offen lds
    s_add_u32 m0, s33, 16384
    s_movk_i32 s35, 128
    buffer_load_dwordx4 v242, s[4:7], s35 offen lds
    s_add_u32 m0, s33, 17408
    s_movk_i32 s35, 128
    buffer_load_dwordx4 v243, s[4:7], s35 offen lds
    s_add_u32 m0, s33, 18432
    s_movk_i32 s35, 128
    buffer_load_dwordx4 v244, s[4:7], s35 offen lds
    s_add_u32 m0, s33, 19456
    s_movk_i32 s35, 128
    buffer_load_dwordx4 v245, s[4:7], s35 offen lds
    v_bfe_u32 v12, v1, 4, 1
    v_lshrrev_b32 v13, 5, v1
    v_lshlrev_b32 v14, 12, v13
    v_lshl_add_u32 v14, v12, 10, v14
    v_bfe_u32 v15, v1, 2, 2
    v_lshl_add_u32 v14, v15, 6, v14
    v_and_b32 v15, 1, v1
    v_lshl_add_u32 v14, v15, 4, v14
    v_bfe_u32 v15, v1, 1, 1
    v_lshl_add_u32 v14, v15, 3, v14
    s_lshr_b32 s36, s31, 1
    s_lshl_b32 s36, s36, 11
    s_and_b32 s37, s31, 1
    s_lshl_b32 s37, s37, 9
    s_add_u32 s36, s36, s37
    s_add_u32 s36, s36, 49152
    v_add_u32 v14, s36, v14
    v_lshl_add_u32 v6, v12, 5, v14
    v_xor_b32 v12, 1, v12
    v_lshl_add_u32 v7, v12, 5, v14
    v_and_b32 v12, 31, v1
    v_bfe_u32 v14, v1, 1, 3
    v_lshlrev_b32 v12, 7, v12
    v_add_u32 v15, 0, v13
    v_xor_b32 v15, v15, v14
    v_lshl_add_u32 v8, v15, 4, v12
    v_add_u32 v15, 2, v13
    v_xor_b32 v15, v15, v14
    v_lshl_add_u32 v9, v15, 4, v12
    v_add_u32 v15, 4, v13
    v_xor_b32 v15, v15, v14
    v_lshl_add_u32 v10, v15, 4, v12
    v_add_u32 v15, 6, v13
    v_xor_b32 v15, v15, v14
    v_lshl_add_u32 v11, v15, 4, v12
    v_lshrrev_b32 v13, 4, v1
    v_lshlrev_b32 v14, 12, v13
    v_bfe_u32 v15, v1, 2, 2
    v_lshl_add_u32 v14, v15, 6, v14
    v_and_b32 v15, 3, v1
    v_lshl_add_u32 v14, v15, 3, v14
    v_add_u32 v14, s36, v14
    v_and_b32 v12, 1, v13
    v_lshl_add_u32 v6, v12, 5, v14
    v_xor_b32 v7, 32, v6
    v_and_b32 v12, 15, v1
    v_bfe_u32 v14, v1, 1, 3
    v_lshlrev_b32 v12, 7, v12
    v_xor_b32 v15, v13, v14
    v_lshl_add_u32 v8, v15, 4, v12
    v_xor_b32 v9, 64, v8
    s_cmp_eq_u32 s3, 0
    s_cselect_b32 s36, s60, s64
    s_cselect_b32 s37, s61, s65
    s_cmp_eq_u32 s3, 1
    s_cselect_b32 s36, s62, s36
    s_cselect_b32 s37, s63, s37
    s_mul_i32 s38, s2, 7168
    v_min_u32 v12, 55, v1
    v_lshlrev_b32 v12, 7, v12
    v_add_u32 v12, s38, v12
    global_load_dword v251, v12, s[36:37]
    s_lshl_b32 s36, s3, 21
    s_add_u32 s36, s70, s36
    s_addc_u32 s37, s71, 0
    s_load_dword s100, s[36:37], 0
    s_load_dword s101, s[66:67], 0
    s_load_dword s101, s[68:69], 0
    s_add_u32 s36, s36, 8388608
    s_addc_u32 s37, s37, 0
    s_load_dword s100, s[36:37], 0
    s_load_dword s101, s[64:65], 0
    s_mov_b32 s16, s68
    s_mov_b32 s17, s69
    s_mov_b32 s18, 256
    s_mov_b32 s19, 0x00020000
    s_lshl_b32 s36, s28, 1
    s_lshl_b32 s48, 3, s36
    s_bfe_u32 s36, s2, 0x10002
    s_mul_i32 s37, s36, 7
    s_sub_u32 s37, s29, s37
    s_lshl_b32 s36, s36, 2
    s_lshr_b32 s38, s37, 1
    s_lshl_b32 s38, s38, 3
    s_add_u32 s36, s36, s38
    s_and_b32 s37, s37, 1
    s_lshl_b32 s37, s37, 1
    s_add_u32 s36, s36, s37
    s_lshl_b32 s36, 3, s36
    s_or_b32 s48, s48, s36
    s_and_b32 s38, s2, 7
    s_lshr_b32 s39, s2, 3
    s_lshl_b32 s56, s38, 2
    s_and_b32 s38, s39, 3
    s_add_u32 s56, s56, s38
    s_lshr_b32 s57, s39, 2
    s_and_b32 s42, s3, 1
    s_lshr_b32 s43, s3, 1
    s_mul_i32 s51, s42, 9216
    v_and_b32 v12, 31, v1
    v_bfe_u32 v14, v12, 3, 1
    v_lshlrev_b32 v13, 4, v14
    v_bfe_u32 v14, v12, 1, 1
    v_lshl_or_b32 v13, v14, 3, v13
    v_and_b32 v14, 1, v12
    v_lshl_or_b32 v13, v14, 2, v13
    v_bfe_u32 v14, v12, 2, 1
    v_lshl_or_b32 v13, v14, 1, v13
    v_bfe_u32 v14, v12, 4, 1
    v_or_b32 v13, v14, v13
    v_lshlrev_b32 v14, 2, v12
    s_lshr_b32 s36, s2, 3
    s_lshl_b32 s36, s36, 2
    s_add_u32 s36, s36, s3
    s_mul_i32 s36, s36, 14336
    v_lshrrev_b32 v252, 2, v1
    v_lshlrev_b32 v252, 7, v252
    v_add_u32 v252, s36, v252
    v_mov_b32 v2, 0x3f803f80
    v_mov_b32 v3, 0x3f803f80
    v_lshrrev_b32 v4, 5, v1
    v_lshlrev_b32 v4, 10, v4
    v_bfe_u32 v5, v1, 4, 1
    v_lshl_add_u32 v4, v5, 9, v4
    v_bfe_u32 v5, v1, 2, 1
    v_lshl_add_u32 v4, v5, 5, v4
    v_bfe_u32 v5, v1, 3, 1
    v_lshl_add_u32 v4, v5, 4, v4
    s_lshl_b32 s36, s31, 7
    s_add_u32 s36, s36, 161792
    v_add_u32 v4, s36, v4
    v_lshlrev_b32 v13, 4, v13
    v_add_u32 v13, 157696, v13
    v_lshrrev_b32 v12, 5, v1
    v_lshlrev_b32 v12, 5, v12
    s_lshl_b32 s36, s31, 7
    s_add_u32 s36, s36, 159744
    v_add_u32 v12, s36, v12
    v_lshlrev_b32 v15, 4, v1
    v_mov_b32 v240, 0xc0135761
    v_mov_b32 v241, 0xbdd2d3e8
    s_mul_i32 s44, s28, 448
    s_lshl_b32 s37, s29, 3
    s_add_u32 s44, s44, s37
    s_lshl_b32 s37, s31, 1
    s_add_u32 s44, s44, s37
    s_lshl_b32 s44, s44, 10
    s_add_u32 s45, s44, 114688
    s_add_u32 s46, s44, 229376
    s_add_u32 s47, s44, 344064
    v_and_b32 v12, 15, v1
    v_bfe_u32 v4, v12, 3, 1
    v_lshlrev_b32 v13, 4, v4
    v_bfe_u32 v4, v12, 1, 1
    v_lshl_or_b32 v13, v4, 3, v13
    v_and_b32 v4, 1, v12
    v_lshl_or_b32 v13, v4, 2, v13
    v_bfe_u32 v4, v12, 2, 1
    v_lshl_or_b32 v13, v4, 1, v13
    v_bfe_u32 v4, v12, 4, 1
    v_or_b32 v13, v4, v13
    v_lshlrev_b32 v13, 4, v13
    v_add_u32 v13, 157696, v13
    v_lshlrev_b32 v15, 4, v12
    v_lshrrev_b32 v12, 4, v1
    v_lshl_add_u32 v15, v12, 9, v15
    v_lshl_add_u32 v12, v12, 4, s36
    v_mov_b32 v4, 0x3f803f80
    v_mov_b32 v5, 0x3f803f80
    s_waitcnt vmcnt(9) lgkmcnt(0)
    s_barrier
    ds_read_b64_tr_b16 v[208:209], v6 offset:0
    ds_read_b64_tr_b16 v[210:211], v6 offset:256
    ds_read_b128 v[160:163], v8 offset:0
    ds_read_b64_tr_b16 v[212:213], v7 offset:0
    ds_read_b64_tr_b16 v[214:215], v7 offset:256
    ds_read_b64_tr_b16 v[216:217], v6 offset:1024
    ds_read_b64_tr_b16 v[218:219], v6 offset:1280
    ds_read_b64_tr_b16 v[220:221], v7 offset:1024
    ds_read_b64_tr_b16 v[222:223], v7 offset:1280
    ds_read_b128 v[164:167], v8 offset:2048
    ds_read_b128 v[168:171], v8 offset:4096
    ds_read_b128 v[172:175], v8 offset:6144
    s_add_u32 m0, s33, 81920
    s_add_u32 s35, s32, 229376
    buffer_load_dwordx4 v246, s[8:11], s35 offen lds
    s_add_u32 m0, s33, 82944
    s_nop 0
    buffer_load_dwordx4 v247, s[12:15], s35 offen lds
    s_add_u32 m0, s33, 83968
    s_add_u32 s35, s32, 229504
    buffer_load_dwordx4 v246, s[8:11], s35 offen lds
    s_add_u32 m0, s33, 84992
    s_nop 0
    buffer_load_dwordx4 v247, s[12:15], s35 offen lds
    s_waitcnt lgkmcnt(9)
    v_mfma_f32_16x16x32_bf16 v[16:19], v[208:211], v[160:163], 0
    s_waitcnt lgkmcnt(7)
    v_mfma_f32_16x16x32_bf16 v[20:23], v[212:215], v[160:163], 0
    s_add_u32 m0, s33, 98304
    s_add_u32 s35, s32, 344064
    buffer_load_dwordx4 v246, s[8:11], s35 offen lds
    s_waitcnt lgkmcnt(5)
    v_mfma_f32_16x16x32_bf16 v[24:27], v[216:219], v[160:163], 0
    s_waitcnt lgkmcnt(3)
    v_mfma_f32_16x16x32_bf16 v[28:31], v[220:223], v[160:163], 0
    s_add_u32 m0, s33, 99328
    s_nop 0
    buffer_load_dwordx4 v247, s[12:15], s35 offen lds
    s_waitcnt lgkmcnt(2)
    v_mfma_f32_16x16x32_bf16 v[44:47], v[220:223], v[164:167], 0
    ds_read_b128 v[176:179], v8 offset:8192
    v_mfma_f32_16x16x32_bf16 v[40:43], v[216:219], v[164:167], 0
    ds_read_b128 v[180:183], v8 offset:10240
    s_add_u32 m0, s33, 100352
    s_add_u32 s35, s32, 344192
    buffer_load_dwordx4 v246, s[8:11], s35 offen lds
    v_mfma_f32_16x16x32_bf16 v[36:39], v[212:215], v[164:167], 0
    ds_read_b128 v[184:187], v8 offset:12288
    v_mfma_f32_16x16x32_bf16 v[32:35], v[208:211], v[164:167], 0
    ds_read_b128 v[188:191], v8 offset:14336
    s_add_u32 m0, s33, 101376
    s_nop 0
    buffer_load_dwordx4 v247, s[12:15], s35 offen lds
    s_waitcnt lgkmcnt(5)
    v_mfma_f32_16x16x32_bf16 v[48:51], v[208:211], v[168:171], 0
    v_mfma_f32_16x16x32_bf16 v[52:55], v[212:215], v[168:171], 0
    s_add_u32 m0, s33, 32768
    s_movk_i32 s35, 256
    buffer_load_dwordx4 v242, s[4:7], s35 offen lds
    v_mfma_f32_16x16x32_bf16 v[56:59], v[216:219], v[168:171], 0
    v_mfma_f32_16x16x32_bf16 v[60:63], v[220:223], v[168:171], 0
    s_add_u32 m0, s33, 33792
    s_movk_i32 s35, 256
    buffer_load_dwordx4 v243, s[4:7], s35 offen lds
    s_waitcnt lgkmcnt(4)
    v_mfma_f32_16x16x32_bf16 v[76:79], v[220:223], v[172:175], 0
    v_mfma_f32_16x16x32_bf16 v[72:75], v[216:219], v[172:175], 0
    s_add_u32 m0, s33, 34816
    s_movk_i32 s35, 256
    buffer_load_dwordx4 v244, s[4:7], s35 offen lds
    v_mfma_f32_16x16x32_bf16 v[68:71], v[212:215], v[172:175], 0
    v_mfma_f32_16x16x32_bf16 v[64:67], v[208:211], v[172:175], 0
    s_add_u32 m0, s33, 35840
    s_movk_i32 s35, 256
    buffer_load_dwordx4 v245, s[4:7], s35 offen lds
    s_waitcnt lgkmcnt(0) vmcnt(17)
    s_barrier
    v_mfma_f32_16x16x32_bf16 v[80:83], v[208:211], v[176:179], 0
    ds_read_b64_tr_b16 v[144:145], v6 offset:16384
    ds_read_b64_tr_b16 v[146:147], v6 offset:16640
    v_mfma_f32_16x16x32_bf16 v[84:87], v[212:215], v[176:179], 0
    ds_read_b128 v[160:163], v9 offset:0
    ds_read_b64_tr_b16 v[148:149], v7 offset:16384
    v_mfma_f32_16x16x32_bf16 v[88:91], v[216:219], v[176:179], 0
    ds_read_b64_tr_b16 v[150:151], v7 offset:16640
    ds_read_b64_tr_b16 v[152:153], v6 offset:17408
    v_mfma_f32_16x16x32_bf16 v[92:95], v[220:223], v[176:179], 0
    v_mfma_f32_16x16x32_bf16 v[192:195], v[208:211], v[2:5], 0
    ds_read_b64_tr_b16 v[154:155], v6 offset:17664
    ds_read_b64_tr_b16 v[156:157], v7 offset:17408
    v_mfma_f32_16x16x32_bf16 v[108:111], v[220:223], v[180:183], 0
    ds_read_b64_tr_b16 v[158:159], v7 offset:17664
    ds_read_b128 v[164:167], v9 offset:2048
    v_mfma_f32_16x16x32_bf16 v[104:107], v[216:219], v[180:183], 0
    ds_read_b128 v[168:171], v9 offset:4096
    ds_read_b128 v[172:175], v9 offset:6144
    v_mfma_f32_16x16x32_bf16 v[100:103], v[212:215], v[180:183], 0
    v_mfma_f32_16x16x32_bf16 v[96:99], v[208:211], v[180:183], 0
    v_mfma_f32_16x16x32_bf16 v[196:199], v[212:215], v[2:5], 0
    v_mfma_f32_16x16x32_bf16 v[112:115], v[208:211], v[184:187], 0
    v_mfma_f32_16x16x32_bf16 v[116:119], v[212:215], v[184:187], 0
    v_mfma_f32_16x16x32_bf16 v[120:123], v[216:219], v[184:187], 0
    v_mfma_f32_16x16x32_bf16 v[124:127], v[220:223], v[184:187], 0
    v_mfma_f32_16x16x32_bf16 v[200:203], v[216:219], v[2:5], 0
    v_mfma_f32_16x16x32_bf16 v[140:143], v[220:223], v[188:191], 0
    v_mfma_f32_16x16x32_bf16 v[136:139], v[216:219], v[188:191], 0
    v_mfma_f32_16x16x32_bf16 v[132:135], v[212:215], v[188:191], 0
    v_mfma_f32_16x16x32_bf16 v[128:131], v[208:211], v[188:191], 0
    v_mfma_f32_16x16x32_bf16 v[204:207], v[220:223], v[2:5], 0
    s_waitcnt lgkmcnt(0)
    v_mfma_f32_16x16x32_bf16 v[16:19], v[144:147], v[160:163], v[16:19]
    v_mfma_f32_16x16x32_bf16 v[20:23], v[148:151], v[160:163], v[20:23]
    s_mov_b32 s4, s70
    s_mov_b32 s5, s71
    v_mfma_f32_16x16x32_bf16 v[24:27], v[152:155], v[160:163], v[24:27]
    v_mfma_f32_16x16x32_bf16 v[28:31], v[156:159], v[160:163], v[28:31]
    s_mov_b32 s6, 7340032
    s_mov_b32 s7, 0x00020000
    v_lshrrev_b32 v244, 5, v1
    v_mfma_f32_16x16x32_bf16 v[44:47], v[156:159], v[164:167], v[44:47]
    ds_read_b128 v[176:179], v9 offset:8192
    v_mfma_f32_16x16x32_bf16 v[40:43], v[152:155], v[164:167], v[40:43]
    ds_read_b128 v[180:183], v9 offset:10240
    v_lshlrev_b32 v244, 9, v244
    v_bfe_u32 v248, v1, 2, 2
    v_mfma_f32_16x16x32_bf16 v[36:39], v[148:151], v[164:167], v[36:39]
    ds_read_b128 v[184:187], v9 offset:12288
    v_mfma_f32_16x16x32_bf16 v[32:35], v[144:147], v[164:167], v[32:35]
    ds_read_b128 v[188:191], v9 offset:14336
    v_lshl_add_u32 v244, v248, 7, v244
    v_and_b32 v248, 1, v1
    v_lshl_add_u32 v244, v248, 5, v244
    v_mfma_f32_16x16x32_bf16 v[48:51], v[144:147], v[168:171], v[48:51]
    v_mfma_f32_16x16x32_bf16 v[52:55], v[148:151], v[168:171], v[52:55]
    v_bfe_u32 v248, v1, 4, 1
    v_lshl_add_u32 v244, v248, 4, v244
    v_mfma_f32_16x16x32_bf16 v[56:59], v[152:155], v[168:171], v[56:59]
    v_mfma_f32_16x16x32_bf16 v[60:63], v[156:159], v[168:171], v[60:63]
    v_bfe_u32 v248, v1, 1, 1
    v_lshl_add_u32 v244, v248, 3, v244
    v_bfe_u32 v248, v1, 3, 1
    v_mfma_f32_16x16x32_bf16 v[76:79], v[156:159], v[172:175], v[76:79]
    v_mfma_f32_16x16x32_bf16 v[72:75], v[152:155], v[172:175], v[72:75]
    v_lshl_add_u32 v244, v248, 6, v244
    v_add_u32 v244, s33, v244
    v_mfma_f32_16x16x32_bf16 v[68:71], v[148:151], v[172:175], v[68:71]
    v_mfma_f32_16x16x32_bf16 v[64:67], v[144:147], v[172:175], v[64:67]
    v_xor_b32 v245, 64, v244
    v_add_u32 v246, 0x10000, v244
    v_add_u32 v247, 0x10000, v245
    s_waitcnt lgkmcnt(0) vmcnt(8)
    s_barrier
    v_mfma_f32_16x16x32_bf16 v[80:83], v[144:147], v[176:179], v[80:83]
    ds_read_b64_tr_b16 v[208:209], v6 offset:32768
    ds_read_b64_tr_b16 v[210:211], v6 offset:33024
    v_mfma_f32_16x16x32_bf16 v[84:87], v[148:151], v[176:179], v[84:87]
    ds_read_b128 v[160:163], v8 offset:16384
    ds_read_b64_tr_b16 v[212:213], v7 offset:32768
    v_mfma_f32_16x16x32_bf16 v[88:91], v[152:155], v[176:179], v[88:91]
    ds_read_b64_tr_b16 v[214:215], v7 offset:33024
    ds_read_b64_tr_b16 v[216:217], v6 offset:33792
    v_mfma_f32_16x16x32_bf16 v[92:95], v[156:159], v[176:179], v[92:95]
    v_mfma_f32_16x16x32_bf16 v[192:195], v[144:147], v[2:5], v[192:195]
    ds_read_b64_tr_b16 v[218:219], v6 offset:34048
    ds_read_b64_tr_b16 v[220:221], v7 offset:33792
    v_mfma_f32_16x16x32_bf16 v[108:111], v[156:159], v[180:183], v[108:111]
    ds_read_b64_tr_b16 v[222:223], v7 offset:34048
    ds_read_b128 v[164:167], v8 offset:18432
    v_mfma_f32_16x16x32_bf16 v[104:107], v[152:155], v[180:183], v[104:107]
    ds_read_b128 v[168:171], v8 offset:20480
    ds_read_b128 v[172:175], v8 offset:22528
    v_mfma_f32_16x16x32_bf16 v[100:103], v[148:151], v[180:183], v[100:103]
    v_mfma_f32_16x16x32_bf16 v[96:99], v[144:147], v[180:183], v[96:99]
    v_mfma_f32_16x16x32_bf16 v[196:199], v[148:151], v[2:5], v[196:199]
    v_mfma_f32_16x16x32_bf16 v[112:115], v[144:147], v[184:187], v[112:115]
    v_mfma_f32_16x16x32_bf16 v[116:119], v[148:151], v[184:187], v[116:119]
    v_mfma_f32_16x16x32_bf16 v[120:123], v[152:155], v[184:187], v[120:123]
    v_mfma_f32_16x16x32_bf16 v[124:127], v[156:159], v[184:187], v[124:127]
    v_mfma_f32_16x16x32_bf16 v[200:203], v[152:155], v[2:5], v[200:203]
    v_mfma_f32_16x16x32_bf16 v[140:143], v[156:159], v[188:191], v[140:143]
    v_mfma_f32_16x16x32_bf16 v[136:139], v[152:155], v[188:191], v[136:139]
    v_mfma_f32_16x16x32_bf16 v[132:135], v[148:151], v[188:191], v[132:135]
    v_mfma_f32_16x16x32_bf16 v[128:131], v[144:147], v[188:191], v[128:131]
    v_mfma_f32_16x16x32_bf16 v[204:207], v[156:159], v[2:5], v[204:207]
    s_waitcnt lgkmcnt(0)
    v_mfma_f32_16x16x32_bf16 v[16:19], v[208:211], v[160:163], v[16:19]
    v_mfma_f32_16x16x32_bf16 v[20:23], v[212:215], v[160:163], v[20:23]
    v_mfma_f32_16x16x32_bf16 v[24:27], v[216:219], v[160:163], v[24:27]
    v_mfma_f32_16x16x32_bf16 v[28:31], v[220:223], v[160:163], v[28:31]
    v_mfma_f32_16x16x32_bf16 v[44:47], v[220:223], v[164:167], v[44:47]
    ds_read_b128 v[176:179], v8 offset:24576
    v_mfma_f32_16x16x32_bf16 v[40:43], v[216:219], v[164:167], v[40:43]
    ds_read_b128 v[180:183], v8 offset:26624
    v_mfma_f32_16x16x32_bf16 v[36:39], v[212:215], v[164:167], v[36:39]
    ds_read_b128 v[184:187], v8 offset:28672
    v_mfma_f32_16x16x32_bf16 v[32:35], v[208:211], v[164:167], v[32:35]
    ds_read_b128 v[188:191], v8 offset:30720
    v_mfma_f32_16x16x32_bf16 v[48:51], v[208:211], v[168:171], v[48:51]
    v_mfma_f32_16x16x32_bf16 v[52:55], v[212:215], v[168:171], v[52:55]
    v_mfma_f32_16x16x32_bf16 v[56:59], v[216:219], v[168:171], v[56:59]
    v_mfma_f32_16x16x32_bf16 v[60:63], v[220:223], v[168:171], v[60:63]
    v_mfma_f32_16x16x32_bf16 v[76:79], v[220:223], v[172:175], v[76:79]
    v_mfma_f32_16x16x32_bf16 v[72:75], v[216:219], v[172:175], v[72:75]
    v_mfma_f32_16x16x32_bf16 v[68:71], v[212:215], v[172:175], v[68:71]
    v_mfma_f32_16x16x32_bf16 v[64:67], v[208:211], v[172:175], v[64:67]
    s_waitcnt lgkmcnt(0) vmcnt(4)
    s_barrier
    v_mfma_f32_16x16x32_bf16 v[80:83], v[208:211], v[176:179], v[80:83]
    ds_read_b64_tr_b16 v[144:145], v6 offset:49152
    ds_read_b64_tr_b16 v[146:147], v6 offset:49408
    v_mfma_f32_16x16x32_bf16 v[84:87], v[212:215], v[176:179], v[84:87]
    ds_read_b128 v[160:163], v9 offset:16384
    ds_read_b64_tr_b16 v[148:149], v7 offset:49152
    v_mfma_f32_16x16x32_bf16 v[88:91], v[216:219], v[176:179], v[88:91]
    ds_read_b64_tr_b16 v[150:151], v7 offset:49408
    ds_read_b64_tr_b16 v[152:153], v6 offset:50176
    v_mfma_f32_16x16x32_bf16 v[92:95], v[220:223], v[176:179], v[92:95]
    ds_read_b64_tr_b16 v[154:155], v6 offset:50432
    ds_read_b64_tr_b16 v[156:157], v7 offset:50176
    v_mfma_f32_16x16x32_bf16 v[108:111], v[220:223], v[180:183], v[108:111]
    ds_read_b64_tr_b16 v[158:159], v7 offset:50432
    ds_read_b128 v[164:167], v9 offset:18432
    v_mfma_f32_16x16x32_bf16 v[104:107], v[216:219], v[180:183], v[104:107]
    ds_read_b128 v[168:171], v9 offset:20480
    ds_read_b128 v[172:175], v9 offset:22528
    v_mfma_f32_16x16x32_bf16 v[100:103], v[212:215], v[180:183], v[100:103]
    v_mfma_f32_16x16x32_bf16 v[96:99], v[208:211], v[180:183], v[96:99]
    v_mfma_f32_16x16x32_bf16 v[112:115], v[208:211], v[184:187], v[112:115]
    v_mfma_f32_16x16x32_bf16 v[116:119], v[212:215], v[184:187], v[116:119]
    v_mfma_f32_16x16x32_bf16 v[120:123], v[216:219], v[184:187], v[120:123]
    v_mfma_f32_16x16x32_bf16 v[124:127], v[220:223], v[184:187], v[124:127]
    v_mfma_f32_16x16x32_bf16 v[140:143], v[220:223], v[188:191], v[140:143]
    v_mfma_f32_16x16x32_bf16 v[136:139], v[216:219], v[188:191], v[136:139]
    v_mfma_f32_16x16x32_bf16 v[132:135], v[212:215], v[188:191], v[132:135]
    v_mfma_f32_16x16x32_bf16 v[128:131], v[208:211], v[188:191], v[128:131]
    s_waitcnt lgkmcnt(0)
    v_mfma_f32_16x16x32_bf16 v[16:19], v[144:147], v[160:163], v[16:19]
    v_mfma_f32_16x16x32_bf16 v[20:23], v[148:151], v[160:163], v[20:23]
    v_mfma_f32_16x16x32_bf16 v[24:27], v[152:155], v[160:163], v[24:27]
    v_mfma_f32_16x16x32_bf16 v[28:31], v[156:159], v[160:163], v[28:31]
    v_mfma_f32_16x16x32_bf16 v[44:47], v[156:159], v[164:167], v[44:47]
    ds_read_b128 v[176:179], v9 offset:24576
    v_mfma_f32_16x16x32_bf16 v[40:43], v[152:155], v[164:167], v[40:43]
    ds_read_b128 v[180:183], v9 offset:26624
    v_mfma_f32_16x16x32_bf16 v[36:39], v[148:151], v[164:167], v[36:39]
    ds_read_b128 v[184:187], v9 offset:28672
    v_mfma_f32_16x16x32_bf16 v[32:35], v[144:147], v[164:167], v[32:35]
    ds_read_b128 v[188:191], v9 offset:30720
    v_mfma_f32_16x16x32_bf16 v[48:51], v[144:147], v[168:171], v[48:51]
    v_mfma_f32_16x16x32_bf16 v[52:55], v[148:151], v[168:171], v[52:55]
    v_mfma_f32_16x16x32_bf16 v[56:59], v[152:155], v[168:171], v[56:59]
    v_mfma_f32_16x16x32_bf16 v[60:63], v[156:159], v[168:171], v[60:63]
    v_mfma_f32_16x16x32_bf16 v[76:79], v[156:159], v[172:175], v[76:79]
    v_mfma_f32_16x16x32_bf16 v[72:75], v[152:155], v[172:175], v[72:75]
    v_mfma_f32_16x16x32_bf16 v[68:71], v[148:151], v[172:175], v[68:71]
    v_mfma_f32_16x16x32_bf16 v[64:67], v[144:147], v[172:175], v[64:67]
    s_waitcnt lgkmcnt(0) vmcnt(0)
    s_barrier
    v_mfma_f32_16x16x32_bf16 v[80:83], v[144:147], v[176:179], v[80:83]
    ds_read_b64_tr_b16 v[208:209], v6 offset:0
    ds_read_b64_tr_b16 v[210:211], v6 offset:256
    v_mfma_f32_16x16x32_bf16 v[84:87], v[148:151], v[176:179], v[84:87]
    ds_read_b128 v[160:163], v8 offset:32768
    ds_read_b64_tr_b16 v[212:213], v7 offset:0
    v_mfma_f32_16x16x32_bf16 v[88:91], v[152:155], v[176:179], v[88:91]
    ds_read_b64_tr_b16 v[214:215], v7 offset:256
    ds_read_b64_tr_b16 v[216:217], v6 offset:1024
    v_mfma_f32_16x16x32_bf16 v[92:95], v[156:159], v[176:179], v[92:95]
    ds_read_b64_tr_b16 v[218:219], v6 offset:1280
    ds_read_b64_tr_b16 v[220:221], v7 offset:1024
    v_mfma_f32_16x16x32_bf16 v[108:111], v[156:159], v[180:183], v[108:111]
    ds_read_b64_tr_b16 v[222:223], v7 offset:1280
    ds_read_b128 v[164:167], v8 offset:34816
    v_mfma_f32_16x16x32_bf16 v[104:107], v[152:155], v[180:183], v[104:107]
    ds_read_b128 v[168:171], v8 offset:36864
    ds_read_b128 v[172:175], v8 offset:38912
    v_mfma_f32_16x16x32_bf16 v[100:103], v[148:151], v[180:183], v[100:103]
    v_mfma_f32_16x16x32_bf16 v[96:99], v[144:147], v[180:183], v[96:99]
    v_mfma_f32_16x16x32_bf16 v[112:115], v[144:147], v[184:187], v[112:115]
    v_mfma_f32_16x16x32_bf16 v[116:119], v[148:151], v[184:187], v[116:119]
    v_mfma_f32_16x16x32_bf16 v[120:123], v[152:155], v[184:187], v[120:123]
    v_mfma_f32_16x16x32_bf16 v[124:127], v[156:159], v[184:187], v[124:127]
    v_mfma_f32_16x16x32_bf16 v[140:143], v[156:159], v[188:191], v[140:143]
    v_mfma_f32_16x16x32_bf16 v[136:139], v[152:155], v[188:191], v[136:139]
    v_mfma_f32_16x16x32_bf16 v[132:135], v[148:151], v[188:191], v[132:135]
    v_mfma_f32_16x16x32_bf16 v[128:131], v[144:147], v[188:191], v[128:131]
    s_waitcnt lgkmcnt(0)
    v_mfma_f32_16x16x32_bf16 v[16:19], v[208:211], v[160:163], v[16:19]
    v_mfma_f32_16x16x32_bf16 v[20:23], v[212:215], v[160:163], v[20:23]
    v_mfma_f32_16x16x32_bf16 v[24:27], v[216:219], v[160:163], v[24:27]
    v_mfma_f32_16x16x32_bf16 v[28:31], v[220:223], v[160:163], v[28:31]
    v_mfma_f32_16x16x32_bf16 v[44:47], v[220:223], v[164:167], v[44:47]
    ds_read_b128 v[176:179], v8 offset:40960
    v_mfma_f32_16x16x32_bf16 v[40:43], v[216:219], v[164:167], v[40:43]
    ds_read_b128 v[180:183], v8 offset:43008
    v_mfma_f32_16x16x32_bf16 v[36:39], v[212:215], v[164:167], v[36:39]
    ds_read_b128 v[184:187], v8 offset:45056
    v_mfma_f32_16x16x32_bf16 v[32:35], v[208:211], v[164:167], v[32:35]
    ds_read_b128 v[188:191], v8 offset:47104
    v_mfma_f32_16x16x32_bf16 v[48:51], v[208:211], v[168:171], v[48:51]
    v_mfma_f32_16x16x32_bf16 v[52:55], v[212:215], v[168:171], v[52:55]
    v_mfma_f32_16x16x32_bf16 v[56:59], v[216:219], v[168:171], v[56:59]
    v_mfma_f32_16x16x32_bf16 v[60:63], v[220:223], v[168:171], v[60:63]
    v_mfma_f32_16x16x32_bf16 v[76:79], v[220:223], v[172:175], v[76:79]
    v_mfma_f32_16x16x32_bf16 v[72:75], v[216:219], v[172:175], v[72:75]
    v_mfma_f32_16x16x32_bf16 v[68:71], v[212:215], v[172:175], v[68:71]
    v_mfma_f32_16x16x32_bf16 v[64:67], v[208:211], v[172:175], v[64:67]
    s_waitcnt lgkmcnt(0)
    s_barrier
    v_mfma_f32_16x16x32_bf16 v[80:83], v[208:211], v[176:179], v[80:83]
    ds_read_b64_tr_b16 v[144:145], v6 offset:16384
    ds_read_b64_tr_b16 v[146:147], v6 offset:16640
    v_mfma_f32_16x16x32_bf16 v[84:87], v[212:215], v[176:179], v[84:87]
    ds_read_b128 v[160:163], v9 offset:32768
    ds_read_b64_tr_b16 v[148:149], v7 offset:16384
    v_mfma_f32_16x16x32_bf16 v[88:91], v[216:219], v[176:179], v[88:91]
    ds_read_b64_tr_b16 v[150:151], v7 offset:16640
    ds_read_b64_tr_b16 v[152:153], v6 offset:17408
    v_mfma_f32_16x16x32_bf16 v[92:95], v[220:223], v[176:179], v[92:95]
    ds_read_b64_tr_b16 v[154:155], v6 offset:17664
    ds_read_b64_tr_b16 v[156:157], v7 offset:17408
    v_mfma_f32_16x16x32_bf16 v[108:111], v[220:223], v[180:183], v[108:111]
    ds_read_b64_tr_b16 v[158:159], v7 offset:17664
    ds_read_b128 v[164:167], v9 offset:34816
    v_mfma_f32_16x16x32_bf16 v[104:107], v[216:219], v[180:183], v[104:107]
    ds_read_b128 v[168:171], v9 offset:36864
    ds_read_b128 v[172:175], v9 offset:38912
    v_mfma_f32_16x16x32_bf16 v[100:103], v[212:215], v[180:183], v[100:103]
    v_mfma_f32_16x16x32_bf16 v[96:99], v[208:211], v[180:183], v[96:99]
    v_mfma_f32_16x16x32_bf16 v[112:115], v[208:211], v[184:187], v[112:115]
    v_mfma_f32_16x16x32_bf16 v[116:119], v[212:215], v[184:187], v[116:119]
    v_mfma_f32_16x16x32_bf16 v[120:123], v[216:219], v[184:187], v[120:123]
    v_mfma_f32_16x16x32_bf16 v[124:127], v[220:223], v[184:187], v[124:127]
    v_mfma_f32_16x16x32_bf16 v[140:143], v[220:223], v[188:191], v[140:143]
    v_mfma_f32_16x16x32_bf16 v[136:139], v[216:219], v[188:191], v[136:139]
    v_mfma_f32_16x16x32_bf16 v[132:135], v[212:215], v[188:191], v[132:135]
    v_mfma_f32_16x16x32_bf16 v[128:131], v[208:211], v[188:191], v[128:131]
    s_waitcnt lgkmcnt(0)
    v_mfma_f32_16x16x32_bf16 v[16:19], v[144:147], v[160:163], v[16:19]
    v_mfma_f32_16x16x32_bf16 v[20:23], v[148:151], v[160:163], v[20:23]
    v_mfma_f32_16x16x32_bf16 v[24:27], v[152:155], v[160:163], v[24:27]
    v_mfma_f32_16x16x32_bf16 v[28:31], v[156:159], v[160:163], v[28:31]
    v_mfma_f32_16x16x32_bf16 v[44:47], v[156:159], v[164:167], v[44:47]
    ds_read_b128 v[176:179], v9 offset:40960
    v_mfma_f32_16x16x32_bf16 v[40:43], v[152:155], v[164:167], v[40:43]
    ds_read_b128 v[180:183], v9 offset:43008
    v_mfma_f32_16x16x32_bf16 v[36:39], v[148:151], v[164:167], v[36:39]
    ds_read_b128 v[184:187], v9 offset:45056
    v_mfma_f32_16x16x32_bf16 v[32:35], v[144:147], v[164:167], v[32:35]
    ds_read_b128 v[188:191], v9 offset:47104
    v_mfma_f32_16x16x32_bf16 v[48:51], v[144:147], v[168:171], v[48:51]
    v_mfma_f32_16x16x32_bf16 v[52:55], v[148:151], v[168:171], v[52:55]
    v_mfma_f32_16x16x32_bf16 v[56:59], v[152:155], v[168:171], v[56:59]
    v_mfma_f32_16x16x32_bf16 v[60:63], v[156:159], v[168:171], v[60:63]
    v_mfma_f32_16x16x32_bf16 v[76:79], v[156:159], v[172:175], v[76:79]
    v_mfma_f32_16x16x32_bf16 v[72:75], v[152:155], v[172:175], v[72:75]
    v_mfma_f32_16x16x32_bf16 v[68:71], v[148:151], v[172:175], v[68:71]
    v_mfma_f32_16x16x32_bf16 v[64:67], v[144:147], v[172:175], v[64:67]
    s_waitcnt lgkmcnt(0)
    s_barrier
    v_mfma_f32_16x16x32_bf16 v[80:83], v[144:147], v[176:179], v[80:83]
    ds_read_b64_tr_b16 v[208:209], v6 offset:32768
    ds_read_b64_tr_b16 v[210:211], v6 offset:33024
    v_mfma_f32_16x16x32_bf16 v[84:87], v[148:151], v[176:179], v[84:87]
    ds_read_b128 v[160:163], v8 offset:0
    ds_read_b64_tr_b16 v[212:213], v7 offset:32768
    v_mfma_f32_16x16x32_bf16 v[88:91], v[152:155], v[176:179], v[88:91]
    ds_read_b64_tr_b16 v[214:215], v7 offset:33024
    ds_read_b64_tr_b16 v[216:217], v6 offset:33792
    v_mfma_f32_16x16x32_bf16 v[92:95], v[156:159], v[176:179], v[92:95]
    ds_read_b64_tr_b16 v[218:219], v6 offset:34048
    ds_read_b64_tr_b16 v[220:221], v7 offset:33792
    v_mfma_f32_16x16x32_bf16 v[108:111], v[156:159], v[180:183], v[108:111]
    ds_read_b64_tr_b16 v[222:223], v7 offset:34048
    ds_read_b128 v[164:167], v8 offset:2048
    v_mfma_f32_16x16x32_bf16 v[104:107], v[152:155], v[180:183], v[104:107]
    ds_read_b128 v[168:171], v8 offset:4096
    ds_read_b128 v[172:175], v8 offset:6144
    v_mfma_f32_16x16x32_bf16 v[100:103], v[148:151], v[180:183], v[100:103]
    v_mfma_f32_16x16x32_bf16 v[96:99], v[144:147], v[180:183], v[96:99]
    v_mfma_f32_16x16x32_bf16 v[112:115], v[144:147], v[184:187], v[112:115]
    v_mfma_f32_16x16x32_bf16 v[116:119], v[148:151], v[184:187], v[116:119]
    v_mfma_f32_16x16x32_bf16 v[120:123], v[152:155], v[184:187], v[120:123]
    v_mfma_f32_16x16x32_bf16 v[124:127], v[156:159], v[184:187], v[124:127]
    v_mfma_f32_16x16x32_bf16 v[140:143], v[156:159], v[188:191], v[140:143]
    v_mfma_f32_16x16x32_bf16 v[136:139], v[152:155], v[188:191], v[136:139]
    v_mfma_f32_16x16x32_bf16 v[132:135], v[148:151], v[188:191], v[132:135]
    v_mfma_f32_16x16x32_bf16 v[128:131], v[144:147], v[188:191], v[128:131]
    s_waitcnt lgkmcnt(0)
    v_mfma_f32_16x16x32_bf16 v[16:19], v[208:211], v[160:163], v[16:19]
    v_mfma_f32_16x16x32_bf16 v[20:23], v[212:215], v[160:163], v[20:23]
    v_mfma_f32_16x16x32_bf16 v[24:27], v[216:219], v[160:163], v[24:27]
    v_mfma_f32_16x16x32_bf16 v[28:31], v[220:223], v[160:163], v[28:31]
    v_mfma_f32_16x16x32_bf16 v[44:47], v[220:223], v[164:167], v[44:47]
    ds_read_b128 v[176:179], v8 offset:8192
    v_mfma_f32_16x16x32_bf16 v[40:43], v[216:219], v[164:167], v[40:43]
    ds_read_b128 v[180:183], v8 offset:10240
    v_mfma_f32_16x16x32_bf16 v[36:39], v[212:215], v[164:167], v[36:39]
    ds_read_b128 v[184:187], v8 offset:12288
    v_mfma_f32_16x16x32_bf16 v[32:35], v[208:211], v[164:167], v[32:35]
    ds_read_b128 v[188:191], v8 offset:14336
    v_mfma_f32_16x16x32_bf16 v[48:51], v[208:211], v[168:171], v[48:51]
    v_mfma_f32_16x16x32_bf16 v[52:55], v[212:215], v[168:171], v[52:55]
    v_mfma_f32_16x16x32_bf16 v[56:59], v[216:219], v[168:171], v[56:59]
    v_mfma_f32_16x16x32_bf16 v[60:63], v[220:223], v[168:171], v[60:63]
    v_mfma_f32_16x16x32_bf16 v[76:79], v[220:223], v[172:175], v[76:79]
    v_mfma_f32_16x16x32_bf16 v[72:75], v[216:219], v[172:175], v[72:75]
    v_mfma_f32_16x16x32_bf16 v[68:71], v[212:215], v[172:175], v[68:71]
    v_mfma_f32_16x16x32_bf16 v[64:67], v[208:211], v[172:175], v[64:67]
    s_waitcnt lgkmcnt(0)
    s_barrier
    v_mfma_f32_16x16x32_bf16 v[80:83], v[208:211], v[176:179], v[80:83]
    ds_read_b64_tr_b16 v[144:145], v6 offset:49152
    ds_read_b64_tr_b16 v[146:147], v6 offset:49408
    v_mfma_f32_16x16x32_bf16 v[84:87], v[212:215], v[176:179], v[84:87]
    ds_read_b128 v[160:163], v9 offset:0
    ds_read_b64_tr_b16 v[148:149], v7 offset:49152
    v_mfma_f32_16x16x32_bf16 v[88:91], v[216:219], v[176:179], v[88:91]
    ds_read_b64_tr_b16 v[150:151], v7 offset:49408
    ds_read_b64_tr_b16 v[152:153], v6 offset:50176
    v_mfma_f32_16x16x32_bf16 v[92:95], v[220:223], v[176:179], v[92:95]
    ds_read_b64_tr_b16 v[154:155], v6 offset:50432
    ds_read_b64_tr_b16 v[156:157], v7 offset:50176
    v_mfma_f32_16x16x32_bf16 v[108:111], v[220:223], v[180:183], v[108:111]
    ds_read_b64_tr_b16 v[158:159], v7 offset:50432
    ds_read_b128 v[164:167], v9 offset:2048
    v_mfma_f32_16x16x32_bf16 v[104:107], v[216:219], v[180:183], v[104:107]
    ds_read_b128 v[168:171], v9 offset:4096
    ds_read_b128 v[172:175], v9 offset:6144
    v_mfma_f32_16x16x32_bf16 v[100:103], v[212:215], v[180:183], v[100:103]
    v_mfma_f32_16x16x32_bf16 v[96:99], v[208:211], v[180:183], v[96:99]
    v_mfma_f32_16x16x32_bf16 v[112:115], v[208:211], v[184:187], v[112:115]
    v_mfma_f32_16x16x32_bf16 v[116:119], v[212:215], v[184:187], v[116:119]
    v_mfma_f32_16x16x32_bf16 v[120:123], v[216:219], v[184:187], v[120:123]
    v_mfma_f32_16x16x32_bf16 v[124:127], v[220:223], v[184:187], v[124:127]
    v_mfma_f32_16x16x32_bf16 v[140:143], v[220:223], v[188:191], v[140:143]
    v_mfma_f32_16x16x32_bf16 v[136:139], v[216:219], v[188:191], v[136:139]
    v_mfma_f32_16x16x32_bf16 v[132:135], v[212:215], v[188:191], v[132:135]
    v_mfma_f32_16x16x32_bf16 v[128:131], v[208:211], v[188:191], v[128:131]
    s_waitcnt lgkmcnt(0)
    v_mfma_f32_16x16x32_bf16 v[16:19], v[144:147], v[160:163], v[16:19]
    v_mfma_f32_16x16x32_bf16 v[20:23], v[148:151], v[160:163], v[20:23]
    v_mfma_f32_16x16x32_bf16 v[24:27], v[152:155], v[160:163], v[24:27]
    v_mfma_f32_16x16x32_bf16 v[28:31], v[156:159], v[160:163], v[28:31]
    v_mfma_f32_16x16x32_bf16 v[44:47], v[156:159], v[164:167], v[44:47]
    ds_read_b128 v[176:179], v9 offset:8192
    v_mfma_f32_16x16x32_bf16 v[40:43], v[152:155], v[164:167], v[40:43]
    ds_read_b128 v[180:183], v9 offset:10240
    v_mfma_f32_16x16x32_bf16 v[36:39], v[148:151], v[164:167], v[36:39]
    ds_read_b128 v[184:187], v9 offset:12288
    v_mfma_f32_16x16x32_bf16 v[32:35], v[144:147], v[164:167], v[32:35]
    ds_read_b128 v[188:191], v9 offset:14336
    v_mfma_f32_16x16x32_bf16 v[48:51], v[144:147], v[168:171], v[48:51]
    v_mfma_f32_16x16x32_bf16 v[52:55], v[148:151], v[168:171], v[52:55]
    v_mfma_f32_16x16x32_bf16 v[56:59], v[152:155], v[168:171], v[56:59]
    v_mfma_f32_16x16x32_bf16 v[60:63], v[156:159], v[168:171], v[60:63]
    v_mfma_f32_16x16x32_bf16 v[76:79], v[156:159], v[172:175], v[76:79]
    v_mfma_f32_16x16x32_bf16 v[72:75], v[152:155], v[172:175], v[72:75]
    v_mfma_f32_16x16x32_bf16 v[68:71], v[148:151], v[172:175], v[68:71]
    v_mfma_f32_16x16x32_bf16 v[64:67], v[144:147], v[172:175], v[64:67]
    s_waitcnt lgkmcnt(0)
    s_barrier
    v_mfma_f32_16x16x32_bf16 v[80:83], v[144:147], v[176:179], v[80:83]
    ds_read_b64_tr_b16 v[208:209], v6 offset:0
    ds_read_b64_tr_b16 v[210:211], v6 offset:256
    v_mfma_f32_16x16x32_bf16 v[84:87], v[148:151], v[176:179], v[84:87]
    ds_read_b128 v[160:163], v8 offset:16384
    ds_read_b64_tr_b16 v[212:213], v7 offset:0
    v_mfma_f32_16x16x32_bf16 v[88:91], v[152:155], v[176:179], v[88:91]
    ds_read_b64_tr_b16 v[214:215], v7 offset:256
    ds_read_b64_tr_b16 v[216:217], v6 offset:1024
    v_mfma_f32_16x16x32_bf16 v[92:95], v[156:159], v[176:179], v[92:95]
    ds_read_b64_tr_b16 v[218:219], v6 offset:1280
    ds_read_b64_tr_b16 v[220:221], v7 offset:1024
    v_mfma_f32_16x16x32_bf16 v[108:111], v[156:159], v[180:183], v[108:111]
    ds_read_b64_tr_b16 v[222:223], v7 offset:1280
    ds_read_b128 v[164:167], v8 offset:18432
    v_mfma_f32_16x16x32_bf16 v[104:107], v[152:155], v[180:183], v[104:107]
    ds_read_b128 v[168:171], v8 offset:20480
    ds_read_b128 v[172:175], v8 offset:22528
    v_mfma_f32_16x16x32_bf16 v[100:103], v[148:151], v[180:183], v[100:103]
    v_mfma_f32_16x16x32_bf16 v[96:99], v[144:147], v[180:183], v[96:99]
    v_mfma_f32_16x16x32_bf16 v[112:115], v[144:147], v[184:187], v[112:115]
    v_mfma_f32_16x16x32_bf16 v[116:119], v[148:151], v[184:187], v[116:119]
    v_mfma_f32_16x16x32_bf16 v[120:123], v[152:155], v[184:187], v[120:123]
    v_mfma_f32_16x16x32_bf16 v[124:127], v[156:159], v[184:187], v[124:127]
    v_mfma_f32_16x16x32_bf16 v[140:143], v[156:159], v[188:191], v[140:143]
    v_mfma_f32_16x16x32_bf16 v[136:139], v[152:155], v[188:191], v[136:139]
    v_mfma_f32_16x16x32_bf16 v[132:135], v[148:151], v[188:191], v[132:135]
    v_mfma_f32_16x16x32_bf16 v[128:131], v[144:147], v[188:191], v[128:131]
    s_waitcnt lgkmcnt(0)
    v_mfma_f32_16x16x32_bf16 v[16:19], v[208:211], v[160:163], v[16:19]
    v_mfma_f32_16x16x32_bf16 v[20:23], v[212:215], v[160:163], v[20:23]
    v_mfma_f32_16x16x32_bf16 v[24:27], v[216:219], v[160:163], v[24:27]
    v_mfma_f32_16x16x32_bf16 v[28:31], v[220:223], v[160:163], v[28:31]
    v_mfma_f32_16x16x32_bf16 v[44:47], v[220:223], v[164:167], v[44:47]
    ds_read_b128 v[176:179], v8 offset:24576
    v_mfma_f32_16x16x32_bf16 v[40:43], v[216:219], v[164:167], v[40:43]
    ds_read_b128 v[180:183], v8 offset:26624
    v_mfma_f32_16x16x32_bf16 v[36:39], v[212:215], v[164:167], v[36:39]
    ds_read_b128 v[184:187], v8 offset:28672
    v_mfma_f32_16x16x32_bf16 v[32:35], v[208:211], v[164:167], v[32:35]
    ds_read_b128 v[188:191], v8 offset:30720
    v_mfma_f32_16x16x32_bf16 v[48:51], v[208:211], v[168:171], v[48:51]
    v_mfma_f32_16x16x32_bf16 v[52:55], v[212:215], v[168:171], v[52:55]
    v_mfma_f32_16x16x32_bf16 v[56:59], v[216:219], v[168:171], v[56:59]
    v_mfma_f32_16x16x32_bf16 v[60:63], v[220:223], v[168:171], v[60:63]
    v_mfma_f32_16x16x32_bf16 v[76:79], v[220:223], v[172:175], v[76:79]
    v_mfma_f32_16x16x32_bf16 v[72:75], v[216:219], v[172:175], v[72:75]
    v_mfma_f32_16x16x32_bf16 v[68:71], v[212:215], v[172:175], v[68:71]
    v_mfma_f32_16x16x32_bf16 v[64:67], v[208:211], v[172:175], v[64:67]
    s_waitcnt lgkmcnt(0)
    s_barrier
    v_mfma_f32_16x16x32_bf16 v[80:83], v[208:211], v[176:179], v[80:83]
    ds_read_b64_tr_b16 v[144:145], v6 offset:16384
    ds_read_b64_tr_b16 v[146:147], v6 offset:16640
    v_mfma_f32_16x16x32_bf16 v[84:87], v[212:215], v[176:179], v[84:87]
    ds_read_b128 v[160:163], v9 offset:16384
    ds_read_b64_tr_b16 v[148:149], v7 offset:16384
    v_mfma_f32_16x16x32_bf16 v[88:91], v[216:219], v[176:179], v[88:91]
    ds_read_b64_tr_b16 v[150:151], v7 offset:16640
    ds_read_b64_tr_b16 v[152:153], v6 offset:17408
    v_mfma_f32_16x16x32_bf16 v[92:95], v[220:223], v[176:179], v[92:95]
    ds_read_b64_tr_b16 v[154:155], v6 offset:17664
    ds_read_b64_tr_b16 v[156:157], v7 offset:17408
    v_mfma_f32_16x16x32_bf16 v[108:111], v[220:223], v[180:183], v[108:111]
    ds_read_b64_tr_b16 v[158:159], v7 offset:17664
    ds_read_b128 v[164:167], v9 offset:18432
    v_mfma_f32_16x16x32_bf16 v[104:107], v[216:219], v[180:183], v[104:107]
    ds_read_b128 v[168:171], v9 offset:20480
    ds_read_b128 v[172:175], v9 offset:22528
    v_mfma_f32_16x16x32_bf16 v[100:103], v[212:215], v[180:183], v[100:103]
    v_mfma_f32_16x16x32_bf16 v[96:99], v[208:211], v[180:183], v[96:99]
    v_mfma_f32_16x16x32_bf16 v[112:115], v[208:211], v[184:187], v[112:115]
    v_mfma_f32_16x16x32_bf16 v[116:119], v[212:215], v[184:187], v[116:119]
    v_mfma_f32_16x16x32_bf16 v[120:123], v[216:219], v[184:187], v[120:123]
    v_mfma_f32_16x16x32_bf16 v[124:127], v[220:223], v[184:187], v[124:127]
    v_mfma_f32_16x16x32_bf16 v[140:143], v[220:223], v[188:191], v[140:143]
    v_mfma_f32_16x16x32_bf16 v[136:139], v[216:219], v[188:191], v[136:139]
    v_mfma_f32_16x16x32_bf16 v[132:135], v[212:215], v[188:191], v[132:135]
    v_mfma_f32_16x16x32_bf16 v[128:131], v[208:211], v[188:191], v[128:131]
    s_waitcnt lgkmcnt(0)
    v_mfma_f32_16x16x32_bf16 v[16:19], v[144:147], v[160:163], v[16:19]
    v_mfma_f32_16x16x32_bf16 v[20:23], v[148:151], v[160:163], v[20:23]
    v_mfma_f32_16x16x32_bf16 v[24:27], v[152:155], v[160:163], v[24:27]
    v_mfma_f32_16x16x32_bf16 v[28:31], v[156:159], v[160:163], v[28:31]
    v_mfma_f32_16x16x32_bf16 v[44:47], v[156:159], v[164:167], v[44:47]
    ds_read_b128 v[176:179], v9 offset:24576
    v_mfma_f32_16x16x32_bf16 v[40:43], v[152:155], v[164:167], v[40:43]
    ds_read_b128 v[180:183], v9 offset:26624
    v_mfma_f32_16x16x32_bf16 v[36:39], v[148:151], v[164:167], v[36:39]
    ds_read_b128 v[184:187], v9 offset:28672
    v_mfma_f32_16x16x32_bf16 v[32:35], v[144:147], v[164:167], v[32:35]
    ds_read_b128 v[188:191], v9 offset:30720
    v_mfma_f32_16x16x32_bf16 v[48:51], v[144:147], v[168:171], v[48:51]
    v_mfma_f32_16x16x32_bf16 v[52:55], v[148:151], v[168:171], v[52:55]
    v_mfma_f32_16x16x32_bf16 v[56:59], v[152:155], v[168:171], v[56:59]
    v_mfma_f32_16x16x32_bf16 v[60:63], v[156:159], v[168:171], v[60:63]
    v_mfma_f32_16x16x32_bf16 v[76:79], v[156:159], v[172:175], v[76:79]
    v_mfma_f32_16x16x32_bf16 v[72:75], v[152:155], v[172:175], v[72:75]
    v_mfma_f32_16x16x32_bf16 v[68:71], v[148:151], v[172:175], v[68:71]
    v_mfma_f32_16x16x32_bf16 v[64:67], v[144:147], v[172:175], v[64:67]
    s_waitcnt lgkmcnt(0)
    s_barrier
    v_mfma_f32_16x16x32_bf16 v[80:83], v[144:147], v[176:179], v[80:83]
    ds_read_b64_tr_b16 v[208:209], v6 offset:32768
    ds_read_b64_tr_b16 v[210:211], v6 offset:33024
    v_mfma_f32_16x16x32_bf16 v[84:87], v[148:151], v[176:179], v[84:87]
    ds_read_b128 v[160:163], v8 offset:32768
    ds_read_b64_tr_b16 v[212:213], v7 offset:32768
    v_mfma_f32_16x16x32_bf16 v[88:91], v[152:155], v[176:179], v[88:91]
    ds_read_b64_tr_b16 v[214:215], v7 offset:33024
    ds_read_b64_tr_b16 v[216:217], v6 offset:33792
    v_mfma_f32_16x16x32_bf16 v[92:95], v[156:159], v[176:179], v[92:95]
    ds_read_b64_tr_b16 v[218:219], v6 offset:34048
    ds_read_b64_tr_b16 v[220:221], v7 offset:33792
    v_mfma_f32_16x16x32_bf16 v[108:111], v[156:159], v[180:183], v[108:111]
    ds_read_b64_tr_b16 v[222:223], v7 offset:34048
    ds_read_b128 v[164:167], v8 offset:34816
    v_mfma_f32_16x16x32_bf16 v[104:107], v[152:155], v[180:183], v[104:107]
    ds_read_b128 v[168:171], v8 offset:36864
    ds_read_b128 v[172:175], v8 offset:38912
    v_mfma_f32_16x16x32_bf16 v[100:103], v[148:151], v[180:183], v[100:103]
    v_mfma_f32_16x16x32_bf16 v[96:99], v[144:147], v[180:183], v[96:99]
    v_mfma_f32_16x16x32_bf16 v[112:115], v[144:147], v[184:187], v[112:115]
    v_mfma_f32_16x16x32_bf16 v[116:119], v[148:151], v[184:187], v[116:119]
    v_mfma_f32_16x16x32_bf16 v[120:123], v[152:155], v[184:187], v[120:123]
    v_mfma_f32_16x16x32_bf16 v[124:127], v[156:159], v[184:187], v[124:127]
    v_mfma_f32_16x16x32_bf16 v[140:143], v[156:159], v[188:191], v[140:143]
    v_mfma_f32_16x16x32_bf16 v[136:139], v[152:155], v[188:191], v[136:139]
    s_cmp_lg_u32 s3, 0
    s_cbranch_scc1 pst_1
    buffer_load_dword v250, v14, s[16:19], 0 offen sc1
    pst_1:
    v_mfma_f32_16x16x32_bf16 v[132:135], v[148:151], v[188:191], v[132:135]
    v_mfma_f32_16x16x32_bf16 v[128:131], v[144:147], v[188:191], v[128:131]
    s_waitcnt lgkmcnt(0)
    v_mfma_f32_16x16x32_bf16 v[16:19], v[208:211], v[160:163], v[16:19]
    v_mfma_f32_16x16x32_bf16 v[20:23], v[212:215], v[160:163], v[20:23]
    v_mfma_f32_16x16x32_bf16 v[24:27], v[216:219], v[160:163], v[24:27]
    v_mfma_f32_16x16x32_bf16 v[28:31], v[220:223], v[160:163], v[28:31]
    v_mfma_f32_16x16x32_bf16 v[44:47], v[220:223], v[164:167], v[44:47]
    ds_read_b128 v[176:179], v8 offset:40960
    v_mfma_f32_16x16x32_bf16 v[40:43], v[216:219], v[164:167], v[40:43]
    ds_read_b128 v[180:183], v8 offset:43008
    v_mfma_f32_16x16x32_bf16 v[36:39], v[212:215], v[164:167], v[36:39]
    ds_read_b128 v[184:187], v8 offset:45056
    v_mfma_f32_16x16x32_bf16 v[32:35], v[208:211], v[164:167], v[32:35]
    ds_read_b128 v[188:191], v8 offset:47104
    v_mfma_f32_16x16x32_bf16 v[48:51], v[208:211], v[168:171], v[48:51]
    v_mfma_f32_16x16x32_bf16 v[52:55], v[212:215], v[168:171], v[52:55]
    v_mfma_f32_16x16x32_bf16 v[56:59], v[216:219], v[168:171], v[56:59]
    v_mfma_f32_16x16x32_bf16 v[60:63], v[220:223], v[168:171], v[60:63]
    v_mfma_f32_16x16x32_bf16 v[76:79], v[220:223], v[172:175], v[76:79]
    v_mfma_f32_16x16x32_bf16 v[72:75], v[216:219], v[172:175], v[72:75]
    v_mfma_f32_16x16x32_bf16 v[68:71], v[212:215], v[172:175], v[68:71]
    v_mfma_f32_16x16x32_bf16 v[64:67], v[208:211], v[172:175], v[64:67]
    s_waitcnt lgkmcnt(0)
    s_barrier
    v_mfma_f32_16x16x32_bf16 v[80:83], v[208:211], v[176:179], v[80:83]
    ds_read_b64_tr_b16 v[144:145], v6 offset:49152
    ds_read_b64_tr_b16 v[146:147], v6 offset:49408
    v_mfma_f32_16x16x32_bf16 v[84:87], v[212:215], v[176:179], v[84:87]
    ds_read_b128 v[160:163], v9 offset:32768
    ds_read_b64_tr_b16 v[148:149], v7 offset:49152
    v_mfma_f32_16x16x32_bf16 v[88:91], v[216:219], v[176:179], v[88:91]
    ds_read_b64_tr_b16 v[150:151], v7 offset:49408
    ds_read_b64_tr_b16 v[152:153], v6 offset:50176
    v_mfma_f32_16x16x32_bf16 v[92:95], v[220:223], v[176:179], v[92:95]
    ds_read_b64_tr_b16 v[154:155], v6 offset:50432
    ds_read_b64_tr_b16 v[156:157], v7 offset:50176
    v_mfma_f32_16x16x32_bf16 v[108:111], v[220:223], v[180:183], v[108:111]
    ds_read_b64_tr_b16 v[158:159], v7 offset:50432
    ds_read_b128 v[164:167], v9 offset:34816
    v_mfma_f32_16x16x32_bf16 v[104:107], v[216:219], v[180:183], v[104:107]
    ds_read_b128 v[168:171], v9 offset:36864
    ds_read_b128 v[172:175], v9 offset:38912
    v_mfma_f32_16x16x32_bf16 v[100:103], v[212:215], v[180:183], v[100:103]
    v_mfma_f32_16x16x32_bf16 v[96:99], v[208:211], v[180:183], v[96:99]
    v_mfma_f32_16x16x32_bf16 v[112:115], v[208:211], v[184:187], v[112:115]
    v_mfma_f32_16x16x32_bf16 v[116:119], v[212:215], v[184:187], v[116:119]
    v_mfma_f32_16x16x32_bf16 v[120:123], v[216:219], v[184:187], v[120:123]
    v_mfma_f32_16x16x32_bf16 v[124:127], v[220:223], v[184:187], v[124:127]
    v_mfma_f32_16x16x32_bf16 v[140:143], v[220:223], v[188:191], v[140:143]
    v_mfma_f32_16x16x32_bf16 v[136:139], v[216:219], v[188:191], v[136:139]
    v_mfma_f32_16x16x32_bf16 v[132:135], v[212:215], v[188:191], v[132:135]
    v_mfma_f32_16x16x32_bf16 v[128:131], v[208:211], v[188:191], v[128:131]
    s_waitcnt lgkmcnt(0)
    v_mfma_f32_16x16x32_bf16 v[16:19], v[144:147], v[160:163], v[16:19]
    v_mfma_f32_16x16x32_bf16 v[20:23], v[148:151], v[160:163], v[20:23]
    v_mfma_f32_16x16x32_bf16 v[24:27], v[152:155], v[160:163], v[24:27]
    v_mfma_f32_16x16x32_bf16 v[28:31], v[156:159], v[160:163], v[28:31]
    v_mfma_f32_16x16x32_bf16 v[44:47], v[156:159], v[164:167], v[44:47]
    ds_read_b128 v[176:179], v9 offset:40960
    v_mfma_f32_16x16x32_bf16 v[40:43], v[152:155], v[164:167], v[40:43]
    ds_read_b128 v[180:183], v9 offset:43008
    v_mfma_f32_16x16x32_bf16 v[36:39], v[148:151], v[164:167], v[36:39]
    ds_read_b128 v[184:187], v9 offset:45056
    v_mfma_f32_16x16x32_bf16 v[32:35], v[144:147], v[164:167], v[32:35]
    ds_read_b128 v[188:191], v9 offset:47104
    v_mfma_f32_16x16x32_bf16 v[48:51], v[144:147], v[168:171], v[48:51]
    v_mfma_f32_16x16x32_bf16 v[52:55], v[148:151], v[168:171], v[52:55]
    v_mfma_f32_16x16x32_bf16 v[56:59], v[152:155], v[168:171], v[56:59]
    v_mfma_f32_16x16x32_bf16 v[60:63], v[156:159], v[168:171], v[60:63]
    v_mfma_f32_16x16x32_bf16 v[76:79], v[156:159], v[172:175], v[76:79]
    v_mfma_f32_16x16x32_bf16 v[72:75], v[152:155], v[172:175], v[72:75]
    v_mfma_f32_16x16x32_bf16 v[68:71], v[148:151], v[172:175], v[68:71]
    v_mfma_f32_16x16x32_bf16 v[64:67], v[144:147], v[172:175], v[64:67]
    s_waitcnt lgkmcnt(0)
    s_cmp_lg_u32 s3, 0
    s_cbranch_scc1 gate_2
    s_waitcnt vmcnt(0)
    v_cmp_eq_u32 vcc, 1, v250
    s_and_b32 s36, vcc_lo, s48
    s_cmp_eq_u32 s36, s48
    s_cbranch_scc1 gate_2
    s_mov_b32 s50, 0
gspin_3:
    buffer_load_dword v250, v14, s[16:19], 0 offen sc1
    s_waitcnt vmcnt(0)
    v_cmp_eq_u32 vcc, 1, v250
    s_and_b32 s36, vcc_lo, s48
    s_cmp_eq_u32 s36, s48
    s_cbranch_scc1 gspin_3_ok
    s_add_u32 s50, s50, 1
    s_cmp_ge_u32 s50, 200000
    s_cbranch_scc1 gspin_3_ok
    s_sleep 16
    s_branch gspin_3
gspin_3_ok:
gate_2:
    s_barrier
    v_mfma_f32_16x16x32_bf16 v[80:83], v[144:147], v[176:179], v[80:83]
    ds_read_b64_tr_b16 v[208:209], v6 offset:0
    ds_read_b64_tr_b16 v[210:211], v6 offset:256
    v_mfma_f32_16x16x32_bf16 v[84:87], v[148:151], v[176:179], v[84:87]
    ds_read_b128 v[160:163], v8 offset:0
    ds_read_b64_tr_b16 v[212:213], v7 offset:0
    v_mfma_f32_16x16x32_bf16 v[88:91], v[152:155], v[176:179], v[88:91]
    ds_read_b64_tr_b16 v[214:215], v7 offset:256
    ds_read_b64_tr_b16 v[216:217], v6 offset:1024
    v_mfma_f32_16x16x32_bf16 v[92:95], v[156:159], v[176:179], v[92:95]
    ds_read_b64_tr_b16 v[218:219], v6 offset:1280
    ds_read_b64_tr_b16 v[220:221], v7 offset:1024
    v_mfma_f32_16x16x32_bf16 v[108:111], v[156:159], v[180:183], v[108:111]
    ds_read_b64_tr_b16 v[222:223], v7 offset:1280
    ds_read_b128 v[164:167], v8 offset:2048
    v_mfma_f32_16x16x32_bf16 v[104:107], v[152:155], v[180:183], v[104:107]
    ds_read_b128 v[168:171], v8 offset:4096
    ds_read_b128 v[172:175], v8 offset:6144
    v_mfma_f32_16x16x32_bf16 v[100:103], v[148:151], v[180:183], v[100:103]
    v_mfma_f32_16x16x32_bf16 v[96:99], v[144:147], v[180:183], v[96:99]
    v_mfma_f32_16x16x32_bf16 v[112:115], v[144:147], v[184:187], v[112:115]
    v_mfma_f32_16x16x32_bf16 v[116:119], v[148:151], v[184:187], v[116:119]
    v_mfma_f32_16x16x32_bf16 v[120:123], v[152:155], v[184:187], v[120:123]
    v_mfma_f32_16x16x32_bf16 v[124:127], v[156:159], v[184:187], v[124:127]
    v_mfma_f32_16x16x32_bf16 v[140:143], v[156:159], v[188:191], v[140:143]
    v_mfma_f32_16x16x32_bf16 v[136:139], v[152:155], v[188:191], v[136:139]
    v_mfma_f32_16x16x32_bf16 v[132:135], v[148:151], v[188:191], v[132:135]
    v_mfma_f32_16x16x32_bf16 v[128:131], v[144:147], v[188:191], v[128:131]
    s_waitcnt lgkmcnt(0)
    v_mfma_f32_16x16x32_bf16 v[16:19], v[208:211], v[160:163], v[16:19]
    v_mfma_f32_16x16x32_bf16 v[20:23], v[212:215], v[160:163], v[20:23]
    v_mfma_f32_16x16x32_bf16 v[24:27], v[216:219], v[160:163], v[24:27]
    v_mfma_f32_16x16x32_bf16 v[28:31], v[220:223], v[160:163], v[28:31]
    v_mfma_f32_16x16x32_bf16 v[44:47], v[220:223], v[164:167], v[44:47]
    ds_read_b128 v[176:179], v8 offset:8192
    v_mfma_f32_16x16x32_bf16 v[40:43], v[216:219], v[164:167], v[40:43]
    ds_read_b128 v[180:183], v8 offset:10240
    v_mfma_f32_16x16x32_bf16 v[36:39], v[212:215], v[164:167], v[36:39]
    ds_read_b128 v[184:187], v8 offset:12288
    v_mfma_f32_16x16x32_bf16 v[32:35], v[208:211], v[164:167], v[32:35]
    ds_read_b128 v[188:191], v8 offset:14336
    v_mfma_f32_16x16x32_bf16 v[48:51], v[208:211], v[168:171], v[48:51]
    v_mfma_f32_16x16x32_bf16 v[52:55], v[212:215], v[168:171], v[52:55]
    v_mfma_f32_16x16x32_bf16 v[56:59], v[216:219], v[168:171], v[56:59]
    v_mfma_f32_16x16x32_bf16 v[60:63], v[220:223], v[168:171], v[60:63]
    v_mfma_f32_16x16x32_bf16 v[76:79], v[220:223], v[172:175], v[76:79]
    v_mfma_f32_16x16x32_bf16 v[72:75], v[216:219], v[172:175], v[72:75]
    v_mfma_f32_16x16x32_bf16 v[68:71], v[212:215], v[172:175], v[68:71]
    v_mfma_f32_16x16x32_bf16 v[64:67], v[208:211], v[172:175], v[64:67]
    s_waitcnt lgkmcnt(0)
    s_barrier
    v_mfma_f32_16x16x32_bf16 v[80:83], v[208:211], v[176:179], v[80:83]
    ds_read_b64_tr_b16 v[144:145], v6 offset:16384
    ds_read_b64_tr_b16 v[146:147], v6 offset:16640
    v_mfma_f32_16x16x32_bf16 v[84:87], v[212:215], v[176:179], v[84:87]
    ds_read_b128 v[160:163], v9 offset:0
    ds_read_b64_tr_b16 v[148:149], v7 offset:16384
    v_mfma_f32_16x16x32_bf16 v[88:91], v[216:219], v[176:179], v[88:91]
    ds_read_b64_tr_b16 v[150:151], v7 offset:16640
    ds_read_b64_tr_b16 v[152:153], v6 offset:17408
    v_mfma_f32_16x16x32_bf16 v[92:95], v[220:223], v[176:179], v[92:95]
    ds_read_b64_tr_b16 v[154:155], v6 offset:17664
    ds_read_b64_tr_b16 v[156:157], v7 offset:17408
    v_mfma_f32_16x16x32_bf16 v[108:111], v[220:223], v[180:183], v[108:111]
    ds_read_b64_tr_b16 v[158:159], v7 offset:17664
    ds_read_b128 v[164:167], v9 offset:2048
    v_mfma_f32_16x16x32_bf16 v[104:107], v[216:219], v[180:183], v[104:107]
    ds_read_b128 v[168:171], v9 offset:4096
    ds_read_b128 v[172:175], v9 offset:6144
    v_mfma_f32_16x16x32_bf16 v[100:103], v[212:215], v[180:183], v[100:103]
    v_mfma_f32_16x16x32_bf16 v[96:99], v[208:211], v[180:183], v[96:99]
    v_mfma_f32_16x16x32_bf16 v[112:115], v[208:211], v[184:187], v[112:115]
    v_mfma_f32_16x16x32_bf16 v[116:119], v[212:215], v[184:187], v[116:119]
    v_mfma_f32_16x16x32_bf16 v[120:123], v[216:219], v[184:187], v[120:123]
    v_mfma_f32_16x16x32_bf16 v[124:127], v[220:223], v[184:187], v[124:127]
    v_mfma_f32_16x16x32_bf16 v[140:143], v[220:223], v[188:191], v[140:143]
    v_mfma_f32_16x16x32_bf16 v[136:139], v[216:219], v[188:191], v[136:139]
    v_mfma_f32_16x16x32_bf16 v[132:135], v[212:215], v[188:191], v[132:135]
    v_mfma_f32_16x16x32_bf16 v[128:131], v[208:211], v[188:191], v[128:131]
    s_waitcnt lgkmcnt(0)
    v_mfma_f32_16x16x32_bf16 v[16:19], v[144:147], v[160:163], v[16:19]
    v_mfma_f32_16x16x32_bf16 v[20:23], v[148:151], v[160:163], v[20:23]
    v_mfma_f32_16x16x32_bf16 v[24:27], v[152:155], v[160:163], v[24:27]
    v_mfma_f32_16x16x32_bf16 v[28:31], v[156:159], v[160:163], v[28:31]
    v_mfma_f32_16x16x32_bf16 v[44:47], v[156:159], v[164:167], v[44:47]
    ds_read_b128 v[176:179], v9 offset:8192
    v_mfma_f32_16x16x32_bf16 v[40:43], v[152:155], v[164:167], v[40:43]
    ds_read_b128 v[180:183], v9 offset:10240
    v_mfma_f32_16x16x32_bf16 v[36:39], v[148:151], v[164:167], v[36:39]
    ds_read_b128 v[184:187], v9 offset:12288
    v_mfma_f32_16x16x32_bf16 v[32:35], v[144:147], v[164:167], v[32:35]
    ds_read_b128 v[188:191], v9 offset:14336
    v_mfma_f32_16x16x32_bf16 v[48:51], v[144:147], v[168:171], v[48:51]
    v_mfma_f32_16x16x32_bf16 v[52:55], v[148:151], v[168:171], v[52:55]
    v_mfma_f32_16x16x32_bf16 v[56:59], v[152:155], v[168:171], v[56:59]
    v_mfma_f32_16x16x32_bf16 v[60:63], v[156:159], v[168:171], v[60:63]
    v_mfma_f32_16x16x32_bf16 v[76:79], v[156:159], v[172:175], v[76:79]
    v_mfma_f32_16x16x32_bf16 v[72:75], v[152:155], v[172:175], v[72:75]
    v_mfma_f32_16x16x32_bf16 v[68:71], v[148:151], v[172:175], v[68:71]
    v_mfma_f32_16x16x32_bf16 v[64:67], v[144:147], v[172:175], v[64:67]
    s_waitcnt lgkmcnt(0)
    v_mfma_f32_16x16x32_bf16 v[80:83], v[144:147], v[176:179], v[80:83]
    v_mfma_f32_16x16x32_bf16 v[84:87], v[148:151], v[176:179], v[84:87]
    v_mfma_f32_16x16x32_bf16 v[88:91], v[152:155], v[176:179], v[88:91]
    v_mfma_f32_16x16x32_bf16 v[92:95], v[156:159], v[176:179], v[92:95]
    v_mfma_f32_16x16x32_bf16 v[108:111], v[156:159], v[180:183], v[108:111]
    v_mfma_f32_16x16x32_bf16 v[104:107], v[152:155], v[180:183], v[104:107]
    v_mfma_f32_16x16x32_bf16 v[100:103], v[148:151], v[180:183], v[100:103]
    v_mfma_f32_16x16x32_bf16 v[96:99], v[144:147], v[180:183], v[96:99]
    s_barrier
    ds_read_b128 v[208:211], v12 offset:0
    ds_read_b128 v[212:215], v12 offset:64
    ds_read_b128 v[216:219], v12 offset:512
    ds_read_b128 v[220:223], v12 offset:576
    ds_read_b128 v[224:227], v13 offset:0
    ds_read_b128 v[228:231], v13 offset:16
    ds_read_b128 v[232:235], v13 offset:512
    ds_read_b128 v[236:239], v13 offset:528
    ds_read_b128 v[160:163], v13 offset:1024
    ds_read_b128 v[164:167], v13 offset:1040
    ds_read_b128 v[168:171], v13 offset:1536
    ds_read_b128 v[172:175], v13 offset:1552
    v_mfma_f32_16x16x32_bf16 v[112:115], v[144:147], v[184:187], v[112:115]
    v_mfma_f32_16x16x32_bf16 v[116:119], v[148:151], v[184:187], v[116:119]
    v_mfma_f32_16x16x32_bf16 v[120:123], v[152:155], v[184:187], v[120:123]
    v_mfma_f32_16x16x32_bf16 v[124:127], v[156:159], v[184:187], v[124:127]
    v_mfma_f32_16x16x32_bf16 v[140:143], v[156:159], v[188:191], v[140:143]
    v_mfma_f32_16x16x32_bf16 v[136:139], v[152:155], v[188:191], v[136:139]
    v_mfma_f32_16x16x32_bf16 v[132:135], v[148:151], v[188:191], v[132:135]
    v_mfma_f32_16x16x32_bf16 v[128:131], v[144:147], v[188:191], v[128:131]
    s_setprio 1
    s_waitcnt lgkmcnt(4)
    v_pk_add_f32 v[192:193], v[192:193], v[208:209]
    v_pk_add_f32 v[194:195], v[194:195], v[210:211]
    v_pk_add_f32 v[196:197], v[196:197], v[212:213]
    v_pk_add_f32 v[198:199], v[198:199], v[214:215]
    v_pk_add_f32 v[200:201], v[200:201], v[216:217]
    v_pk_add_f32 v[202:203], v[202:203], v[218:219]
    v_pk_add_f32 v[204:205], v[204:205], v[220:221]
    v_pk_add_f32 v[206:207], v[206:207], v[222:223]
    v_pk_fma_f32 v[16:17], v[192:193], v[224:225], v[16:17] op_sel:[0,0,0] op_sel_hi:[1,0,1] neg_lo:[1,0,0] neg_hi:[1,0,0]
    v_pk_fma_f32 v[18:19], v[194:195], v[224:225], v[18:19] op_sel:[0,0,0] op_sel_hi:[1,0,1] neg_lo:[1,0,0] neg_hi:[1,0,0]
    v_pk_fma_f32 v[20:21], v[196:197], v[224:225], v[20:21] op_sel:[0,0,0] op_sel_hi:[1,0,1] neg_lo:[1,0,0] neg_hi:[1,0,0]
    v_pk_fma_f32 v[22:23], v[198:199], v[224:225], v[22:23] op_sel:[0,0,0] op_sel_hi:[1,0,1] neg_lo:[1,0,0] neg_hi:[1,0,0]
    v_pk_fma_f32 v[24:25], v[200:201], v[224:225], v[24:25] op_sel:[0,0,0] op_sel_hi:[1,0,1] neg_lo:[1,0,0] neg_hi:[1,0,0]
    v_pk_fma_f32 v[26:27], v[202:203], v[224:225], v[26:27] op_sel:[0,0,0] op_sel_hi:[1,0,1] neg_lo:[1,0,0] neg_hi:[1,0,0]
    v_pk_fma_f32 v[28:29], v[204:205], v[224:225], v[28:29] op_sel:[0,0,0] op_sel_hi:[1,0,1] neg_lo:[1,0,0] neg_hi:[1,0,0]
    v_pk_fma_f32 v[30:31], v[206:207], v[224:225], v[30:31] op_sel:[0,0,0] op_sel_hi:[1,0,1] neg_lo:[1,0,0] neg_hi:[1,0,0]
    v_pk_mul_f32 v[2:3], v[16:17], v[16:17]
    v_pk_mul_f32 v[4:5], v[18:19], v[18:19]
    v_pk_mul_f32 v[6:7], v[20:21], v[20:21]
    v_pk_mul_f32 v[8:9], v[22:23], v[22:23]
    v_pk_fma_f32 v[2:3], v[2:3], v[226:227], v[224:225] op_sel:[0,0,1] op_sel_hi:[1,0,1]
    v_pk_fma_f32 v[4:5], v[4:5], v[226:227], v[224:225] op_sel:[0,0,1] op_sel_hi:[1,0,1]
    v_pk_fma_f32 v[6:7], v[6:7], v[226:227], v[224:225] op_sel:[0,0,1] op_sel_hi:[1,0,1]
    v_pk_fma_f32 v[8:9], v[8:9], v[226:227], v[224:225] op_sel:[0,0,1] op_sel_hi:[1,0,1]
    v_pk_mul_f32 v[2:3], v[2:3], v[16:17]
    v_pk_mul_f32 v[4:5], v[4:5], v[18:19]
    v_pk_mul_f32 v[6:7], v[6:7], v[20:21]
    v_pk_mul_f32 v[8:9], v[8:9], v[22:23]
    v_exp_f32 v2, v2
    v_exp_f32 v3, v3
    v_exp_f32 v4, v4
    v_exp_f32 v5, v5
    v_exp_f32 v6, v6
    v_exp_f32 v7, v7
    v_exp_f32 v8, v8
    v_exp_f32 v9, v9
    v_pk_mul_f32 v[24:25], v[24:25], v[16:17]
    v_pk_mul_f32 v[26:27], v[26:27], v[18:19]
    v_pk_mul_f32 v[28:29], v[28:29], v[20:21]
    v_pk_mul_f32 v[30:31], v[30:31], v[22:23]
    v_pk_fma_f32 v[2:3], v[2:3], v[226:227], v[226:227] op_sel:[0,1,1] op_sel_hi:[1,1,1]
    v_pk_fma_f32 v[4:5], v[4:5], v[226:227], v[226:227] op_sel:[0,1,1] op_sel_hi:[1,1,1]
    v_pk_fma_f32 v[6:7], v[6:7], v[226:227], v[226:227] op_sel:[0,1,1] op_sel_hi:[1,1,1]
    v_pk_fma_f32 v[8:9], v[8:9], v[226:227], v[226:227] op_sel:[0,1,1] op_sel_hi:[1,1,1]
    v_rcp_f32 v2, v2
    v_rcp_f32 v3, v3
    v_rcp_f32 v4, v4
    v_rcp_f32 v5, v5
    v_rcp_f32 v6, v6
    v_rcp_f32 v7, v7
    v_rcp_f32 v8, v8
    v_rcp_f32 v9, v9
    s_nop 0
    v_pk_mul_f32 v[2:3], v[2:3], v[24:25]
    v_pk_mul_f32 v[4:5], v[4:5], v[26:27]
    v_pk_mul_f32 v[6:7], v[6:7], v[28:29]
    v_pk_mul_f32 v[8:9], v[8:9], v[30:31]
    v_cvt_pk_bf16_f32 v16, v2, v3
    v_cvt_pk_bf16_f32 v17, v4, v5
    v_cvt_pk_bf16_f32 v18, v6, v7
    v_cvt_pk_bf16_f32 v19, v8, v9
    buffer_store_dwordx4 v[16:19], v15, s[4:7], s44 offen offset:0 sc1
    v_pk_fma_f32 v[32:33], v[192:193], v[228:229], v[32:33] op_sel:[0,0,0] op_sel_hi:[1,0,1] neg_lo:[1,0,0] neg_hi:[1,0,0]
    v_pk_fma_f32 v[34:35], v[194:195], v[228:229], v[34:35] op_sel:[0,0,0] op_sel_hi:[1,0,1] neg_lo:[1,0,0] neg_hi:[1,0,0]
    v_pk_fma_f32 v[36:37], v[196:197], v[228:229], v[36:37] op_sel:[0,0,0] op_sel_hi:[1,0,1] neg_lo:[1,0,0] neg_hi:[1,0,0]
    v_pk_fma_f32 v[38:39], v[198:199], v[228:229], v[38:39] op_sel:[0,0,0] op_sel_hi:[1,0,1] neg_lo:[1,0,0] neg_hi:[1,0,0]
    v_pk_fma_f32 v[40:41], v[200:201], v[228:229], v[40:41] op_sel:[0,0,0] op_sel_hi:[1,0,1] neg_lo:[1,0,0] neg_hi:[1,0,0]
    v_pk_fma_f32 v[42:43], v[202:203], v[228:229], v[42:43] op_sel:[0,0,0] op_sel_hi:[1,0,1] neg_lo:[1,0,0] neg_hi:[1,0,0]
    v_pk_fma_f32 v[44:45], v[204:205], v[228:229], v[44:45] op_sel:[0,0,0] op_sel_hi:[1,0,1] neg_lo:[1,0,0] neg_hi:[1,0,0]
    v_pk_fma_f32 v[46:47], v[206:207], v[228:229], v[46:47] op_sel:[0,0,0] op_sel_hi:[1,0,1] neg_lo:[1,0,0] neg_hi:[1,0,0]
    v_pk_mul_f32 v[2:3], v[32:33], v[32:33]
    v_pk_mul_f32 v[4:5], v[34:35], v[34:35]
    v_pk_mul_f32 v[6:7], v[36:37], v[36:37]
    v_pk_mul_f32 v[8:9], v[38:39], v[38:39]
    v_pk_fma_f32 v[2:3], v[2:3], v[230:231], v[228:229] op_sel:[0,0,1] op_sel_hi:[1,0,1]
    v_pk_fma_f32 v[4:5], v[4:5], v[230:231], v[228:229] op_sel:[0,0,1] op_sel_hi:[1,0,1]
    v_pk_fma_f32 v[6:7], v[6:7], v[230:231], v[228:229] op_sel:[0,0,1] op_sel_hi:[1,0,1]
    v_pk_fma_f32 v[8:9], v[8:9], v[230:231], v[228:229] op_sel:[0,0,1] op_sel_hi:[1,0,1]
    v_pk_mul_f32 v[2:3], v[2:3], v[32:33]
    v_pk_mul_f32 v[4:5], v[4:5], v[34:35]
    v_pk_mul_f32 v[6:7], v[6:7], v[36:37]
    v_pk_mul_f32 v[8:9], v[8:9], v[38:39]
    v_exp_f32 v2, v2
    v_exp_f32 v3, v3
    v_exp_f32 v4, v4
    v_exp_f32 v5, v5
    v_exp_f32 v6, v6
    v_exp_f32 v7, v7
    v_exp_f32 v8, v8
    v_exp_f32 v9, v9
    v_pk_mul_f32 v[40:41], v[40:41], v[32:33]
    v_pk_mul_f32 v[42:43], v[42:43], v[34:35]
    v_pk_mul_f32 v[44:45], v[44:45], v[36:37]
    v_pk_mul_f32 v[46:47], v[46:47], v[38:39]
    v_pk_fma_f32 v[2:3], v[2:3], v[230:231], v[230:231] op_sel:[0,1,1] op_sel_hi:[1,1,1]
    v_pk_fma_f32 v[4:5], v[4:5], v[230:231], v[230:231] op_sel:[0,1,1] op_sel_hi:[1,1,1]
    v_pk_fma_f32 v[6:7], v[6:7], v[230:231], v[230:231] op_sel:[0,1,1] op_sel_hi:[1,1,1]
    v_pk_fma_f32 v[8:9], v[8:9], v[230:231], v[230:231] op_sel:[0,1,1] op_sel_hi:[1,1,1]
    v_rcp_f32 v2, v2
    v_rcp_f32 v3, v3
    v_rcp_f32 v4, v4
    v_rcp_f32 v5, v5
    v_rcp_f32 v6, v6
    v_rcp_f32 v7, v7
    v_rcp_f32 v8, v8
    v_rcp_f32 v9, v9
    s_nop 0
    v_pk_mul_f32 v[2:3], v[2:3], v[40:41]
    v_pk_mul_f32 v[4:5], v[4:5], v[42:43]
    v_pk_mul_f32 v[6:7], v[6:7], v[44:45]
    v_pk_mul_f32 v[8:9], v[8:9], v[46:47]
    v_cvt_pk_bf16_f32 v32, v2, v3
    v_cvt_pk_bf16_f32 v33, v4, v5
    v_cvt_pk_bf16_f32 v34, v6, v7
    v_cvt_pk_bf16_f32 v35, v8, v9
    buffer_store_dwordx4 v[32:35], v15, s[4:7], s44 offen offset:256 sc1
    v_pk_fma_f32 v[48:49], v[192:193], v[232:233], v[48:49] op_sel:[0,0,0] op_sel_hi:[1,0,1] neg_lo:[1,0,0] neg_hi:[1,0,0]
    v_pk_fma_f32 v[50:51], v[194:195], v[232:233], v[50:51] op_sel:[0,0,0] op_sel_hi:[1,0,1] neg_lo:[1,0,0] neg_hi:[1,0,0]
    v_pk_fma_f32 v[52:53], v[196:197], v[232:233], v[52:53] op_sel:[0,0,0] op_sel_hi:[1,0,1] neg_lo:[1,0,0] neg_hi:[1,0,0]
    v_pk_fma_f32 v[54:55], v[198:199], v[232:233], v[54:55] op_sel:[0,0,0] op_sel_hi:[1,0,1] neg_lo:[1,0,0] neg_hi:[1,0,0]
    v_pk_fma_f32 v[56:57], v[200:201], v[232:233], v[56:57] op_sel:[0,0,0] op_sel_hi:[1,0,1] neg_lo:[1,0,0] neg_hi:[1,0,0]
    v_pk_fma_f32 v[58:59], v[202:203], v[232:233], v[58:59] op_sel:[0,0,0] op_sel_hi:[1,0,1] neg_lo:[1,0,0] neg_hi:[1,0,0]
    v_pk_fma_f32 v[60:61], v[204:205], v[232:233], v[60:61] op_sel:[0,0,0] op_sel_hi:[1,0,1] neg_lo:[1,0,0] neg_hi:[1,0,0]
    v_pk_fma_f32 v[62:63], v[206:207], v[232:233], v[62:63] op_sel:[0,0,0] op_sel_hi:[1,0,1] neg_lo:[1,0,0] neg_hi:[1,0,0]
    v_pk_mul_f32 v[2:3], v[48:49], v[48:49]
    v_pk_mul_f32 v[4:5], v[50:51], v[50:51]
    v_pk_mul_f32 v[6:7], v[52:53], v[52:53]
    v_pk_mul_f32 v[8:9], v[54:55], v[54:55]
    v_pk_fma_f32 v[2:3], v[2:3], v[234:235], v[232:233] op_sel:[0,0,1] op_sel_hi:[1,0,1]
    v_pk_fma_f32 v[4:5], v[4:5], v[234:235], v[232:233] op_sel:[0,0,1] op_sel_hi:[1,0,1]
    v_pk_fma_f32 v[6:7], v[6:7], v[234:235], v[232:233] op_sel:[0,0,1] op_sel_hi:[1,0,1]
    v_pk_fma_f32 v[8:9], v[8:9], v[234:235], v[232:233] op_sel:[0,0,1] op_sel_hi:[1,0,1]
    v_pk_mul_f32 v[2:3], v[2:3], v[48:49]
    v_pk_mul_f32 v[4:5], v[4:5], v[50:51]
    v_pk_mul_f32 v[6:7], v[6:7], v[52:53]
    v_pk_mul_f32 v[8:9], v[8:9], v[54:55]
    v_exp_f32 v2, v2
    v_exp_f32 v3, v3
    v_exp_f32 v4, v4
    v_exp_f32 v5, v5
    v_exp_f32 v6, v6
    v_exp_f32 v7, v7
    v_exp_f32 v8, v8
    v_exp_f32 v9, v9
    v_pk_mul_f32 v[56:57], v[56:57], v[48:49]
    v_pk_mul_f32 v[58:59], v[58:59], v[50:51]
    v_pk_mul_f32 v[60:61], v[60:61], v[52:53]
    v_pk_mul_f32 v[62:63], v[62:63], v[54:55]
    v_pk_fma_f32 v[2:3], v[2:3], v[234:235], v[234:235] op_sel:[0,1,1] op_sel_hi:[1,1,1]
    v_pk_fma_f32 v[4:5], v[4:5], v[234:235], v[234:235] op_sel:[0,1,1] op_sel_hi:[1,1,1]
    v_pk_fma_f32 v[6:7], v[6:7], v[234:235], v[234:235] op_sel:[0,1,1] op_sel_hi:[1,1,1]
    v_pk_fma_f32 v[8:9], v[8:9], v[234:235], v[234:235] op_sel:[0,1,1] op_sel_hi:[1,1,1]
    v_rcp_f32 v2, v2
    v_rcp_f32 v3, v3
    v_rcp_f32 v4, v4
    v_rcp_f32 v5, v5
    v_rcp_f32 v6, v6
    v_rcp_f32 v7, v7
    v_rcp_f32 v8, v8
    v_rcp_f32 v9, v9
    s_nop 0
    v_pk_mul_f32 v[2:3], v[2:3], v[56:57]
    v_pk_mul_f32 v[4:5], v[4:5], v[58:59]
    v_pk_mul_f32 v[6:7], v[6:7], v[60:61]
    v_pk_mul_f32 v[8:9], v[8:9], v[62:63]
    v_cvt_pk_bf16_f32 v48, v2, v3
    v_cvt_pk_bf16_f32 v49, v4, v5
    v_cvt_pk_bf16_f32 v50, v6, v7
    v_cvt_pk_bf16_f32 v51, v8, v9
    buffer_store_dwordx4 v[48:51], v15, s[4:7], s45 offen offset:0 sc1
    v_pk_fma_f32 v[64:65], v[192:193], v[236:237], v[64:65] op_sel:[0,0,0] op_sel_hi:[1,0,1] neg_lo:[1,0,0] neg_hi:[1,0,0]
    v_pk_fma_f32 v[66:67], v[194:195], v[236:237], v[66:67] op_sel:[0,0,0] op_sel_hi:[1,0,1] neg_lo:[1,0,0] neg_hi:[1,0,0]
    v_pk_fma_f32 v[68:69], v[196:197], v[236:237], v[68:69] op_sel:[0,0,0] op_sel_hi:[1,0,1] neg_lo:[1,0,0] neg_hi:[1,0,0]
    v_pk_fma_f32 v[70:71], v[198:199], v[236:237], v[70:71] op_sel:[0,0,0] op_sel_hi:[1,0,1] neg_lo:[1,0,0] neg_hi:[1,0,0]
    v_pk_fma_f32 v[72:73], v[200:201], v[236:237], v[72:73] op_sel:[0,0,0] op_sel_hi:[1,0,1] neg_lo:[1,0,0] neg_hi:[1,0,0]
    v_pk_fma_f32 v[74:75], v[202:203], v[236:237], v[74:75] op_sel:[0,0,0] op_sel_hi:[1,0,1] neg_lo:[1,0,0] neg_hi:[1,0,0]
    v_pk_fma_f32 v[76:77], v[204:205], v[236:237], v[76:77] op_sel:[0,0,0] op_sel_hi:[1,0,1] neg_lo:[1,0,0] neg_hi:[1,0,0]
    v_pk_fma_f32 v[78:79], v[206:207], v[236:237], v[78:79] op_sel:[0,0,0] op_sel_hi:[1,0,1] neg_lo:[1,0,0] neg_hi:[1,0,0]
    v_pk_mul_f32 v[2:3], v[64:65], v[64:65]
    v_pk_mul_f32 v[4:5], v[66:67], v[66:67]
    v_pk_mul_f32 v[6:7], v[68:69], v[68:69]
    v_pk_mul_f32 v[8:9], v[70:71], v[70:71]
    v_pk_fma_f32 v[2:3], v[2:3], v[238:239], v[236:237] op_sel:[0,0,1] op_sel_hi:[1,0,1]
    v_pk_fma_f32 v[4:5], v[4:5], v[238:239], v[236:237] op_sel:[0,0,1] op_sel_hi:[1,0,1]
    v_pk_fma_f32 v[6:7], v[6:7], v[238:239], v[236:237] op_sel:[0,0,1] op_sel_hi:[1,0,1]
    v_pk_fma_f32 v[8:9], v[8:9], v[238:239], v[236:237] op_sel:[0,0,1] op_sel_hi:[1,0,1]
    v_pk_mul_f32 v[2:3], v[2:3], v[64:65]
    v_pk_mul_f32 v[4:5], v[4:5], v[66:67]
    v_pk_mul_f32 v[6:7], v[6:7], v[68:69]
    v_pk_mul_f32 v[8:9], v[8:9], v[70:71]
    v_exp_f32 v2, v2
    v_exp_f32 v3, v3
    v_exp_f32 v4, v4
    v_exp_f32 v5, v5
    v_exp_f32 v6, v6
    v_exp_f32 v7, v7
    v_exp_f32 v8, v8
    v_exp_f32 v9, v9
    v_pk_mul_f32 v[72:73], v[72:73], v[64:65]
    v_pk_mul_f32 v[74:75], v[74:75], v[66:67]
    v_pk_mul_f32 v[76:77], v[76:77], v[68:69]
    v_pk_mul_f32 v[78:79], v[78:79], v[70:71]
    v_pk_fma_f32 v[2:3], v[2:3], v[238:239], v[238:239] op_sel:[0,1,1] op_sel_hi:[1,1,1]
    v_pk_fma_f32 v[4:5], v[4:5], v[238:239], v[238:239] op_sel:[0,1,1] op_sel_hi:[1,1,1]
    v_pk_fma_f32 v[6:7], v[6:7], v[238:239], v[238:239] op_sel:[0,1,1] op_sel_hi:[1,1,1]
    v_pk_fma_f32 v[8:9], v[8:9], v[238:239], v[238:239] op_sel:[0,1,1] op_sel_hi:[1,1,1]
    v_rcp_f32 v2, v2
    v_rcp_f32 v3, v3
    v_rcp_f32 v4, v4
    v_rcp_f32 v5, v5
    v_rcp_f32 v6, v6
    v_rcp_f32 v7, v7
    v_rcp_f32 v8, v8
    v_rcp_f32 v9, v9
    s_nop 0
    v_pk_mul_f32 v[2:3], v[2:3], v[72:73]
    v_pk_mul_f32 v[4:5], v[4:5], v[74:75]
    v_pk_mul_f32 v[6:7], v[6:7], v[76:77]
    v_pk_mul_f32 v[8:9], v[8:9], v[78:79]
    v_cvt_pk_bf16_f32 v64, v2, v3
    v_cvt_pk_bf16_f32 v65, v4, v5
    v_cvt_pk_bf16_f32 v66, v6, v7
    v_cvt_pk_bf16_f32 v67, v8, v9
    buffer_store_dwordx4 v[64:67], v15, s[4:7], s45 offen offset:256 sc1
    s_waitcnt lgkmcnt(0)
    v_pk_fma_f32 v[80:81], v[192:193], v[160:161], v[80:81] op_sel:[0,0,0] op_sel_hi:[1,0,1] neg_lo:[1,0,0] neg_hi:[1,0,0]
    v_pk_fma_f32 v[82:83], v[194:195], v[160:161], v[82:83] op_sel:[0,0,0] op_sel_hi:[1,0,1] neg_lo:[1,0,0] neg_hi:[1,0,0]
    v_pk_fma_f32 v[84:85], v[196:197], v[160:161], v[84:85] op_sel:[0,0,0] op_sel_hi:[1,0,1] neg_lo:[1,0,0] neg_hi:[1,0,0]
    v_pk_fma_f32 v[86:87], v[198:199], v[160:161], v[86:87] op_sel:[0,0,0] op_sel_hi:[1,0,1] neg_lo:[1,0,0] neg_hi:[1,0,0]
    v_pk_fma_f32 v[88:89], v[200:201], v[160:161], v[88:89] op_sel:[0,0,0] op_sel_hi:[1,0,1] neg_lo:[1,0,0] neg_hi:[1,0,0]
    v_pk_fma_f32 v[90:91], v[202:203], v[160:161], v[90:91] op_sel:[0,0,0] op_sel_hi:[1,0,1] neg_lo:[1,0,0] neg_hi:[1,0,0]
    v_pk_fma_f32 v[92:93], v[204:205], v[160:161], v[92:93] op_sel:[0,0,0] op_sel_hi:[1,0,1] neg_lo:[1,0,0] neg_hi:[1,0,0]
    v_pk_fma_f32 v[94:95], v[206:207], v[160:161], v[94:95] op_sel:[0,0,0] op_sel_hi:[1,0,1] neg_lo:[1,0,0] neg_hi:[1,0,0]
    v_pk_mul_f32 v[2:3], v[80:81], v[80:81]
    v_pk_mul_f32 v[4:5], v[82:83], v[82:83]
    v_pk_mul_f32 v[6:7], v[84:85], v[84:85]
    v_pk_mul_f32 v[8:9], v[86:87], v[86:87]
    v_pk_fma_f32 v[2:3], v[2:3], v[162:163], v[160:161] op_sel:[0,0,1] op_sel_hi:[1,0,1]
    v_pk_fma_f32 v[4:5], v[4:5], v[162:163], v[160:161] op_sel:[0,0,1] op_sel_hi:[1,0,1]
    v_pk_fma_f32 v[6:7], v[6:7], v[162:163], v[160:161] op_sel:[0,0,1] op_sel_hi:[1,0,1]
    v_pk_fma_f32 v[8:9], v[8:9], v[162:163], v[160:161] op_sel:[0,0,1] op_sel_hi:[1,0,1]
    v_pk_mul_f32 v[2:3], v[2:3], v[80:81]
    v_pk_mul_f32 v[4:5], v[4:5], v[82:83]
    v_pk_mul_f32 v[6:7], v[6:7], v[84:85]
    v_pk_mul_f32 v[8:9], v[8:9], v[86:87]
    v_exp_f32 v2, v2
    v_exp_f32 v3, v3
    v_exp_f32 v4, v4
    v_exp_f32 v5, v5
    v_exp_f32 v6, v6
    v_exp_f32 v7, v7
    v_exp_f32 v8, v8
    v_exp_f32 v9, v9
    v_pk_mul_f32 v[88:89], v[88:89], v[80:81]
    v_pk_mul_f32 v[90:91], v[90:91], v[82:83]
    v_pk_mul_f32 v[92:93], v[92:93], v[84:85]
    v_pk_mul_f32 v[94:95], v[94:95], v[86:87]
    v_pk_fma_f32 v[2:3], v[2:3], v[162:163], v[162:163] op_sel:[0,1,1] op_sel_hi:[1,1,1]
    v_pk_fma_f32 v[4:5], v[4:5], v[162:163], v[162:163] op_sel:[0,1,1] op_sel_hi:[1,1,1]
    v_pk_fma_f32 v[6:7], v[6:7], v[162:163], v[162:163] op_sel:[0,1,1] op_sel_hi:[1,1,1]
    v_pk_fma_f32 v[8:9], v[8:9], v[162:163], v[162:163] op_sel:[0,1,1] op_sel_hi:[1,1,1]
    v_rcp_f32 v2, v2
    v_rcp_f32 v3, v3
    v_rcp_f32 v4, v4
    v_rcp_f32 v5, v5
    v_rcp_f32 v6, v6
    v_rcp_f32 v7, v7
    v_rcp_f32 v8, v8
    v_rcp_f32 v9, v9
    s_nop 0
    v_pk_mul_f32 v[2:3], v[2:3], v[88:89]
    v_pk_mul_f32 v[4:5], v[4:5], v[90:91]
    v_pk_mul_f32 v[6:7], v[6:7], v[92:93]
    v_pk_mul_f32 v[8:9], v[8:9], v[94:95]
    v_cvt_pk_bf16_f32 v80, v2, v3
    v_cvt_pk_bf16_f32 v81, v4, v5
    v_cvt_pk_bf16_f32 v82, v6, v7
    v_cvt_pk_bf16_f32 v83, v8, v9
    buffer_store_dwordx4 v[80:83], v15, s[4:7], s46 offen offset:0 sc1
    v_pk_fma_f32 v[96:97], v[192:193], v[164:165], v[96:97] op_sel:[0,0,0] op_sel_hi:[1,0,1] neg_lo:[1,0,0] neg_hi:[1,0,0]
    v_pk_fma_f32 v[98:99], v[194:195], v[164:165], v[98:99] op_sel:[0,0,0] op_sel_hi:[1,0,1] neg_lo:[1,0,0] neg_hi:[1,0,0]
    v_pk_fma_f32 v[100:101], v[196:197], v[164:165], v[100:101] op_sel:[0,0,0] op_sel_hi:[1,0,1] neg_lo:[1,0,0] neg_hi:[1,0,0]
    v_pk_fma_f32 v[102:103], v[198:199], v[164:165], v[102:103] op_sel:[0,0,0] op_sel_hi:[1,0,1] neg_lo:[1,0,0] neg_hi:[1,0,0]
    v_pk_fma_f32 v[104:105], v[200:201], v[164:165], v[104:105] op_sel:[0,0,0] op_sel_hi:[1,0,1] neg_lo:[1,0,0] neg_hi:[1,0,0]
    v_pk_fma_f32 v[106:107], v[202:203], v[164:165], v[106:107] op_sel:[0,0,0] op_sel_hi:[1,0,1] neg_lo:[1,0,0] neg_hi:[1,0,0]
    v_pk_fma_f32 v[108:109], v[204:205], v[164:165], v[108:109] op_sel:[0,0,0] op_sel_hi:[1,0,1] neg_lo:[1,0,0] neg_hi:[1,0,0]
    v_pk_fma_f32 v[110:111], v[206:207], v[164:165], v[110:111] op_sel:[0,0,0] op_sel_hi:[1,0,1] neg_lo:[1,0,0] neg_hi:[1,0,0]
    v_pk_mul_f32 v[2:3], v[96:97], v[96:97]
    v_pk_mul_f32 v[4:5], v[98:99], v[98:99]
    v_pk_mul_f32 v[6:7], v[100:101], v[100:101]
    v_pk_mul_f32 v[8:9], v[102:103], v[102:103]
    v_pk_fma_f32 v[2:3], v[2:3], v[166:167], v[164:165] op_sel:[0,0,1] op_sel_hi:[1,0,1]
    v_pk_fma_f32 v[4:5], v[4:5], v[166:167], v[164:165] op_sel:[0,0,1] op_sel_hi:[1,0,1]
    v_pk_fma_f32 v[6:7], v[6:7], v[166:167], v[164:165] op_sel:[0,0,1] op_sel_hi:[1,0,1]
    v_pk_fma_f32 v[8:9], v[8:9], v[166:167], v[164:165] op_sel:[0,0,1] op_sel_hi:[1,0,1]
    v_pk_mul_f32 v[2:3], v[2:3], v[96:97]
    v_pk_mul_f32 v[4:5], v[4:5], v[98:99]
    v_pk_mul_f32 v[6:7], v[6:7], v[100:101]
    v_pk_mul_f32 v[8:9], v[8:9], v[102:103]
    v_exp_f32 v2, v2
    v_exp_f32 v3, v3
    v_exp_f32 v4, v4
    v_exp_f32 v5, v5
    v_exp_f32 v6, v6
    v_exp_f32 v7, v7
    v_exp_f32 v8, v8
    v_exp_f32 v9, v9
    v_pk_mul_f32 v[104:105], v[104:105], v[96:97]
    v_pk_mul_f32 v[106:107], v[106:107], v[98:99]
    v_pk_mul_f32 v[108:109], v[108:109], v[100:101]
    v_pk_mul_f32 v[110:111], v[110:111], v[102:103]
    v_pk_fma_f32 v[2:3], v[2:3], v[166:167], v[166:167] op_sel:[0,1,1] op_sel_hi:[1,1,1]
    v_pk_fma_f32 v[4:5], v[4:5], v[166:167], v[166:167] op_sel:[0,1,1] op_sel_hi:[1,1,1]
    v_pk_fma_f32 v[6:7], v[6:7], v[166:167], v[166:167] op_sel:[0,1,1] op_sel_hi:[1,1,1]
    v_pk_fma_f32 v[8:9], v[8:9], v[166:167], v[166:167] op_sel:[0,1,1] op_sel_hi:[1,1,1]
    v_rcp_f32 v2, v2
    v_rcp_f32 v3, v3
    v_rcp_f32 v4, v4
    v_rcp_f32 v5, v5
    v_rcp_f32 v6, v6
    v_rcp_f32 v7, v7
    v_rcp_f32 v8, v8
    v_rcp_f32 v9, v9
    s_nop 0
    v_pk_mul_f32 v[2:3], v[2:3], v[104:105]
    v_pk_mul_f32 v[4:5], v[4:5], v[106:107]
    v_pk_mul_f32 v[6:7], v[6:7], v[108:109]
    v_pk_mul_f32 v[8:9], v[8:9], v[110:111]
    v_cvt_pk_bf16_f32 v96, v2, v3
    v_cvt_pk_bf16_f32 v97, v4, v5
    v_cvt_pk_bf16_f32 v98, v6, v7
    v_cvt_pk_bf16_f32 v99, v8, v9
    buffer_store_dwordx4 v[96:99], v15, s[4:7], s46 offen offset:256 sc1
    v_pk_fma_f32 v[112:113], v[192:193], v[168:169], v[112:113] op_sel:[0,0,0] op_sel_hi:[1,0,1] neg_lo:[1,0,0] neg_hi:[1,0,0]
    v_pk_fma_f32 v[114:115], v[194:195], v[168:169], v[114:115] op_sel:[0,0,0] op_sel_hi:[1,0,1] neg_lo:[1,0,0] neg_hi:[1,0,0]
    v_pk_fma_f32 v[116:117], v[196:197], v[168:169], v[116:117] op_sel:[0,0,0] op_sel_hi:[1,0,1] neg_lo:[1,0,0] neg_hi:[1,0,0]
    v_pk_fma_f32 v[118:119], v[198:199], v[168:169], v[118:119] op_sel:[0,0,0] op_sel_hi:[1,0,1] neg_lo:[1,0,0] neg_hi:[1,0,0]
    v_pk_fma_f32 v[120:121], v[200:201], v[168:169], v[120:121] op_sel:[0,0,0] op_sel_hi:[1,0,1] neg_lo:[1,0,0] neg_hi:[1,0,0]
    v_pk_fma_f32 v[122:123], v[202:203], v[168:169], v[122:123] op_sel:[0,0,0] op_sel_hi:[1,0,1] neg_lo:[1,0,0] neg_hi:[1,0,0]
    v_pk_fma_f32 v[124:125], v[204:205], v[168:169], v[124:125] op_sel:[0,0,0] op_sel_hi:[1,0,1] neg_lo:[1,0,0] neg_hi:[1,0,0]
    v_pk_fma_f32 v[126:127], v[206:207], v[168:169], v[126:127] op_sel:[0,0,0] op_sel_hi:[1,0,1] neg_lo:[1,0,0] neg_hi:[1,0,0]
    v_pk_mul_f32 v[2:3], v[112:113], v[112:113]
    v_pk_mul_f32 v[4:5], v[114:115], v[114:115]
    v_pk_mul_f32 v[6:7], v[116:117], v[116:117]
    v_pk_mul_f32 v[8:9], v[118:119], v[118:119]
    v_pk_fma_f32 v[2:3], v[2:3], v[170:171], v[168:169] op_sel:[0,0,1] op_sel_hi:[1,0,1]
    v_pk_fma_f32 v[4:5], v[4:5], v[170:171], v[168:169] op_sel:[0,0,1] op_sel_hi:[1,0,1]
    v_pk_fma_f32 v[6:7], v[6:7], v[170:171], v[168:169] op_sel:[0,0,1] op_sel_hi:[1,0,1]
    v_pk_fma_f32 v[8:9], v[8:9], v[170:171], v[168:169] op_sel:[0,0,1] op_sel_hi:[1,0,1]
    v_pk_mul_f32 v[2:3], v[2:3], v[112:113]
    v_pk_mul_f32 v[4:5], v[4:5], v[114:115]
    v_pk_mul_f32 v[6:7], v[6:7], v[116:117]
    v_pk_mul_f32 v[8:9], v[8:9], v[118:119]
    v_exp_f32 v2, v2
    v_exp_f32 v3, v3
    v_exp_f32 v4, v4
    v_exp_f32 v5, v5
    v_exp_f32 v6, v6
    v_exp_f32 v7, v7
    v_exp_f32 v8, v8
    v_exp_f32 v9, v9
    v_pk_mul_f32 v[120:121], v[120:121], v[112:113]
    v_pk_mul_f32 v[122:123], v[122:123], v[114:115]
    v_pk_mul_f32 v[124:125], v[124:125], v[116:117]
    v_pk_mul_f32 v[126:127], v[126:127], v[118:119]
    v_pk_fma_f32 v[2:3], v[2:3], v[170:171], v[170:171] op_sel:[0,1,1] op_sel_hi:[1,1,1]
    v_pk_fma_f32 v[4:5], v[4:5], v[170:171], v[170:171] op_sel:[0,1,1] op_sel_hi:[1,1,1]
    v_pk_fma_f32 v[6:7], v[6:7], v[170:171], v[170:171] op_sel:[0,1,1] op_sel_hi:[1,1,1]
    v_pk_fma_f32 v[8:9], v[8:9], v[170:171], v[170:171] op_sel:[0,1,1] op_sel_hi:[1,1,1]
    v_rcp_f32 v2, v2
    v_rcp_f32 v3, v3
    v_rcp_f32 v4, v4
    v_rcp_f32 v5, v5
    v_rcp_f32 v6, v6
    v_rcp_f32 v7, v7
    v_rcp_f32 v8, v8
    v_rcp_f32 v9, v9
    s_nop 0
    v_pk_mul_f32 v[2:3], v[2:3], v[120:121]
    v_pk_mul_f32 v[4:5], v[4:5], v[122:123]
    v_pk_mul_f32 v[6:7], v[6:7], v[124:125]
    v_pk_mul_f32 v[8:9], v[8:9], v[126:127]
    v_cvt_pk_bf16_f32 v112, v2, v3
    v_cvt_pk_bf16_f32 v113, v4, v5
    v_cvt_pk_bf16_f32 v114, v6, v7
    v_cvt_pk_bf16_f32 v115, v8, v9
    buffer_store_dwordx4 v[112:115], v15, s[4:7], s47 offen offset:0 sc1
    v_pk_fma_f32 v[128:129], v[192:193], v[172:173], v[128:129] op_sel:[0,0,0] op_sel_hi:[1,0,1] neg_lo:[1,0,0] neg_hi:[1,0,0]
    v_pk_fma_f32 v[130:131], v[194:195], v[172:173], v[130:131] op_sel:[0,0,0] op_sel_hi:[1,0,1] neg_lo:[1,0,0] neg_hi:[1,0,0]
    v_pk_fma_f32 v[132:133], v[196:197], v[172:173], v[132:133] op_sel:[0,0,0] op_sel_hi:[1,0,1] neg_lo:[1,0,0] neg_hi:[1,0,0]
    v_pk_fma_f32 v[134:135], v[198:199], v[172:173], v[134:135] op_sel:[0,0,0] op_sel_hi:[1,0,1] neg_lo:[1,0,0] neg_hi:[1,0,0]
    v_pk_fma_f32 v[136:137], v[200:201], v[172:173], v[136:137] op_sel:[0,0,0] op_sel_hi:[1,0,1] neg_lo:[1,0,0] neg_hi:[1,0,0]
    v_pk_fma_f32 v[138:139], v[202:203], v[172:173], v[138:139] op_sel:[0,0,0] op_sel_hi:[1,0,1] neg_lo:[1,0,0] neg_hi:[1,0,0]
    v_pk_fma_f32 v[140:141], v[204:205], v[172:173], v[140:141] op_sel:[0,0,0] op_sel_hi:[1,0,1] neg_lo:[1,0,0] neg_hi:[1,0,0]
    v_pk_fma_f32 v[142:143], v[206:207], v[172:173], v[142:143] op_sel:[0,0,0] op_sel_hi:[1,0,1] neg_lo:[1,0,0] neg_hi:[1,0,0]
    v_pk_mul_f32 v[2:3], v[128:129], v[128:129]
    v_pk_mul_f32 v[4:5], v[130:131], v[130:131]
    v_pk_mul_f32 v[6:7], v[132:133], v[132:133]
    v_pk_mul_f32 v[8:9], v[134:135], v[134:135]
    v_pk_fma_f32 v[2:3], v[2:3], v[174:175], v[172:173] op_sel:[0,0,1] op_sel_hi:[1,0,1]
    v_pk_fma_f32 v[4:5], v[4:5], v[174:175], v[172:173] op_sel:[0,0,1] op_sel_hi:[1,0,1]
    v_pk_fma_f32 v[6:7], v[6:7], v[174:175], v[172:173] op_sel:[0,0,1] op_sel_hi:[1,0,1]
    v_pk_fma_f32 v[8:9], v[8:9], v[174:175], v[172:173] op_sel:[0,0,1] op_sel_hi:[1,0,1]
    v_pk_mul_f32 v[2:3], v[2:3], v[128:129]
    v_pk_mul_f32 v[4:5], v[4:5], v[130:131]
    v_pk_mul_f32 v[6:7], v[6:7], v[132:133]
    v_pk_mul_f32 v[8:9], v[8:9], v[134:135]
    v_exp_f32 v2, v2
    v_exp_f32 v3, v3
    v_exp_f32 v4, v4
    v_exp_f32 v5, v5
    v_exp_f32 v6, v6
    v_exp_f32 v7, v7
    v_exp_f32 v8, v8
    v_exp_f32 v9, v9
    v_pk_mul_f32 v[136:137], v[136:137], v[128:129]
    v_pk_mul_f32 v[138:139], v[138:139], v[130:131]
    v_pk_mul_f32 v[140:141], v[140:141], v[132:133]
    v_pk_mul_f32 v[142:143], v[142:143], v[134:135]
    v_pk_fma_f32 v[2:3], v[2:3], v[174:175], v[174:175] op_sel:[0,1,1] op_sel_hi:[1,1,1]
    v_pk_fma_f32 v[4:5], v[4:5], v[174:175], v[174:175] op_sel:[0,1,1] op_sel_hi:[1,1,1]
    v_pk_fma_f32 v[6:7], v[6:7], v[174:175], v[174:175] op_sel:[0,1,1] op_sel_hi:[1,1,1]
    v_pk_fma_f32 v[8:9], v[8:9], v[174:175], v[174:175] op_sel:[0,1,1] op_sel_hi:[1,1,1]
    v_rcp_f32 v2, v2
    v_rcp_f32 v3, v3
    v_rcp_f32 v4, v4
    v_rcp_f32 v5, v5
    v_rcp_f32 v6, v6
    v_rcp_f32 v7, v7
    v_rcp_f32 v8, v8
    v_rcp_f32 v9, v9
    s_nop 0
    v_pk_mul_f32 v[2:3], v[2:3], v[136:137]
    v_pk_mul_f32 v[4:5], v[4:5], v[138:139]
    v_pk_mul_f32 v[6:7], v[6:7], v[140:141]
    v_pk_mul_f32 v[8:9], v[8:9], v[142:143]
    v_cvt_pk_bf16_f32 v128, v2, v3
    v_cvt_pk_bf16_f32 v129, v4, v5
    v_cvt_pk_bf16_f32 v130, v6, v7
    v_cvt_pk_bf16_f32 v131, v8, v9
    buffer_store_dwordx4 v[128:131], v15, s[4:7], s47 offen offset:256 sc1
    v_mov_b32 v10, 160880
    v_mov_b32 v11, 1
    s_mov_b64 exec, 1
    ds_add_u32 v10, v11
    s_mov_b64 exec, -1
    s_setprio 2
    s_add_u32 s36, s51, 139264
    v_bfe_u32 v8, v1, 4, 1
    v_lshlrev_b32 v7, 5, v8
    v_and_b32 v8, 3, v1
    v_lshl_add_u32 v7, v8, 3, v7
    v_lshrrev_b32 v8, 5, v1
    v_lshlrev_b32 v9, 6, v8
    v_sub_u32 v7, v7, v9
    v_bfe_u32 v9, v1, 2, 2
    v_lshlrev_b32 v9, 3, v9
    v_sub_u32 v7, v7, v9
    v_add_u32 v7, 96, v7
    v_add_u32 v7, s36, v7
    v_and_b32 v9, 3, v1
    v_mul_u32_u24 v9, 1216, v9
    v_bfe_u32 v10, v1, 2, 3
    v_add_u32 v10, v10, v8
    v_lshl_add_u32 v9, v10, 4, v9
    v_add_u32 v9, s36, v9
    v_add_u32 v9, 4352, v9
    s_add_u32 s24, s70, 10485760
    s_addc_u32 s25, s71, 0
    s_mov_b32 s26, 1835008
    s_mov_b32 s27, 0x00020000
    s_add_u32 s8, s70, 14811136
    s_addc_u32 s9, s71, 0
    s_mov_b32 s10, 61440
    s_mov_b32 s11, 0x00020000
    v_and_b32 v13, 31, v1
    v_and_b32 v14, 1, v13
    v_lshlrev_b32 v12, 4, v14
    v_bfe_u32 v14, v13, 4, 1
    v_lshl_or_b32 v12, v14, 3, v12
    v_bfe_u32 v14, v13, 1, 1
    v_lshl_or_b32 v12, v14, 2, v12
    v_bfe_u32 v14, v13, 3, 1
    v_lshl_or_b32 v12, v14, 1, v12
    v_bfe_u32 v14, v13, 2, 1
    v_or_b32 v12, v14, v12
    v_and_b32 v13, 32, v1
    v_or_b32 v12, v12, v13
    s_lshl_b32 s37, s42, 7
    s_add_u32 s37, s37, 161024
    v_mov_b32 v11, s37
    v_lshlrev_b32 v12, 1, v12
    v_add_u32 v12, s36, v12
    v_and_b32 v3, 31, v1
    v_lshlrev_b32 v3, 4, v3
    v_add_u32 v2, s36, v3
    v_lshrrev_b32 v14, 7, v3
    s_mov_b32 s39, 57344
    v_mul_lo_u32 v14, v14, s39
    v_and_b32 v3, 127, v3
    v_add_u32 v14, v14, v3
    v_lshrrev_b32 v3, 5, v1
    s_lshl_b32 s39, s2, 1
    s_add_u32 s39, s39, s42
    s_lshl_b32 s39, s39, 7
    s_lshl_b32 s38, s42, 2
    s_add_u32 s37, s38, 160832
    v_mov_b32 v124, s37
    s_mov_b32 s50, 0
kr_4:
    ds_read_b32 v125, v124
    s_waitcnt lgkmcnt(0)
    v_readfirstlane_b32 s36, v125
    s_cmp_ge_u32 s36, 2
    s_cbranch_scc1 kr_4_ok
    s_add_u32 s50, s50, 1
    s_cmp_ge_u32 s50, 1600000
    s_cbranch_scc1 kr_4_ok
    s_sleep 1
    s_branch kr_4
kr_4_ok:
    s_add_u32 s37, s38, 160768
    v_mov_b32 v127, s37
    ds_read_b32 v127, v127
    s_cmp_eq_u32 s43, 1
    s_cbranch_scc1 cvY_5
    ds_read_b64_tr_b16 v[80:81], v7 offset:32
    ds_read_b64_tr_b16 v[82:83], v7 offset:0
    ds_read_b128 v[96:99], v9 offset:128
    ds_read_b128 v[100:103], v9 offset:512
    ds_read_b128 v[104:107], v9 offset:640
    ds_read_b128 v[108:111], v9 offset:1024
    ds_read_b64_tr_b16 v[84:85], v7 offset:160
    ds_read_b64_tr_b16 v[86:87], v7 offset:128
    ds_read_b128 v[112:115], v9 offset:96
    ds_read_b128 v[116:119], v9 offset:480
    s_waitcnt lgkmcnt(7)
    v_mfma_f32_32x32x16_f16 v[16:31], v[96:99], v[80:83], 0
    ds_read_b128 v[120:123], v9 offset:608
    s_waitcnt lgkmcnt(7)
    v_mfma_f32_32x32x16_f16 v[32:47], v[100:103], v[80:83], 0
    ds_read_b128 v[96:99], v9 offset:992
    s_waitcnt lgkmcnt(7)
    v_mfma_f32_32x32x16_f16 v[48:63], v[104:107], v[80:83], 0
    ds_read_b64_tr_b16 v[88:89], v7 offset:288
    ds_read_b64_tr_b16 v[90:91], v7 offset:256
    ds_read_b128 v[100:103], v9 offset:64
    s_waitcnt lgkmcnt(9)
    v_mfma_f32_32x32x16_f16 v[64:79], v[108:111], v[80:83], 0
    ds_read_b128 v[104:107], v9 offset:448
    s_waitcnt lgkmcnt(7)
    v_mfma_f32_32x32x16_f16 v[16:31], v[112:115], v[84:87], v[16:31]
    ds_read_b128 v[108:111], v9 offset:576
    s_waitcnt lgkmcnt(7)
    v_mfma_f32_32x32x16_f16 v[32:47], v[116:119], v[84:87], v[32:47]
    ds_read_b128 v[112:115], v9 offset:960
    s_waitcnt lgkmcnt(7)
    v_mfma_f32_32x32x16_f16 v[48:63], v[120:123], v[84:87], v[48:63]
    ds_read_b64_tr_b16 v[92:93], v7 offset:416
    ds_read_b64_tr_b16 v[94:95], v7 offset:384
    ds_read_b128 v[116:119], v9 offset:32
    s_waitcnt lgkmcnt(9)
    v_mfma_f32_32x32x16_f16 v[64:79], v[96:99], v[84:87], v[64:79]
    ds_read_b128 v[120:123], v9 offset:416
    s_waitcnt lgkmcnt(7)
    v_mfma_f32_32x32x16_f16 v[16:31], v[100:103], v[88:91], v[16:31]
    ds_read_b128 v[96:99], v9 offset:544
    s_waitcnt lgkmcnt(7)
    v_mfma_f32_32x32x16_f16 v[32:47], v[104:107], v[88:91], v[32:47]
    ds_read_b128 v[100:103], v9 offset:928
    s_waitcnt lgkmcnt(7)
    v_mfma_f32_32x32x16_f16 v[48:63], v[108:111], v[88:91], v[48:63]
    ds_read_b64_tr_b16 v[80:81], v7 offset:544
    ds_read_b64_tr_b16 v[82:83], v7 offset:512
    ds_read_b128 v[104:107], v9 offset:0
    s_waitcnt lgkmcnt(9)
    v_mfma_f32_32x32x16_f16 v[64:79], v[112:115], v[88:91], v[64:79]
    ds_read_b128 v[108:111], v9 offset:384
    s_waitcnt lgkmcnt(7)
    v_mfma_f32_32x32x16_f16 v[16:31], v[116:119], v[92:95], v[16:31]
    ds_read_b128 v[112:115], v9 offset:512
    s_waitcnt lgkmcnt(7)
    v_mfma_f32_32x32x16_f16 v[32:47], v[120:123], v[92:95], v[32:47]
    ds_read_b128 v[116:119], v9 offset:896
    s_waitcnt lgkmcnt(7)
    v_mfma_f32_32x32x16_f16 v[48:63], v[96:99], v[92:95], v[48:63]
    ds_read_b64_tr_b16 v[84:85], v7 offset:672
    ds_read_b64_tr_b16 v[86:87], v7 offset:640
    ds_read_b128 v[120:123], v9 offset:352
    s_waitcnt lgkmcnt(9)
    v_mfma_f32_32x32x16_f16 v[64:79], v[100:103], v[92:95], v[64:79]
    ds_read_b128 v[96:99], v9 offset:480
    s_waitcnt lgkmcnt(7)
    v_mfma_f32_32x32x16_f16 v[16:31], v[104:107], v[80:83], v[16:31]
    ds_read_b128 v[100:103], v9 offset:864
    s_waitcnt lgkmcnt(7)
    v_mfma_f32_32x32x16_f16 v[32:47], v[108:111], v[80:83], v[32:47]
    ds_read_b64_tr_b16 v[88:89], v7 offset:800
    ds_read_b64_tr_b16 v[90:91], v7 offset:768
    ds_read_b128 v[104:107], v9 offset:320
    s_waitcnt lgkmcnt(9)
    v_mfma_f32_32x32x16_f16 v[48:63], v[112:115], v[80:83], v[48:63]
    s_waitcnt vmcnt(0)
    v_mov_b32 v124, 160864
    v_mov_b32 v125, 1
    s_mov_b64 exec, 1
    ds_add_rtn_u32 v126, v124, v125
    s_mov_b64 exec, -1
    ds_read_b128 v[108:111], v9 offset:448
    s_waitcnt lgkmcnt(10)
    v_mfma_f32_32x32x16_f16 v[64:79], v[116:119], v[80:83], v[64:79]
    ds_read_b128 v[112:115], v9 offset:832
    s_waitcnt lgkmcnt(8)
    v_mfma_f32_32x32x16_f16 v[32:47], v[120:123], v[84:87], v[32:47]
    ds_read_b64_tr_b16 v[92:93], v7 offset:928
    ds_read_b64_tr_b16 v[94:95], v7 offset:896
    ds_read_b128 v[116:119], v9 offset:288
    s_waitcnt lgkmcnt(10)
    v_mfma_f32_32x32x16_f16 v[48:63], v[96:99], v[84:87], v[48:63]
    s_waitcnt lgkmcnt(5)
    v_readfirstlane_b32 s36, v126
    s_cmp_lg_u32 s36, 3
    s_cbranch_scc1 hf_7
    s_mul_i32 s36, s28, 896
    s_add_u32 s36, s36, s29
    s_lshl_b32 s36, s36, 2
    s_add_u32 s36, s36, 4096
    v_lshl_add_u32 v124, v1, 8, s36
    s_mov_b64 exec, 0x3fff
    buffer_store_dword v125, v124, s[8:11], 0 offen sc1
    s_mov_b64 exec, -1
hf_7:
    ds_read_b128 v[120:123], v9 offset:416
    s_waitcnt lgkmcnt(10)
    v_mfma_f32_32x32x16_f16 v[64:79], v[100:103], v[84:87], v[64:79]
    ds_read_b128 v[96:99], v9 offset:800
    s_waitcnt lgkmcnt(8)
    v_mfma_f32_32x32x16_f16 v[32:47], v[104:107], v[88:91], v[32:47]
    ds_read_b64_tr_b16 v[80:81], v7 offset:1056
    ds_read_b64_tr_b16 v[82:83], v7 offset:1024
    ds_read_b128 v[100:103], v9 offset:256
    s_waitcnt lgkmcnt(9)
    v_mfma_f32_32x32x16_f16 v[48:63], v[108:111], v[88:91], v[48:63]
    ds_read_b128 v[104:107], v9 offset:384
    s_waitcnt lgkmcnt(9)
    v_mfma_f32_32x32x16_f16 v[64:79], v[112:115], v[88:91], v[64:79]
    ds_read_b128 v[108:111], v9 offset:768
    s_waitcnt lgkmcnt(7)
    v_mfma_f32_32x32x16_f16 v[32:47], v[116:119], v[92:95], v[32:47]
    ds_read_b64_tr_b16 v[84:85], v7 offset:1184
    ds_read_b64_tr_b16 v[86:87], v7 offset:1152
    ds_read_b128 v[112:115], v9 offset:224
    s_waitcnt lgkmcnt(9)
    v_mfma_f32_32x32x16_f16 v[48:63], v[120:123], v[92:95], v[48:63]
    ds_read_b128 v[116:119], v9 offset:352
    s_waitcnt lgkmcnt(9)
    v_mfma_f32_32x32x16_f16 v[64:79], v[96:99], v[92:95], v[64:79]
    ds_read_b128 v[120:123], v9 offset:736
    s_waitcnt lgkmcnt(7)
    v_mfma_f32_32x32x16_f16 v[32:47], v[100:103], v[80:83], v[32:47]
    ds_read_b64_tr_b16 v[88:89], v7 offset:1312
    ds_read_b64_tr_b16 v[90:91], v7 offset:1280
    ds_read_b128 v[96:99], v9 offset:192
    s_waitcnt lgkmcnt(9)
    v_mfma_f32_32x32x16_f16 v[48:63], v[104:107], v[80:83], v[48:63]
    ds_read_b128 v[100:103], v9 offset:320
    s_waitcnt lgkmcnt(9)
    v_mfma_f32_32x32x16_f16 v[64:79], v[108:111], v[80:83], v[64:79]
    ds_read_b128 v[104:107], v9 offset:704
    s_waitcnt lgkmcnt(7)
    v_mfma_f32_32x32x16_f16 v[32:47], v[112:115], v[84:87], v[32:47]
    ds_read_b64_tr_b16 v[92:93], v7 offset:1440
    ds_read_b64_tr_b16 v[94:95], v7 offset:1408
    ds_read_b128 v[108:111], v9 offset:160
    s_waitcnt lgkmcnt(9)
    v_mfma_f32_32x32x16_f16 v[48:63], v[116:119], v[84:87], v[48:63]
    ds_read_b128 v[112:115], v9 offset:288
    s_waitcnt lgkmcnt(9)
    v_mfma_f32_32x32x16_f16 v[64:79], v[120:123], v[84:87], v[64:79]
    ds_read_b128 v[116:119], v9 offset:672
    s_waitcnt lgkmcnt(7)
    v_mfma_f32_32x32x16_f16 v[32:47], v[96:99], v[88:91], v[32:47]
    ds_read_b64_tr_b16 v[80:81], v7 offset:1568
    ds_read_b64_tr_b16 v[82:83], v7 offset:1536
    ds_read_b128 v[120:123], v9 offset:128
    s_waitcnt lgkmcnt(9)
    v_mfma_f32_32x32x16_f16 v[48:63], v[100:103], v[88:91], v[48:63]
    ds_read_b128 v[96:99], v9 offset:256
    s_waitcnt lgkmcnt(9)
    v_mfma_f32_32x32x16_f16 v[64:79], v[104:107], v[88:91], v[64:79]
    ds_read_b128 v[100:103], v9 offset:640
    s_waitcnt lgkmcnt(7)
    v_mfma_f32_32x32x16_f16 v[32:47], v[108:111], v[92:95], v[32:47]
    ds_read_b64_tr_b16 v[84:85], v7 offset:1696
    ds_read_b64_tr_b16 v[86:87], v7 offset:1664
    ds_read_b128 v[104:107], v9 offset:96
    s_waitcnt lgkmcnt(9)
    v_mfma_f32_32x32x16_f16 v[48:63], v[112:115], v[92:95], v[48:63]
    ds_read_b128 v[108:111], v9 offset:224
    s_waitcnt lgkmcnt(9)
    v_mfma_f32_32x32x16_f16 v[64:79], v[116:119], v[92:95], v[64:79]
    ds_read_b128 v[112:115], v9 offset:608
    s_waitcnt lgkmcnt(7)
    v_mfma_f32_32x32x16_f16 v[32:47], v[120:123], v[80:83], v[32:47]
    ds_read_b64_tr_b16 v[88:89], v7 offset:1824
    ds_read_b64_tr_b16 v[90:91], v7 offset:1792
    ds_read_b128 v[116:119], v9 offset:64
    s_waitcnt lgkmcnt(9)
    v_mfma_f32_32x32x16_f16 v[48:63], v[96:99], v[80:83], v[48:63]
    ds_read_b128 v[120:123], v9 offset:192
    s_waitcnt lgkmcnt(9)
    v_mfma_f32_32x32x16_f16 v[64:79], v[100:103], v[80:83], v[64:79]
    ds_read_b128 v[96:99], v9 offset:576
    s_waitcnt lgkmcnt(7)
    v_mfma_f32_32x32x16_f16 v[32:47], v[104:107], v[84:87], v[32:47]
    ds_read_b64_tr_b16 v[92:93], v7 offset:1952
    ds_read_b64_tr_b16 v[94:95], v7 offset:1920
    ds_read_b128 v[100:103], v9 offset:32
    s_waitcnt lgkmcnt(9)
    v_mfma_f32_32x32x16_f16 v[48:63], v[108:111], v[84:87], v[48:63]
    ds_read_b128 v[104:107], v9 offset:160
    s_waitcnt lgkmcnt(9)
    v_mfma_f32_32x32x16_f16 v[64:79], v[112:115], v[84:87], v[64:79]
    ds_read_b128 v[108:111], v9 offset:544
    s_waitcnt lgkmcnt(7)
    v_mfma_f32_32x32x16_f16 v[32:47], v[116:119], v[88:91], v[32:47]
    ds_read_b64_tr_b16 v[80:81], v7 offset:2080
    ds_read_b64_tr_b16 v[82:83], v7 offset:2048
    ds_read_b128 v[112:115], v9 offset:0
    s_waitcnt lgkmcnt(9)
    v_mfma_f32_32x32x16_f16 v[48:63], v[120:123], v[88:91], v[48:63]
    ds_read_b128 v[116:119], v9 offset:128
    s_waitcnt lgkmcnt(9)
    v_mfma_f32_32x32x16_f16 v[64:79], v[96:99], v[88:91], v[64:79]
    ds_read_b128 v[120:123], v9 offset:512
    s_waitcnt lgkmcnt(7)
    v_mfma_f32_32x32x16_f16 v[32:47], v[100:103], v[92:95], v[32:47]
    ds_read_b64_tr_b16 v[84:85], v7 offset:2208
    ds_read_b64_tr_b16 v[86:87], v7 offset:2176
    ds_read_b128 v[96:99], v9 offset:96
    s_waitcnt lgkmcnt(9)
    v_mfma_f32_32x32x16_f16 v[48:63], v[104:107], v[92:95], v[48:63]
    ds_read_b128 v[100:103], v9 offset:480
    s_waitcnt lgkmcnt(9)
    v_mfma_f32_32x32x16_f16 v[64:79], v[108:111], v[92:95], v[64:79]
    ds_read_b64_tr_b16 v[88:89], v7 offset:2336
    ds_read_b64_tr_b16 v[90:91], v7 offset:2304
    ds_read_b128 v[104:107], v9 offset:64
    s_waitcnt lgkmcnt(9)
    v_mfma_f32_32x32x16_f16 v[32:47], v[112:115], v[80:83], v[32:47]
    ds_read_b128 v[108:111], v9 offset:448
    s_waitcnt lgkmcnt(9)
    v_mfma_f32_32x32x16_f16 v[48:63], v[116:119], v[80:83], v[48:63]
    ds_read_b64_tr_b16 v[92:93], v7 offset:2464
    ds_read_b64_tr_b16 v[94:95], v7 offset:2432
    ds_read_b128 v[112:115], v9 offset:32
    s_waitcnt lgkmcnt(11)
    v_mfma_f32_32x32x16_f16 v[64:79], v[120:123], v[80:83], v[64:79]
    ds_read_b128 v[116:119], v9 offset:416
    s_waitcnt lgkmcnt(9)
    v_mfma_f32_32x32x16_f16 v[48:63], v[96:99], v[84:87], v[48:63]
    ds_read_b64_tr_b16 v[80:81], v7 offset:2592
    ds_read_b64_tr_b16 v[82:83], v7 offset:2560
    ds_read_b128 v[120:123], v9 offset:0
    s_waitcnt lgkmcnt(11)
    v_mfma_f32_32x32x16_f16 v[64:79], v[100:103], v[84:87], v[64:79]
    ds_read_b128 v[96:99], v9 offset:384
    s_waitcnt lgkmcnt(9)
    v_mfma_f32_32x32x16_f16 v[48:63], v[104:107], v[88:91], v[48:63]
    ds_read_b64_tr_b16 v[84:85], v7 offset:2720
    ds_read_b64_tr_b16 v[86:87], v7 offset:2688
    ds_read_b128 v[100:103], v9 offset:352
    s_waitcnt lgkmcnt(11)
    v_mfma_f32_32x32x16_f16 v[64:79], v[108:111], v[88:91], v[64:79]
    ds_read_b64_tr_b16 v[88:89], v7 offset:2848
    ds_read_b64_tr_b16 v[90:91], v7 offset:2816
    ds_read_b128 v[104:107], v9 offset:320
    s_waitcnt lgkmcnt(11)
    v_mfma_f32_32x32x16_f16 v[48:63], v[112:115], v[92:95], v[48:63]
    s_waitcnt lgkmcnt(10)
    v_mfma_f32_32x32x16_f16 v[64:79], v[116:119], v[92:95], v[64:79]
    ds_read_b64_tr_b16 v[92:93], v7 offset:2976
    ds_read_b64_tr_b16 v[94:95], v7 offset:2944
    ds_read_b128 v[108:111], v9 offset:288
    s_waitcnt lgkmcnt(10)
    v_mfma_f32_32x32x16_f16 v[48:63], v[120:123], v[80:83], v[48:63]
    s_waitcnt lgkmcnt(9)
    v_mfma_f32_32x32x16_f16 v[64:79], v[96:99], v[80:83], v[64:79]
    ds_read_b64_tr_b16 v[80:81], v7 offset:3104
    ds_read_b64_tr_b16 v[82:83], v7 offset:3072
    ds_read_b128 v[112:115], v9 offset:256
    s_waitcnt lgkmcnt(9)
    v_mfma_f32_32x32x16_f16 v[64:79], v[100:103], v[84:87], v[64:79]
    ds_read_b64_tr_b16 v[84:85], v7 offset:3232
    ds_read_b64_tr_b16 v[86:87], v7 offset:3200
    ds_read_b128 v[116:119], v9 offset:224
    s_waitcnt lgkmcnt(9)
    v_mfma_f32_32x32x16_f16 v[64:79], v[104:107], v[88:91], v[64:79]
    ds_read_b64_tr_b16 v[88:89], v7 offset:3360
    ds_read_b64_tr_b16 v[90:91], v7 offset:3328
    ds_read_b128 v[120:123], v9 offset:192
    s_waitcnt lgkmcnt(9)
    v_mfma_f32_32x32x16_f16 v[64:79], v[108:111], v[92:95], v[64:79]
    ds_read_b64_tr_b16 v[92:93], v7 offset:3488
    ds_read_b64_tr_b16 v[94:95], v7 offset:3456
    ds_read_b128 v[96:99], v9 offset:160
    s_waitcnt lgkmcnt(9)
    v_mfma_f32_32x32x16_f16 v[64:79], v[112:115], v[80:83], v[64:79]
    ds_read_b64_tr_b16 v[80:81], v7 offset:3616
    ds_read_b64_tr_b16 v[82:83], v7 offset:3584
    ds_read_b128 v[100:103], v9 offset:128
    s_waitcnt lgkmcnt(9)
    v_mfma_f32_32x32x16_f16 v[64:79], v[116:119], v[84:87], v[64:79]
    ds_read_b64_tr_b16 v[84:85], v7 offset:3744
    ds_read_b64_tr_b16 v[86:87], v7 offset:3712
    ds_read_b128 v[104:107], v9 offset:96
    s_waitcnt lgkmcnt(9)
    v_mfma_f32_32x32x16_f16 v[64:79], v[120:123], v[88:91], v[64:79]
    ds_read_b64_tr_b16 v[88:89], v7 offset:3872
    ds_read_b64_tr_b16 v[90:91], v7 offset:3840
    ds_read_b128 v[108:111], v9 offset:64
    s_waitcnt lgkmcnt(9)
    v_mfma_f32_32x32x16_f16 v[64:79], v[96:99], v[92:95], v[64:79]
    ds_read_b64_tr_b16 v[92:93], v7 offset:4000
    ds_read_b64_tr_b16 v[94:95], v7 offset:3968
    ds_read_b128 v[112:115], v9 offset:32
    s_waitcnt lgkmcnt(9)
    v_mfma_f32_32x32x16_f16 v[64:79], v[100:103], v[80:83], v[64:79]
    ds_read_b64_tr_b16 v[80:81], v7 offset:4128
    ds_read_b64_tr_b16 v[82:83], v7 offset:4096
    ds_read_b128 v[116:119], v9 offset:0
    s_waitcnt lgkmcnt(9)
    v_mfma_f32_32x32x16_f16 v[64:79], v[104:107], v[84:87], v[64:79]
    s_waitcnt lgkmcnt(6)
    v_mfma_f32_32x32x16_f16 v[64:79], v[108:111], v[88:91], v[64:79]
    s_waitcnt lgkmcnt(3)
    v_mfma_f32_32x32x16_f16 v[64:79], v[112:115], v[92:95], v[64:79]
    s_waitcnt lgkmcnt(0)
    v_mfma_f32_32x32x16_f16 v[64:79], v[116:119], v[80:83], v[64:79]
    s_nop 11
    v_mov_b32 v80, v31
    v_add_f32_dpp v81, v31, v30 wave_shr:1 row_mask:0xf bank_mask:0xf bound_ctrl:0
    v_mov_b32 v84, v47
    v_add_f32_dpp v85, v47, v46 wave_shr:1 row_mask:0xf bank_mask:0xf bound_ctrl:0
    v_mov_b32 v88, v63
    v_add_f32_dpp v89, v63, v62 wave_shr:1 row_mask:0xf bank_mask:0xf bound_ctrl:0
    v_mov_b32 v92, v79
    v_add_f32_dpp v93, v79, v78 wave_shr:1 row_mask:0xf bank_mask:0xf bound_ctrl:0
    v_add_f32_dpp v82, v81, v29 wave_shr:1 row_mask:0xf bank_mask:0xf bound_ctrl:0
    v_add_f32_dpp v86, v85, v45 wave_shr:1 row_mask:0xf bank_mask:0xf bound_ctrl:0
    v_add_f32_dpp v90, v89, v61 wave_shr:1 row_mask:0xf bank_mask:0xf bound_ctrl:0
    v_add_f32_dpp v94, v93, v77 wave_shr:1 row_mask:0xf bank_mask:0xf bound_ctrl:0
    s_mov_b32 s44, 0
    s_mov_b32 s45, 0x80000000
    s_mov_b64 exec, s[44:45]
    ds_write_b128 v11, v[80:83] offset:0
    ds_write_b128 v11, v[84:87] offset:48
    ds_write_b128 v11, v[88:91] offset:64
    ds_write_b128 v11, v[92:95] offset:112
    s_mov_b64 exec, -1
    s_add_u32 s37, s38, 160840
    v_mov_b32 v124, s37
    v_mov_b32 v125, 1
    s_mov_b64 exec, 1
    ds_add_u32 v124, v125
    s_mov_b64 exec, -1
    v_lshlrev_b32 v10, 2, v1
    v_sub_u32 v10, v11, v10
    v_add_f32_dpp v18, v19, v18 wave_shr:1 row_mask:0xf bank_mask:0xf bound_ctrl:0
    v_add_f32_dpp v34, v35, v34 wave_shr:1 row_mask:0xf bank_mask:0xf bound_ctrl:0
    v_add_f32_dpp v50, v51, v50 wave_shr:1 row_mask:0xf bank_mask:0xf bound_ctrl:0
    v_add_f32_dpp v66, v67, v66 wave_shr:1 row_mask:0xf bank_mask:0xf bound_ctrl:0
    v_add_f32_dpp v17, v18, v17 wave_shr:1 row_mask:0xf bank_mask:0xf bound_ctrl:0
    v_add_f32_dpp v33, v34, v33 wave_shr:1 row_mask:0xf bank_mask:0xf bound_ctrl:0
    v_add_f32_dpp v49, v50, v49 wave_shr:1 row_mask:0xf bank_mask:0xf bound_ctrl:0
    v_add_f32_dpp v65, v66, v65 wave_shr:1 row_mask:0xf bank_mask:0xf bound_ctrl:0
    v_add_f32_dpp v16, v17, v16 wave_shr:1 row_mask:0xf bank_mask:0xf bound_ctrl:0
    v_add_f32_dpp v32, v33, v32 wave_shr:1 row_mask:0xf bank_mask:0xf bound_ctrl:0
    v_add_f32_dpp v48, v49, v48 wave_shr:1 row_mask:0xf bank_mask:0xf bound_ctrl:0
    v_add_f32_dpp v64, v65, v64 wave_shr:1 row_mask:0xf bank_mask:0xf bound_ctrl:0
    v_cndmask_b32 v112, v23, v19, s[44:45]
    v_cndmask_b32 v113, v39, v35, s[44:45]
    v_cndmask_b32 v114, v55, v51, s[44:45]
    v_cndmask_b32 v115, v71, v67, s[44:45]
    v_add_f32_dpp v22, v112, v22 wave_ror:1 row_mask:0xf bank_mask:0xf
    v_add_f32_dpp v38, v113, v38 wave_ror:1 row_mask:0xf bank_mask:0xf
    v_add_f32_dpp v54, v114, v54 wave_ror:1 row_mask:0xf bank_mask:0xf
    v_add_f32_dpp v70, v115, v70 wave_ror:1 row_mask:0xf bank_mask:0xf
    v_cndmask_b32 v112, v22, v18, s[44:45]
    v_cndmask_b32 v113, v38, v34, s[44:45]
    v_cndmask_b32 v114, v54, v50, s[44:45]
    v_cndmask_b32 v115, v70, v66, s[44:45]
    v_add_f32_dpp v21, v112, v21 wave_ror:1 row_mask:0xf bank_mask:0xf
    v_add_f32_dpp v37, v113, v37 wave_ror:1 row_mask:0xf bank_mask:0xf
    v_add_f32_dpp v53, v114, v53 wave_ror:1 row_mask:0xf bank_mask:0xf
    v_add_f32_dpp v69, v115, v69 wave_ror:1 row_mask:0xf bank_mask:0xf
    v_cndmask_b32 v112, v21, v17, s[44:45]
    v_cndmask_b32 v113, v37, v33, s[44:45]
    v_cndmask_b32 v114, v53, v49, s[44:45]
    v_cndmask_b32 v115, v69, v65, s[44:45]
    v_add_f32_dpp v20, v112, v20 wave_ror:1 row_mask:0xf bank_mask:0xf
    v_add_f32_dpp v36, v113, v36 wave_ror:1 row_mask:0xf bank_mask:0xf
    v_add_f32_dpp v52, v114, v52 wave_ror:1 row_mask:0xf bank_mask:0xf
    v_add_f32_dpp v68, v115, v68 wave_ror:1 row_mask:0xf bank_mask:0xf
    v_cndmask_b32 v112, v27, v23, s[44:45]
    v_cndmask_b32 v113, v43, v39, s[44:45]
    v_cndmask_b32 v114, v59, v55, s[44:45]
    v_cndmask_b32 v115, v75, v71, s[44:45]
    v_add_f32_dpp v26, v112, v26 wave_ror:1 row_mask:0xf bank_mask:0xf
    v_add_f32_dpp v42, v113, v42 wave_ror:1 row_mask:0xf bank_mask:0xf
    v_add_f32_dpp v58, v114, v58 wave_ror:1 row_mask:0xf bank_mask:0xf
    v_add_f32_dpp v74, v115, v74 wave_ror:1 row_mask:0xf bank_mask:0xf
    v_cndmask_b32 v112, v26, v22, s[44:45]
    v_cndmask_b32 v113, v42, v38, s[44:45]
    v_cndmask_b32 v114, v58, v54, s[44:45]
    v_cndmask_b32 v115, v74, v70, s[44:45]
    v_add_f32_dpp v25, v112, v25 wave_ror:1 row_mask:0xf bank_mask:0xf
    v_add_f32_dpp v41, v113, v41 wave_ror:1 row_mask:0xf bank_mask:0xf
    v_add_f32_dpp v57, v114, v57 wave_ror:1 row_mask:0xf bank_mask:0xf
    v_add_f32_dpp v73, v115, v73 wave_ror:1 row_mask:0xf bank_mask:0xf
    v_cndmask_b32 v112, v25, v21, s[44:45]
    v_cndmask_b32 v113, v41, v37, s[44:45]
    v_cndmask_b32 v114, v57, v53, s[44:45]
    v_cndmask_b32 v115, v73, v69, s[44:45]
    v_add_f32_dpp v24, v112, v24 wave_ror:1 row_mask:0xf bank_mask:0xf
    v_add_f32_dpp v40, v113, v40 wave_ror:1 row_mask:0xf bank_mask:0xf
    v_add_f32_dpp v56, v114, v56 wave_ror:1 row_mask:0xf bank_mask:0xf
    v_add_f32_dpp v72, v115, v72 wave_ror:1 row_mask:0xf bank_mask:0xf
    v_cndmask_b32 v112, v31, v27, s[44:45]
    v_cndmask_b32 v113, v47, v43, s[44:45]
    v_cndmask_b32 v114, v63, v59, s[44:45]
    v_cndmask_b32 v115, v79, v75, s[44:45]
    v_add_f32_dpp v30, v112, v30 wave_ror:1 row_mask:0xf bank_mask:0xf
    v_add_f32_dpp v46, v113, v46 wave_ror:1 row_mask:0xf bank_mask:0xf
    v_add_f32_dpp v62, v114, v62 wave_ror:1 row_mask:0xf bank_mask:0xf
    v_add_f32_dpp v78, v115, v78 wave_ror:1 row_mask:0xf bank_mask:0xf
    v_cndmask_b32 v112, v30, v26, s[44:45]
    v_cndmask_b32 v113, v46, v42, s[44:45]
    v_cndmask_b32 v114, v62, v58, s[44:45]
    v_cndmask_b32 v115, v78, v74, s[44:45]
    v_add_f32_dpp v29, v112, v29 wave_ror:1 row_mask:0xf bank_mask:0xf
    v_add_f32_dpp v45, v113, v45 wave_ror:1 row_mask:0xf bank_mask:0xf
    v_add_f32_dpp v61, v114, v61 wave_ror:1 row_mask:0xf bank_mask:0xf
    v_add_f32_dpp v77, v115, v77 wave_ror:1 row_mask:0xf bank_mask:0xf
    v_cndmask_b32 v112, v29, v25, s[44:45]
    v_cndmask_b32 v113, v45, v41, s[44:45]
    v_cndmask_b32 v114, v61, v57, s[44:45]
    v_cndmask_b32 v115, v77, v73, s[44:45]
    v_add_f32_dpp v28, v112, v28 wave_ror:1 row_mask:0xf bank_mask:0xf
    v_add_f32_dpp v44, v113, v44 wave_ror:1 row_mask:0xf bank_mask:0xf
    v_add_f32_dpp v60, v114, v60 wave_ror:1 row_mask:0xf bank_mask:0xf
    v_add_f32_dpp v76, v115, v76 wave_ror:1 row_mask:0xf bank_mask:0xf
    v_mov_b32 v124, s37
    s_mov_b32 s50, 0
ps_8:
    ds_read_b32 v125, v124
    s_waitcnt lgkmcnt(0)
    v_readfirstlane_b32 s36, v125
    s_cmp_ge_u32 s36, 2
    s_cbranch_scc1 ps_8_ok
    s_add_u32 s50, s50, 1
    s_cmp_ge_u32 s50, 1600000
    s_cbranch_scc1 ps_8_ok
    s_sleep 0
    s_branch ps_8
ps_8_ok:
    s_mov_b64 exec, 7
    ds_read_b32 v97, v10 offset:40
    ds_read_b32 v98, v10 offset:56
    ds_read_b32 v99, v10 offset:104
    s_mov_b64 exec, -1
    v_mul_f32 v116, v20, v127
    v_mul_f32 v117, v36, v127
    v_mul_f32 v118, v52, v127
    v_mul_f32 v119, v68, v127
    v_cvt_pk_bf16_f32 v82, v116, v117
    ds_write_b16 v12, v82 offset:128
    ds_write_b16_d16_hi v12, v82 offset:1664
    v_cvt_pk_bf16_f32 v83, v118, v119
    ds_write_b16 v12, v83 offset:2176
    ds_write_b16_d16_hi v12, v83 offset:3712
    v_mul_f32 v116, v24, v127
    v_mul_f32 v117, v40, v127
    v_mul_f32 v118, v56, v127
    v_mul_f32 v119, v72, v127
    v_cvt_pk_bf16_f32 v84, v116, v117
    ds_write_b16 v12, v84 offset:256
    ds_write_b16_d16_hi v12, v84 offset:1792
    v_cvt_pk_bf16_f32 v85, v118, v119
    ds_write_b16 v12, v85 offset:2304
    ds_write_b16_d16_hi v12, v85 offset:3840
    v_mul_f32 v116, v28, v127
    v_mul_f32 v117, v44, v127
    v_mul_f32 v118, v60, v127
    v_mul_f32 v119, v76, v127
    v_cvt_pk_bf16_f32 v86, v116, v117
    ds_write_b16 v12, v86 offset:384
    ds_write_b16_d16_hi v12, v86 offset:1920
    v_cvt_pk_bf16_f32 v87, v118, v119
    ds_write_b16 v12, v87 offset:2432
    ds_write_b16_d16_hi v12, v87 offset:3968
    s_waitcnt lgkmcnt(12)
    s_mov_b64 exec, 7
    v_add_f32 v32, v32, v97
    v_add_f32 v48, v48, v98
    v_add_f32 v64, v64, v99
    s_mov_b64 exec, -1
    v_mul_f32 v116, v16, v127
    v_mul_f32 v117, v32, v127
    v_mul_f32 v118, v48, v127
    v_mul_f32 v119, v64, v127
    v_cvt_pk_bf16_f32 v80, v116, v117
    ds_write_b16 v12, v80 offset:0
    ds_write_b16_d16_hi v12, v80 offset:1536
    v_cvt_pk_bf16_f32 v81, v118, v119
    ds_write_b16 v12, v81 offset:2048
    ds_write_b16_d16_hi v12, v81 offset:3584
    v_mul_u32_u24 v112, 1536, v3
    v_add_u32 v112, v112, v2
    ds_read_b128 v[116:119], v112 offset:0
    v_mul_u32_u24 v113, 688128, v3
    v_add_u32 v113, v113, v14
    s_add_u32 s44, s39, 0
    v_mul_u32_u24 v112, 1536, v3
    v_add_u32 v112, v112, v2
    ds_read_b128 v[120:123], v112 offset:2048
    v_mul_u32_u24 v114, 688128, v3
    v_add_u32 v114, v114, v14
    s_add_u32 s45, s39, 917504
    s_branch cvE_6
cvY_5:
    ds_read_b64_tr_b16 v[80:81], v7 offset:32
    ds_read_b64_tr_b16 v[82:83], v7 offset:0
    ds_read_b128 v[96:99], v9 offset:256
    ds_read_b128 v[100:103], v9 offset:384
    ds_read_b128 v[104:107], v9 offset:768
    ds_read_b128 v[108:111], v9 offset:896
    ds_read_b64_tr_b16 v[84:85], v7 offset:160
    ds_read_b64_tr_b16 v[86:87], v7 offset:128
    ds_read_b128 v[112:115], v9 offset:224
    ds_read_b128 v[116:119], v9 offset:352
    s_waitcnt lgkmcnt(7)
    v_mfma_f32_32x32x16_f16 v[16:31], v[96:99], v[80:83], 0
    ds_read_b128 v[120:123], v9 offset:736
    s_waitcnt lgkmcnt(7)
    v_mfma_f32_32x32x16_f16 v[32:47], v[100:103], v[80:83], 0
    ds_read_b128 v[96:99], v9 offset:864
    s_waitcnt lgkmcnt(7)
    v_mfma_f32_32x32x16_f16 v[48:63], v[104:107], v[80:83], 0
    ds_read_b64_tr_b16 v[88:89], v7 offset:288
    ds_read_b64_tr_b16 v[90:91], v7 offset:256
    ds_read_b128 v[100:103], v9 offset:192
    s_waitcnt lgkmcnt(9)
    v_mfma_f32_32x32x16_f16 v[64:79], v[108:111], v[80:83], 0
    ds_read_b128 v[104:107], v9 offset:320
    s_waitcnt lgkmcnt(7)
    v_mfma_f32_32x32x16_f16 v[16:31], v[112:115], v[84:87], v[16:31]
    ds_read_b128 v[108:111], v9 offset:704
    s_waitcnt lgkmcnt(7)
    v_mfma_f32_32x32x16_f16 v[32:47], v[116:119], v[84:87], v[32:47]
    ds_read_b128 v[112:115], v9 offset:832
    s_waitcnt lgkmcnt(7)
    v_mfma_f32_32x32x16_f16 v[48:63], v[120:123], v[84:87], v[48:63]
    ds_read_b64_tr_b16 v[92:93], v7 offset:416
    ds_read_b64_tr_b16 v[94:95], v7 offset:384
    ds_read_b128 v[116:119], v9 offset:160
    s_waitcnt lgkmcnt(9)
    v_mfma_f32_32x32x16_f16 v[64:79], v[96:99], v[84:87], v[64:79]
    ds_read_b128 v[120:123], v9 offset:288
    s_waitcnt lgkmcnt(7)
    v_mfma_f32_32x32x16_f16 v[16:31], v[100:103], v[88:91], v[16:31]
    ds_read_b128 v[96:99], v9 offset:672
    s_waitcnt lgkmcnt(7)
    v_mfma_f32_32x32x16_f16 v[32:47], v[104:107], v[88:91], v[32:47]
    ds_read_b128 v[100:103], v9 offset:800
    s_waitcnt lgkmcnt(7)
    v_mfma_f32_32x32x16_f16 v[48:63], v[108:111], v[88:91], v[48:63]
    ds_read_b64_tr_b16 v[80:81], v7 offset:544
    ds_read_b64_tr_b16 v[82:83], v7 offset:512
    ds_read_b128 v[104:107], v9 offset:128
    s_waitcnt lgkmcnt(9)
    v_mfma_f32_32x32x16_f16 v[64:79], v[112:115], v[88:91], v[64:79]
    ds_read_b128 v[108:111], v9 offset:256
    s_waitcnt lgkmcnt(7)
    v_mfma_f32_32x32x16_f16 v[16:31], v[116:119], v[92:95], v[16:31]
    s_waitcnt vmcnt(0)
    v_mov_b32 v124, 160864
    v_mov_b32 v125, 1
    s_mov_b64 exec, 1
    ds_add_rtn_u32 v126, v124, v125
    s_mov_b64 exec, -1
    ds_read_b128 v[112:115], v9 offset:640
    s_waitcnt lgkmcnt(8)
    v_mfma_f32_32x32x16_f16 v[32:47], v[120:123], v[92:95], v[32:47]
    ds_read_b128 v[116:119], v9 offset:768
    s_waitcnt lgkmcnt(8)
    v_mfma_f32_32x32x16_f16 v[48:63], v[96:99], v[92:95], v[48:63]
    ds_read_b64_tr_b16 v[84:85], v7 offset:672
    ds_read_b64_tr_b16 v[86:87], v7 offset:640
    ds_read_b128 v[120:123], v9 offset:96
    s_waitcnt lgkmcnt(10)
    v_mfma_f32_32x32x16_f16 v[64:79], v[100:103], v[92:95], v[64:79]
    s_waitcnt lgkmcnt(5)
    v_readfirstlane_b32 s36, v126
    s_cmp_lg_u32 s36, 3
    s_cbranch_scc1 hf_9
    s_mul_i32 s36, s28, 896
    s_add_u32 s36, s36, s29
    s_lshl_b32 s36, s36, 2
    s_add_u32 s36, s36, 4096
    v_lshl_add_u32 v124, v1, 8, s36
    s_mov_b64 exec, 0x3fff
    buffer_store_dword v125, v124, s[8:11], 0 offen sc1
    s_mov_b64 exec, -1
hf_9:
    ds_read_b128 v[96:99], v9 offset:224
    s_waitcnt lgkmcnt(8)
    v_mfma_f32_32x32x16_f16 v[16:31], v[104:107], v[80:83], v[16:31]
    ds_read_b128 v[100:103], v9 offset:608
    s_waitcnt lgkmcnt(8)
    v_mfma_f32_32x32x16_f16 v[32:47], v[108:111], v[80:83], v[32:47]
    ds_read_b128 v[104:107], v9 offset:736
    s_waitcnt lgkmcnt(7)
    v_mfma_f32_32x32x16_f16 v[48:63], v[112:115], v[80:83], v[48:63]
    ds_read_b64_tr_b16 v[88:89], v7 offset:800
    ds_read_b64_tr_b16 v[90:91], v7 offset:768
    ds_read_b128 v[108:111], v9 offset:64
    s_waitcnt lgkmcnt(9)
    v_mfma_f32_32x32x16_f16 v[64:79], v[116:119], v[80:83], v[64:79]
    ds_read_b128 v[112:115], v9 offset:192
    s_waitcnt lgkmcnt(7)
    v_mfma_f32_32x32x16_f16 v[16:31], v[120:123], v[84:87], v[16:31]
    ds_read_b128 v[116:119], v9 offset:576
    s_waitcnt lgkmcnt(7)
    v_mfma_f32_32x32x16_f16 v[32:47], v[96:99], v[84:87], v[32:47]
    ds_read_b128 v[120:123], v9 offset:704
    s_waitcnt lgkmcnt(7)
    v_mfma_f32_32x32x16_f16 v[48:63], v[100:103], v[84:87], v[48:63]
    ds_read_b64_tr_b16 v[92:93], v7 offset:928
    ds_read_b64_tr_b16 v[94:95], v7 offset:896
    ds_read_b128 v[96:99], v9 offset:32
    s_waitcnt lgkmcnt(9)
    v_mfma_f32_32x32x16_f16 v[64:79], v[104:107], v[84:87], v[64:79]
    ds_read_b128 v[100:103], v9 offset:160
    s_waitcnt lgkmcnt(7)
    v_mfma_f32_32x32x16_f16 v[16:31], v[108:111], v[88:91], v[16:31]
    ds_read_b128 v[104:107], v9 offset:544
    s_waitcnt lgkmcnt(7)
    v_mfma_f32_32x32x16_f16 v[32:47], v[112:115], v[88:91], v[32:47]
    ds_read_b128 v[108:111], v9 offset:672
    s_waitcnt lgkmcnt(7)
    v_mfma_f32_32x32x16_f16 v[48:63], v[116:119], v[88:91], v[48:63]
    ds_read_b64_tr_b16 v[80:81], v7 offset:1056
    ds_read_b64_tr_b16 v[82:83], v7 offset:1024
    ds_read_b128 v[112:115], v9 offset:0
    s_waitcnt lgkmcnt(9)
    v_mfma_f32_32x32x16_f16 v[64:79], v[120:123], v[88:91], v[64:79]
    ds_read_b128 v[116:119], v9 offset:128
    s_waitcnt lgkmcnt(7)
    v_mfma_f32_32x32x16_f16 v[16:31], v[96:99], v[92:95], v[16:31]
    ds_read_b128 v[120:123], v9 offset:512
    s_waitcnt lgkmcnt(7)
    v_mfma_f32_32x32x16_f16 v[32:47], v[100:103], v[92:95], v[32:47]
    ds_read_b128 v[96:99], v9 offset:640
    s_waitcnt lgkmcnt(7)
    v_mfma_f32_32x32x16_f16 v[48:63], v[104:107], v[92:95], v[48:63]
    ds_read_b64_tr_b16 v[84:85], v7 offset:1184
    ds_read_b64_tr_b16 v[86:87], v7 offset:1152
    ds_read_b128 v[100:103], v9 offset:96
    s_waitcnt lgkmcnt(9)
    v_mfma_f32_32x32x16_f16 v[64:79], v[108:111], v[92:95], v[64:79]
    ds_read_b128 v[104:107], v9 offset:480
    s_waitcnt lgkmcnt(7)
    v_mfma_f32_32x32x16_f16 v[16:31], v[112:115], v[80:83], v[16:31]
    ds_read_b128 v[108:111], v9 offset:608
    s_waitcnt lgkmcnt(7)
    v_mfma_f32_32x32x16_f16 v[32:47], v[116:119], v[80:83], v[32:47]
    ds_read_b64_tr_b16 v[88:89], v7 offset:1312
    ds_read_b64_tr_b16 v[90:91], v7 offset:1280
    ds_read_b128 v[112:115], v9 offset:64
    s_waitcnt lgkmcnt(9)
    v_mfma_f32_32x32x16_f16 v[48:63], v[120:123], v[80:83], v[48:63]
    ds_read_b128 v[116:119], v9 offset:448
    s_waitcnt lgkmcnt(9)
    v_mfma_f32_32x32x16_f16 v[64:79], v[96:99], v[80:83], v[64:79]
    ds_read_b128 v[120:123], v9 offset:576
    s_waitcnt lgkmcnt(7)
    v_mfma_f32_32x32x16_f16 v[32:47], v[100:103], v[84:87], v[32:47]
    ds_read_b64_tr_b16 v[92:93], v7 offset:1440
    ds_read_b64_tr_b16 v[94:95], v7 offset:1408
    ds_read_b128 v[96:99], v9 offset:32
    s_waitcnt lgkmcnt(9)
    v_mfma_f32_32x32x16_f16 v[48:63], v[104:107], v[84:87], v[48:63]
    ds_read_b128 v[100:103], v9 offset:416
    s_waitcnt lgkmcnt(9)
    v_mfma_f32_32x32x16_f16 v[64:79], v[108:111], v[84:87], v[64:79]
    ds_read_b128 v[104:107], v9 offset:544
    s_waitcnt lgkmcnt(7)
    v_mfma_f32_32x32x16_f16 v[32:47], v[112:115], v[88:91], v[32:47]
    ds_read_b64_tr_b16 v[80:81], v7 offset:1568
    ds_read_b64_tr_b16 v[82:83], v7 offset:1536
    ds_read_b128 v[108:111], v9 offset:0
    s_waitcnt lgkmcnt(9)
    v_mfma_f32_32x32x16_f16 v[48:63], v[116:119], v[88:91], v[48:63]
    ds_read_b128 v[112:115], v9 offset:384
    s_waitcnt lgkmcnt(9)
    v_mfma_f32_32x32x16_f16 v[64:79], v[120:123], v[88:91], v[64:79]
    ds_read_b128 v[116:119], v9 offset:512
    s_waitcnt lgkmcnt(7)
    v_mfma_f32_32x32x16_f16 v[32:47], v[96:99], v[92:95], v[32:47]
    ds_read_b64_tr_b16 v[84:85], v7 offset:1696
    ds_read_b64_tr_b16 v[86:87], v7 offset:1664
    ds_read_b128 v[120:123], v9 offset:352
    s_waitcnt lgkmcnt(9)
    v_mfma_f32_32x32x16_f16 v[48:63], v[100:103], v[92:95], v[48:63]
    ds_read_b128 v[96:99], v9 offset:480
    s_waitcnt lgkmcnt(9)
    v_mfma_f32_32x32x16_f16 v[64:79], v[104:107], v[92:95], v[64:79]
    ds_read_b64_tr_b16 v[88:89], v7 offset:1824
    ds_read_b64_tr_b16 v[90:91], v7 offset:1792
    ds_read_b128 v[100:103], v9 offset:320
    s_waitcnt lgkmcnt(9)
    v_mfma_f32_32x32x16_f16 v[32:47], v[108:111], v[80:83], v[32:47]
    ds_read_b128 v[104:107], v9 offset:448
    s_waitcnt lgkmcnt(9)
    v_mfma_f32_32x32x16_f16 v[48:63], v[112:115], v[80:83], v[48:63]
    ds_read_b64_tr_b16 v[92:93], v7 offset:1952
    ds_read_b64_tr_b16 v[94:95], v7 offset:1920
    ds_read_b128 v[108:111], v9 offset:288
    s_waitcnt lgkmcnt(11)
    v_mfma_f32_32x32x16_f16 v[64:79], v[116:119], v[80:83], v[64:79]
    ds_read_b128 v[112:115], v9 offset:416
    s_waitcnt lgkmcnt(9)
    v_mfma_f32_32x32x16_f16 v[48:63], v[120:123], v[84:87], v[48:63]
    ds_read_b64_tr_b16 v[80:81], v7 offset:2080
    ds_read_b64_tr_b16 v[82:83], v7 offset:2048
    ds_read_b128 v[116:119], v9 offset:256
    s_waitcnt lgkmcnt(11)
    v_mfma_f32_32x32x16_f16 v[64:79], v[96:99], v[84:87], v[64:79]
    ds_read_b128 v[120:123], v9 offset:384
    s_waitcnt lgkmcnt(9)
    v_mfma_f32_32x32x16_f16 v[48:63], v[100:103], v[88:91], v[48:63]
    ds_read_b64_tr_b16 v[84:85], v7 offset:2208
    ds_read_b64_tr_b16 v[86:87], v7 offset:2176
    ds_read_b128 v[96:99], v9 offset:224
    s_waitcnt lgkmcnt(11)
    v_mfma_f32_32x32x16_f16 v[64:79], v[104:107], v[88:91], v[64:79]
    ds_read_b128 v[100:103], v9 offset:352
    s_waitcnt lgkmcnt(9)
    v_mfma_f32_32x32x16_f16 v[48:63], v[108:111], v[92:95], v[48:63]
    ds_read_b64_tr_b16 v[88:89], v7 offset:2336
    ds_read_b64_tr_b16 v[90:91], v7 offset:2304
    ds_read_b128 v[104:107], v9 offset:192
    s_waitcnt lgkmcnt(11)
    v_mfma_f32_32x32x16_f16 v[64:79], v[112:115], v[92:95], v[64:79]
    ds_read_b128 v[108:111], v9 offset:320
    s_waitcnt lgkmcnt(9)
    v_mfma_f32_32x32x16_f16 v[48:63], v[116:119], v[80:83], v[48:63]
    ds_read_b64_tr_b16 v[92:93], v7 offset:2464
    ds_read_b64_tr_b16 v[94:95], v7 offset:2432
    ds_read_b128 v[112:115], v9 offset:160
    s_waitcnt lgkmcnt(11)
    v_mfma_f32_32x32x16_f16 v[64:79], v[120:123], v[80:83], v[64:79]
    ds_read_b128 v[116:119], v9 offset:288
    s_waitcnt lgkmcnt(9)
    v_mfma_f32_32x32x16_f16 v[48:63], v[96:99], v[84:87], v[48:63]
    ds_read_b64_tr_b16 v[80:81], v7 offset:2592
    ds_read_b64_tr_b16 v[82:83], v7 offset:2560
    ds_read_b128 v[120:123], v9 offset:128
    s_waitcnt lgkmcnt(11)
    v_mfma_f32_32x32x16_f16 v[64:79], v[100:103], v[84:87], v[64:79]
    ds_read_b128 v[96:99], v9 offset:256
    s_waitcnt lgkmcnt(9)
    v_mfma_f32_32x32x16_f16 v[48:63], v[104:107], v[88:91], v[48:63]
    ds_read_b64_tr_b16 v[84:85], v7 offset:2720
    ds_read_b64_tr_b16 v[86:87], v7 offset:2688
    ds_read_b128 v[100:103], v9 offset:96
    s_waitcnt lgkmcnt(11)
    v_mfma_f32_32x32x16_f16 v[64:79], v[108:111], v[88:91], v[64:79]
    ds_read_b128 v[104:107], v9 offset:224
    s_waitcnt lgkmcnt(9)
    v_mfma_f32_32x32x16_f16 v[48:63], v[112:115], v[92:95], v[48:63]
    ds_read_b64_tr_b16 v[88:89], v7 offset:2848
    ds_read_b64_tr_b16 v[90:91], v7 offset:2816
    ds_read_b128 v[108:111], v9 offset:64
    s_waitcnt lgkmcnt(11)
    v_mfma_f32_32x32x16_f16 v[64:79], v[116:119], v[92:95], v[64:79]
    ds_read_b128 v[112:115], v9 offset:192
    s_waitcnt lgkmcnt(9)
    v_mfma_f32_32x32x16_f16 v[48:63], v[120:123], v[80:83], v[48:63]
    ds_read_b64_tr_b16 v[92:93], v7 offset:2976
    ds_read_b64_tr_b16 v[94:95], v7 offset:2944
    ds_read_b128 v[116:119], v9 offset:32
    s_waitcnt lgkmcnt(11)
    v_mfma_f32_32x32x16_f16 v[64:79], v[96:99], v[80:83], v[64:79]
    ds_read_b128 v[120:123], v9 offset:160
    s_waitcnt lgkmcnt(9)
    v_mfma_f32_32x32x16_f16 v[48:63], v[100:103], v[84:87], v[48:63]
    ds_read_b64_tr_b16 v[80:81], v7 offset:3104
    ds_read_b64_tr_b16 v[82:83], v7 offset:3072
    ds_read_b128 v[96:99], v9 offset:0
    s_waitcnt lgkmcnt(11)
    v_mfma_f32_32x32x16_f16 v[64:79], v[104:107], v[84:87], v[64:79]
    ds_read_b128 v[100:103], v9 offset:128
    s_waitcnt lgkmcnt(9)
    v_mfma_f32_32x32x16_f16 v[48:63], v[108:111], v[88:91], v[48:63]
    ds_read_b64_tr_b16 v[84:85], v7 offset:3232
    ds_read_b64_tr_b16 v[86:87], v7 offset:3200
    ds_read_b128 v[104:107], v9 offset:96
    s_waitcnt lgkmcnt(11)
    v_mfma_f32_32x32x16_f16 v[64:79], v[112:115], v[88:91], v[64:79]
    ds_read_b64_tr_b16 v[88:89], v7 offset:3360
    ds_read_b64_tr_b16 v[90:91], v7 offset:3328
    ds_read_b128 v[108:111], v9 offset:64
    s_waitcnt lgkmcnt(11)
    v_mfma_f32_32x32x16_f16 v[48:63], v[116:119], v[92:95], v[48:63]
    s_waitcnt lgkmcnt(10)
    v_mfma_f32_32x32x16_f16 v[64:79], v[120:123], v[92:95], v[64:79]
    ds_read_b64_tr_b16 v[92:93], v7 offset:3488
    ds_read_b64_tr_b16 v[94:95], v7 offset:3456
    ds_read_b128 v[112:115], v9 offset:32
    s_waitcnt lgkmcnt(10)
    v_mfma_f32_32x32x16_f16 v[48:63], v[96:99], v[80:83], v[48:63]
    s_waitcnt lgkmcnt(9)
    v_mfma_f32_32x32x16_f16 v[64:79], v[100:103], v[80:83], v[64:79]
    ds_read_b64_tr_b16 v[80:81], v7 offset:3616
    ds_read_b64_tr_b16 v[82:83], v7 offset:3584
    ds_read_b128 v[116:119], v9 offset:0
    s_waitcnt lgkmcnt(9)
    v_mfma_f32_32x32x16_f16 v[64:79], v[104:107], v[84:87], v[64:79]
    s_waitcnt lgkmcnt(6)
    v_mfma_f32_32x32x16_f16 v[64:79], v[108:111], v[88:91], v[64:79]
    s_waitcnt lgkmcnt(3)
    v_mfma_f32_32x32x16_f16 v[64:79], v[112:115], v[92:95], v[64:79]
    s_waitcnt lgkmcnt(0)
    v_mfma_f32_32x32x16_f16 v[64:79], v[116:119], v[80:83], v[64:79]
    s_nop 11
    v_mov_b32 v80, v31
    v_add_f32_dpp v81, v31, v30 wave_shr:1 row_mask:0xf bank_mask:0xf bound_ctrl:0
    v_mov_b32 v84, v47
    v_add_f32_dpp v85, v47, v46 wave_shr:1 row_mask:0xf bank_mask:0xf bound_ctrl:0
    v_mov_b32 v88, v63
    v_add_f32_dpp v89, v63, v62 wave_shr:1 row_mask:0xf bank_mask:0xf bound_ctrl:0
    v_mov_b32 v92, v79
    v_add_f32_dpp v93, v79, v78 wave_shr:1 row_mask:0xf bank_mask:0xf bound_ctrl:0
    v_add_f32_dpp v82, v81, v29 wave_shr:1 row_mask:0xf bank_mask:0xf bound_ctrl:0
    v_add_f32_dpp v86, v85, v45 wave_shr:1 row_mask:0xf bank_mask:0xf bound_ctrl:0
    v_add_f32_dpp v90, v89, v61 wave_shr:1 row_mask:0xf bank_mask:0xf bound_ctrl:0
    v_add_f32_dpp v94, v93, v77 wave_shr:1 row_mask:0xf bank_mask:0xf bound_ctrl:0
    s_mov_b32 s44, 0
    s_mov_b32 s45, 0x80000000
    s_mov_b64 exec, s[44:45]
    ds_write_b128 v11, v[80:83] offset:16
    ds_write_b128 v11, v[84:87] offset:32
    ds_write_b128 v11, v[88:91] offset:80
    ds_write_b128 v11, v[92:95] offset:96
    s_mov_b64 exec, -1
    s_add_u32 s37, s38, 160840
    v_mov_b32 v124, s37
    v_mov_b32 v125, 1
    s_mov_b64 exec, 1
    ds_add_u32 v124, v125
    s_mov_b64 exec, -1
    v_lshlrev_b32 v10, 2, v1
    v_sub_u32 v10, v11, v10
    v_add_f32_dpp v18, v19, v18 wave_shr:1 row_mask:0xf bank_mask:0xf bound_ctrl:0
    v_add_f32_dpp v34, v35, v34 wave_shr:1 row_mask:0xf bank_mask:0xf bound_ctrl:0
    v_add_f32_dpp v50, v51, v50 wave_shr:1 row_mask:0xf bank_mask:0xf bound_ctrl:0
    v_add_f32_dpp v66, v67, v66 wave_shr:1 row_mask:0xf bank_mask:0xf bound_ctrl:0
    v_add_f32_dpp v17, v18, v17 wave_shr:1 row_mask:0xf bank_mask:0xf bound_ctrl:0
    v_add_f32_dpp v33, v34, v33 wave_shr:1 row_mask:0xf bank_mask:0xf bound_ctrl:0
    v_add_f32_dpp v49, v50, v49 wave_shr:1 row_mask:0xf bank_mask:0xf bound_ctrl:0
    v_add_f32_dpp v65, v66, v65 wave_shr:1 row_mask:0xf bank_mask:0xf bound_ctrl:0
    v_add_f32_dpp v16, v17, v16 wave_shr:1 row_mask:0xf bank_mask:0xf bound_ctrl:0
    v_add_f32_dpp v32, v33, v32 wave_shr:1 row_mask:0xf bank_mask:0xf bound_ctrl:0
    v_add_f32_dpp v48, v49, v48 wave_shr:1 row_mask:0xf bank_mask:0xf bound_ctrl:0
    v_add_f32_dpp v64, v65, v64 wave_shr:1 row_mask:0xf bank_mask:0xf bound_ctrl:0
    v_cndmask_b32 v112, v23, v19, s[44:45]
    v_cndmask_b32 v113, v39, v35, s[44:45]
    v_cndmask_b32 v114, v55, v51, s[44:45]
    v_cndmask_b32 v115, v71, v67, s[44:45]
    v_add_f32_dpp v22, v112, v22 wave_ror:1 row_mask:0xf bank_mask:0xf
    v_add_f32_dpp v38, v113, v38 wave_ror:1 row_mask:0xf bank_mask:0xf
    v_add_f32_dpp v54, v114, v54 wave_ror:1 row_mask:0xf bank_mask:0xf
    v_add_f32_dpp v70, v115, v70 wave_ror:1 row_mask:0xf bank_mask:0xf
    v_cndmask_b32 v112, v22, v18, s[44:45]
    v_cndmask_b32 v113, v38, v34, s[44:45]
    v_cndmask_b32 v114, v54, v50, s[44:45]
    v_cndmask_b32 v115, v70, v66, s[44:45]
    v_add_f32_dpp v21, v112, v21 wave_ror:1 row_mask:0xf bank_mask:0xf
    v_add_f32_dpp v37, v113, v37 wave_ror:1 row_mask:0xf bank_mask:0xf
    v_add_f32_dpp v53, v114, v53 wave_ror:1 row_mask:0xf bank_mask:0xf
    v_add_f32_dpp v69, v115, v69 wave_ror:1 row_mask:0xf bank_mask:0xf
    v_cndmask_b32 v112, v21, v17, s[44:45]
    v_cndmask_b32 v113, v37, v33, s[44:45]
    v_cndmask_b32 v114, v53, v49, s[44:45]
    v_cndmask_b32 v115, v69, v65, s[44:45]
    v_add_f32_dpp v20, v112, v20 wave_ror:1 row_mask:0xf bank_mask:0xf
    v_add_f32_dpp v36, v113, v36 wave_ror:1 row_mask:0xf bank_mask:0xf
    v_add_f32_dpp v52, v114, v52 wave_ror:1 row_mask:0xf bank_mask:0xf
    v_add_f32_dpp v68, v115, v68 wave_ror:1 row_mask:0xf bank_mask:0xf
    v_cndmask_b32 v112, v27, v23, s[44:45]
    v_cndmask_b32 v113, v43, v39, s[44:45]
    v_cndmask_b32 v114, v59, v55, s[44:45]
    v_cndmask_b32 v115, v75, v71, s[44:45]
    v_add_f32_dpp v26, v112, v26 wave_ror:1 row_mask:0xf bank_mask:0xf
    v_add_f32_dpp v42, v113, v42 wave_ror:1 row_mask:0xf bank_mask:0xf
    v_add_f32_dpp v58, v114, v58 wave_ror:1 row_mask:0xf bank_mask:0xf
    v_add_f32_dpp v74, v115, v74 wave_ror:1 row_mask:0xf bank_mask:0xf
    v_cndmask_b32 v112, v26, v22, s[44:45]
    v_cndmask_b32 v113, v42, v38, s[44:45]
    v_cndmask_b32 v114, v58, v54, s[44:45]
    v_cndmask_b32 v115, v74, v70, s[44:45]
    v_add_f32_dpp v25, v112, v25 wave_ror:1 row_mask:0xf bank_mask:0xf
    v_add_f32_dpp v41, v113, v41 wave_ror:1 row_mask:0xf bank_mask:0xf
    v_add_f32_dpp v57, v114, v57 wave_ror:1 row_mask:0xf bank_mask:0xf
    v_add_f32_dpp v73, v115, v73 wave_ror:1 row_mask:0xf bank_mask:0xf
    v_cndmask_b32 v112, v25, v21, s[44:45]
    v_cndmask_b32 v113, v41, v37, s[44:45]
    v_cndmask_b32 v114, v57, v53, s[44:45]
    v_cndmask_b32 v115, v73, v69, s[44:45]
    v_add_f32_dpp v24, v112, v24 wave_ror:1 row_mask:0xf bank_mask:0xf
    v_add_f32_dpp v40, v113, v40 wave_ror:1 row_mask:0xf bank_mask:0xf
    v_add_f32_dpp v56, v114, v56 wave_ror:1 row_mask:0xf bank_mask:0xf
    v_add_f32_dpp v72, v115, v72 wave_ror:1 row_mask:0xf bank_mask:0xf
    v_cndmask_b32 v112, v31, v27, s[44:45]
    v_cndmask_b32 v113, v47, v43, s[44:45]
    v_cndmask_b32 v114, v63, v59, s[44:45]
    v_cndmask_b32 v115, v79, v75, s[44:45]
    v_add_f32_dpp v30, v112, v30 wave_ror:1 row_mask:0xf bank_mask:0xf
    v_add_f32_dpp v46, v113, v46 wave_ror:1 row_mask:0xf bank_mask:0xf
    v_add_f32_dpp v62, v114, v62 wave_ror:1 row_mask:0xf bank_mask:0xf
    v_add_f32_dpp v78, v115, v78 wave_ror:1 row_mask:0xf bank_mask:0xf
    v_cndmask_b32 v112, v30, v26, s[44:45]
    v_cndmask_b32 v113, v46, v42, s[44:45]
    v_cndmask_b32 v114, v62, v58, s[44:45]
    v_cndmask_b32 v115, v78, v74, s[44:45]
    v_add_f32_dpp v29, v112, v29 wave_ror:1 row_mask:0xf bank_mask:0xf
    v_add_f32_dpp v45, v113, v45 wave_ror:1 row_mask:0xf bank_mask:0xf
    v_add_f32_dpp v61, v114, v61 wave_ror:1 row_mask:0xf bank_mask:0xf
    v_add_f32_dpp v77, v115, v77 wave_ror:1 row_mask:0xf bank_mask:0xf
    v_cndmask_b32 v112, v29, v25, s[44:45]
    v_cndmask_b32 v113, v45, v41, s[44:45]
    v_cndmask_b32 v114, v61, v57, s[44:45]
    v_cndmask_b32 v115, v77, v73, s[44:45]
    v_add_f32_dpp v28, v112, v28 wave_ror:1 row_mask:0xf bank_mask:0xf
    v_add_f32_dpp v44, v113, v44 wave_ror:1 row_mask:0xf bank_mask:0xf
    v_add_f32_dpp v60, v114, v60 wave_ror:1 row_mask:0xf bank_mask:0xf
    v_add_f32_dpp v76, v115, v76 wave_ror:1 row_mask:0xf bank_mask:0xf
    v_mov_b32 v124, s37
    s_mov_b32 s50, 0
ps_10:
    ds_read_b32 v125, v124
    s_waitcnt lgkmcnt(0)
    v_readfirstlane_b32 s36, v125
    s_cmp_ge_u32 s36, 2
    s_cbranch_scc1 ps_10_ok
    s_add_u32 s50, s50, 1
    s_cmp_ge_u32 s50, 1600000
    s_cbranch_scc1 ps_10_ok
    s_sleep 0
    s_branch ps_10
ps_10_ok:
    s_mov_b64 exec, 7
    ds_read_b32 v96, v10 offset:8
    ds_read_b32 v97, v10 offset:24
    ds_read_b32 v98, v10 offset:72
    ds_read_b32 v99, v10 offset:88
    s_mov_b64 exec, -1
    v_mul_f32 v116, v20, v127
    v_mul_f32 v117, v36, v127
    v_mul_f32 v118, v52, v127
    v_mul_f32 v119, v68, v127
    v_cvt_pk_bf16_f32 v82, v116, v117
    ds_write_b16 v12, v82 offset:640
    ds_write_b16_d16_hi v12, v82 offset:1152
    v_cvt_pk_bf16_f32 v83, v118, v119
    ds_write_b16 v12, v83 offset:2688
    ds_write_b16_d16_hi v12, v83 offset:3200
    v_mul_f32 v116, v24, v127
    v_mul_f32 v117, v40, v127
    v_mul_f32 v118, v56, v127
    v_mul_f32 v119, v72, v127
    v_cvt_pk_bf16_f32 v84, v116, v117
    ds_write_b16 v12, v84 offset:768
    ds_write_b16_d16_hi v12, v84 offset:1280
    v_cvt_pk_bf16_f32 v85, v118, v119
    ds_write_b16 v12, v85 offset:2816
    ds_write_b16_d16_hi v12, v85 offset:3328
    v_mul_f32 v116, v28, v127
    v_mul_f32 v117, v44, v127
    v_mul_f32 v118, v60, v127
    v_mul_f32 v119, v76, v127
    v_cvt_pk_bf16_f32 v86, v116, v117
    ds_write_b16 v12, v86 offset:896
    ds_write_b16_d16_hi v12, v86 offset:1408
    v_cvt_pk_bf16_f32 v87, v118, v119
    ds_write_b16 v12, v87 offset:2944
    ds_write_b16_d16_hi v12, v87 offset:3456
    s_waitcnt lgkmcnt(12)
    s_mov_b64 exec, 7
    v_add_f32 v16, v16, v96
    v_add_f32 v32, v32, v97
    v_add_f32 v48, v48, v98
    v_add_f32 v64, v64, v99
    s_mov_b64 exec, -1
    v_mul_f32 v116, v16, v127
    v_mul_f32 v117, v32, v127
    v_mul_f32 v118, v48, v127
    v_mul_f32 v119, v64, v127
    v_cvt_pk_bf16_f32 v80, v116, v117
    ds_write_b16 v12, v80 offset:512
    ds_write_b16_d16_hi v12, v80 offset:1024
    v_cvt_pk_bf16_f32 v81, v118, v119
    ds_write_b16 v12, v81 offset:2560
    ds_write_b16_d16_hi v12, v81 offset:3072
    v_mul_u32_u24 v112, 512, v3
    v_add_u32 v112, v112, v2
    ds_read_b128 v[116:119], v112 offset:512
    v_mul_u32_u24 v113, 229376, v3
    v_add_u32 v113, v113, v14
    s_add_u32 s44, s39, 229376
    v_mul_u32_u24 v112, 512, v3
    v_add_u32 v112, v112, v2
    ds_read_b128 v[120:123], v112 offset:2560
    v_mul_u32_u24 v114, 229376, v3
    v_add_u32 v114, v114, v14
    s_add_u32 s45, s39, 1146880
cvE_6:
    s_waitcnt lgkmcnt(1)
    buffer_store_dwordx4 v[116:119], v113, s[24:27], s44 offen sc1
    s_waitcnt lgkmcnt(0)
    buffer_store_dwordx4 v[120:123], v114, s[24:27], s45 offen sc1
    s_lshl_b32 s37, s3, 2
    s_add_u32 s37, s37, 160848
    v_mov_b32 v124, s37
    s_mov_b32 s50, 0
wr_11:
    ds_read_b32 v125, v124
    s_waitcnt lgkmcnt(0)
    v_readfirstlane_b32 s36, v125
    s_cmp_ge_u32 s36, 1
    s_cbranch_scc1 wr_11_ok
    s_add_u32 s50, s50, 1
    s_cmp_ge_u32 s50, 1600000
    s_cbranch_scc1 wr_11_ok
    s_sleep 1
    s_branch wr_11
wr_11_ok:
    ds_read_b64_tr_b16 v[128:129], v244 offset:16384
    ds_read_b64_tr_b16 v[130:131], v244 offset:18432
    ds_read_b64_tr_b16 v[132:133], v245 offset:16384
    ds_read_b64_tr_b16 v[134:135], v245 offset:18432
    ds_read_b64_tr_b16 v[136:137], v244 offset:17408
    ds_read_b64_tr_b16 v[138:139], v244 offset:19456
    ds_read_b64_tr_b16 v[140:141], v245 offset:17408
    ds_read_b64_tr_b16 v[142:143], v245 offset:19456
    ds_read_b64_tr_b16 v[144:145], v246 offset:16384
    ds_read_b64_tr_b16 v[146:147], v246 offset:18432
    ds_read_b64_tr_b16 v[148:149], v247 offset:16384
    ds_read_b64_tr_b16 v[150:151], v247 offset:18432
    ds_read_b64_tr_b16 v[152:153], v246 offset:17408
    ds_read_b64_tr_b16 v[154:155], v246 offset:19456
    ds_read_b64_tr_b16 v[156:157], v247 offset:17408
    ds_read_b64_tr_b16 v[158:159], v247 offset:19456
    ds_read_b64_tr_b16 v[160:161], v246 offset:32768
    ds_read_b64_tr_b16 v[162:163], v246 offset:34816
    ds_read_b64_tr_b16 v[164:165], v247 offset:32768
    ds_read_b64_tr_b16 v[166:167], v247 offset:34816
    ds_read_b64_tr_b16 v[168:169], v246 offset:33792
    ds_read_b64_tr_b16 v[170:171], v246 offset:35840
    ds_read_b64_tr_b16 v[172:173], v247 offset:33792
    ds_read_b64_tr_b16 v[174:175], v247 offset:35840
    ds_read_b64_tr_b16 v[176:177], v244 offset:32768
    ds_read_b64_tr_b16 v[178:179], v244 offset:34816
    ds_read_b64_tr_b16 v[180:181], v245 offset:32768
    ds_read_b64_tr_b16 v[182:183], v245 offset:34816
    ds_read_b64_tr_b16 v[184:185], v244 offset:33792
    ds_read_b64_tr_b16 v[186:187], v244 offset:35840
    ds_read_b64_tr_b16 v[188:189], v245 offset:33792
    ds_read_b64_tr_b16 v[190:191], v245 offset:35840
    ds_read_b64_tr_b16 v[192:193], v244 offset:49152
    ds_read_b64_tr_b16 v[194:195], v244 offset:51200
    ds_read_b64_tr_b16 v[196:197], v245 offset:49152
    ds_read_b64_tr_b16 v[198:199], v245 offset:51200
    ds_read_b64_tr_b16 v[200:201], v244 offset:50176
    ds_read_b64_tr_b16 v[202:203], v244 offset:52224
    ds_read_b64_tr_b16 v[204:205], v245 offset:50176
    ds_read_b64_tr_b16 v[206:207], v245 offset:52224
    ds_read_b64_tr_b16 v[208:209], v246 offset:0
    ds_read_b64_tr_b16 v[210:211], v246 offset:2048
    ds_read_b64_tr_b16 v[212:213], v247 offset:0
    ds_read_b64_tr_b16 v[214:215], v247 offset:2048
    ds_read_b64_tr_b16 v[216:217], v246 offset:1024
    ds_read_b64_tr_b16 v[218:219], v246 offset:3072
    ds_read_b64_tr_b16 v[220:221], v247 offset:1024
    ds_read_b64_tr_b16 v[222:223], v247 offset:3072
    ds_read_b64_tr_b16 v[224:225], v244 offset:0
    ds_read_b64_tr_b16 v[226:227], v244 offset:2048
    ds_read_b64_tr_b16 v[228:229], v245 offset:0
    ds_read_b64_tr_b16 v[230:231], v245 offset:2048
    ds_read_b64_tr_b16 v[232:233], v244 offset:1024
    ds_read_b64_tr_b16 v[234:235], v244 offset:3072
    ds_read_b64_tr_b16 v[236:237], v245 offset:1024
    ds_read_b64_tr_b16 v[238:239], v245 offset:3072
    v_mov_b32 v124, 160872
    v_mov_b32 v125, 1
    s_mov_b64 exec, 1
    ds_add_u32 v124, v125
    s_mov_b64 exec, -1
    s_waitcnt vmcnt(0)
    v_mov_b32 v124, 160876
    v_mov_b32 v125, 1
    s_mov_b64 exec, 1
    ds_add_rtn_u32 v126, v124, v125
    s_mov_b64 exec, -1
    s_lshr_b32 s36, s2, 5
    s_lshl_b32 s36, s36, 6
    s_and_b32 s49, s2, 31
    s_add_u32 s36, s36, s49
    s_lshl_b32 s36, s36, 2
    s_add_u32 s36, s36, 4224
    v_mul_u32_u24 v124, 1792, v1
    v_add_u32 v124, s36, v124
    s_waitcnt lgkmcnt(0)
    v_readfirstlane_b32 s36, v126
    s_cmp_lg_u32 s36, 3
    s_cbranch_scc1 yp_12
    s_mov_b32 exec_hi, 0
    buffer_store_dword v125, v124, s[8:11], 0 offen sc1
    s_mov_b64 exec, -1
yp_12:
    s_setprio 0
    v_mov_b32 v124, 160868
    s_mov_b32 s50, 0
hr_13:
    ds_read_b32 v125, v124
    s_waitcnt lgkmcnt(0)
    v_readfirstlane_b32 s36, v125
    s_cmp_ge_u32 s36, 1
    s_cbranch_scc1 hr_13_ok
    s_add_u32 s50, s50, 1
    s_cmp_ge_u32 s50, 1600000
    s_cbranch_scc1 hr_13_ok
    s_sleep 2
    s_branch hr_13
hr_13_ok:
    v_lshlrev_b32 v2, 4, v1
    s_mul_i32 s36, s56, 229376
    s_mul_i32 s37, s3, 14336
    s_add_u32 s38, s36, s37
    s_add_u32 s37, s38, 0
    buffer_load_dwordx4 v[80:83], v2, s[4:7], s37 offen offset:0 sc1
    buffer_load_dwordx4 v[84:87], v2, s[4:7], s37 offen offset:1024 sc1
    buffer_load_dwordx4 v[88:91], v2, s[4:7], s37 offen offset:2048 sc1
    buffer_load_dwordx4 v[92:95], v2, s[4:7], s37 offen offset:3072 sc1
    s_add_u32 s37, s38, 4096
    buffer_load_dwordx4 v[96:99], v2, s[4:7], s37 offen offset:0 sc1
    buffer_load_dwordx4 v[100:103], v2, s[4:7], s37 offen offset:1024 sc1
    buffer_load_dwordx4 v[104:107], v2, s[4:7], s37 offen offset:2048 sc1
    buffer_load_dwordx4 v[108:111], v2, s[4:7], s37 offen offset:3072 sc1
    s_add_u32 s37, s38, 8192
    buffer_load_dwordx4 v[112:115], v2, s[4:7], s37 offen offset:0 sc1
    buffer_load_dwordx4 v[116:119], v2, s[4:7], s37 offen offset:1024 sc1
    buffer_load_dwordx4 v[120:123], v2, s[4:7], s37 offen offset:2048 sc1
    s_mov_b32 s20, s40
    s_mov_b32 s21, s41
    s_mov_b32 s22, 1835008
    s_mov_b32 s23, 0x00020000
    s_mov_b32 s12, s66
    s_mov_b32 s13, s67
    s_mov_b32 s14, 1835008
    s_mov_b32 s15, 0x00020000
    v_and_b32 v4, 31, v1
    v_bfe_u32 v9, v4, 3, 1
    v_lshlrev_b32 v8, 4, v9
    v_bfe_u32 v9, v4, 1, 1
    v_lshl_or_b32 v8, v9, 3, v8
    v_and_b32 v9, 1, v4
    v_lshl_or_b32 v8, v9, 2, v8
    v_bfe_u32 v9, v4, 2, 1
    v_lshl_or_b32 v8, v9, 1, v8
    v_bfe_u32 v9, v4, 4, 1
    v_or_b32 v8, v9, v8
    s_lshr_b32 s42, s3, 2
    s_bfe_u32 s43, s3, 0x10001
    s_and_b32 s44, s3, 1
    s_lshl_b32 s45, s56, 1
    s_add_u32 s45, s45, s42
    s_lshl_b32 s45, s45, 5
    v_add_u32 v8, s45, v8
    v_mul_u32_u24 v8, 896, v8
    v_lshrrev_b32 v9, 5, v1
    v_lshl_add_u32 v8, v9, 5, v8
    s_lshl_b32 s46, s57, 7
    s_lshl_b32 s47, s43, 6
    s_add_u32 s46, s46, s47
    s_lshl_b32 s47, s44, 4
    s_add_u32 s46, s46, s47
    buffer_load_dwordx4 v[240:243], v8, s[20:23], s46 offen
    s_lshl_b32 s45, s3, 13
    v_add_u32 v10, s45, v2
    s_lshl_b32 s45, s42, 16
    s_lshl_b32 s47, s43, 12
    s_add_u32 s45, s45, s47
    s_lshl_b32 s47, s44, 11
    s_add_u32 s45, s45, s47
    v_add_u32 v11, s45, v2
    s_mul_i32 s45, s56, 7
    s_add_u32 s45, s45, s57
    s_lshl_b32 s45, s45, 8
    s_add_u32 s45, s45, 4224
    v_lshlrev_b32 v12, 2, v4
    v_add_u32 v12, s45, v12
    s_mul_i32 s45, s56, 57344
    s_lshl_b32 s47, s57, 13
    s_add_u32 s45, s45, s47
    s_lshl_b32 s47, s3, 10
    s_add_u32 s45, s45, s47
    s_add_u32 s47, s47, 131072
    v_add_u32 v13, s47, v2
    v_lshl_add_u32 v14, v9, 1, s44
    v_lshl_add_u32 v14, s43, 2, v14
    v_lshlrev_b32 v14, 3, v14
    v_bfe_u32 v15, v1, 2, 2
    v_add_u32 v14, v14, v15
    v_lshlrev_b32 v14, 7, v14
    v_bfe_u32 v15, v1, 4, 1
    v_lshl_add_u32 v14, v15, 5, v14
    v_and_b32 v15, 3, v1
    v_lshl_add_u32 v14, v15, 3, v14
    s_lshl_b32 s47, s42, 6
    s_add_u32 s47, s47, 131072
    v_add_u32 v14, s47, v14
    s_waitcnt vmcnt(11) lgkmcnt(0)
    v_mfma_f32_32x32x16_bf16 v[16:31], v[128:131], v[80:83], 0
    v_mfma_f32_32x32x16_bf16 v[32:47], v[132:135], v[80:83], 0
    buffer_load_dwordx4 v[80:83], v2, s[4:7], s37 offen offset:3072 sc1
    s_waitcnt vmcnt(11)
    v_mfma_f32_32x32x16_bf16 v[16:31], v[136:139], v[84:87], v[16:31]
    v_mfma_f32_32x32x16_bf16 v[32:47], v[140:143], v[84:87], v[32:47]
    s_add_u32 s37, s38, 12288
    buffer_load_dwordx4 v[84:87], v2, s[4:7], s37 offen offset:0 sc1
    s_waitcnt vmcnt(11)
    v_mfma_f32_32x32x16_bf16 v[16:31], v[144:147], v[88:91], v[16:31]
    v_mfma_f32_32x32x16_bf16 v[32:47], v[148:151], v[88:91], v[32:47]
    buffer_load_dwordx4 v[88:91], v2, s[4:7], s37 offen offset:1024 sc1
    s_waitcnt vmcnt(11)
    v_mfma_f32_32x32x16_bf16 v[16:31], v[152:155], v[92:95], v[16:31]
    v_mfma_f32_32x32x16_bf16 v[32:47], v[156:159], v[92:95], v[32:47]
    s_add_u32 s39, s38, 114688
    buffer_load_dwordx4 v[92:95], v2, s[4:7], s39 offen offset:0 sc1
    s_waitcnt vmcnt(11)
    v_mfma_f32_32x32x16_bf16 v[16:31], v[160:163], v[96:99], v[16:31]
    v_mfma_f32_32x32x16_bf16 v[32:47], v[164:167], v[96:99], v[32:47]
    buffer_load_dwordx4 v[96:99], v2, s[4:7], s39 offen offset:1024 sc1
    s_waitcnt vmcnt(11)
    v_mfma_f32_32x32x16_bf16 v[16:31], v[168:171], v[100:103], v[16:31]
    v_mfma_f32_32x32x16_bf16 v[32:47], v[172:175], v[100:103], v[32:47]
    buffer_load_dwordx4 v[100:103], v2, s[4:7], s39 offen offset:2048 sc1
    s_waitcnt vmcnt(11)
    v_mfma_f32_32x32x16_bf16 v[16:31], v[176:179], v[104:107], v[16:31]
    v_mfma_f32_32x32x16_bf16 v[32:47], v[180:183], v[104:107], v[32:47]
    buffer_load_dwordx4 v[104:107], v2, s[4:7], s39 offen offset:3072 sc1
    s_waitcnt vmcnt(11)
    v_mfma_f32_32x32x16_bf16 v[16:31], v[184:187], v[108:111], v[16:31]
    v_mfma_f32_32x32x16_bf16 v[32:47], v[188:191], v[108:111], v[32:47]
    s_add_u32 s39, s38, 118784
    buffer_load_dwordx4 v[108:111], v2, s[4:7], s39 offen offset:0 sc1
    s_waitcnt vmcnt(11)
    v_mfma_f32_32x32x16_bf16 v[16:31], v[192:195], v[112:115], v[16:31]
    v_mfma_f32_32x32x16_bf16 v[32:47], v[196:199], v[112:115], v[32:47]
    buffer_load_dwordx4 v[112:115], v2, s[4:7], s39 offen offset:1024 sc1
    s_waitcnt vmcnt(11)
    v_mfma_f32_32x32x16_bf16 v[16:31], v[200:203], v[116:119], v[16:31]
    v_mfma_f32_32x32x16_bf16 v[32:47], v[204:207], v[116:119], v[32:47]
    buffer_load_dwordx4 v[116:119], v2, s[4:7], s39 offen offset:2048 sc1
    s_waitcnt vmcnt(11)
    v_mfma_f32_32x32x16_bf16 v[16:31], v[208:211], v[120:123], v[16:31]
    v_mfma_f32_32x32x16_bf16 v[32:47], v[212:215], v[120:123], v[32:47]
    buffer_load_dwordx4 v[120:123], v2, s[4:7], s39 offen offset:3072 sc1
    s_waitcnt vmcnt(10)
    v_mfma_f32_32x32x16_bf16 v[16:31], v[216:219], v[80:83], v[16:31]
    v_mfma_f32_32x32x16_bf16 v[32:47], v[220:223], v[80:83], v[32:47]
    s_add_u32 s39, s38, 122880
    buffer_load_dwordx4 v[80:83], v2, s[4:7], s39 offen offset:0 sc1
    s_waitcnt vmcnt(10)
    v_mfma_f32_32x32x16_bf16 v[16:31], v[224:227], v[84:87], v[16:31]
    v_mfma_f32_32x32x16_bf16 v[32:47], v[228:231], v[84:87], v[32:47]
    buffer_load_dwordx4 v[84:87], v2, s[4:7], s39 offen offset:1024 sc1
    s_waitcnt vmcnt(10)
    v_mfma_f32_32x32x16_bf16 v[16:31], v[232:235], v[88:91], v[16:31]
    v_mfma_f32_32x32x16_bf16 v[32:47], v[236:239], v[88:91], v[32:47]
    buffer_load_dwordx4 v[88:91], v2, s[4:7], s39 offen offset:2048 sc1
    s_waitcnt vmcnt(10)
    v_mfma_f32_32x32x16_bf16 v[48:63], v[128:131], v[92:95], 0
    v_mfma_f32_32x32x16_bf16 v[64:79], v[132:135], v[92:95], 0
    buffer_load_dwordx4 v[92:95], v2, s[4:7], s39 offen offset:3072 sc1
    s_waitcnt vmcnt(10)
    v_mfma_f32_32x32x16_bf16 v[48:63], v[136:139], v[96:99], v[48:63]
    v_mfma_f32_32x32x16_bf16 v[64:79], v[140:143], v[96:99], v[64:79]
    s_add_u32 s39, s38, 126976
    buffer_load_dwordx4 v[96:99], v2, s[4:7], s39 offen offset:0 sc1
    s_waitcnt vmcnt(10)
    v_mfma_f32_32x32x16_bf16 v[48:63], v[144:147], v[100:103], v[48:63]
    v_mfma_f32_32x32x16_bf16 v[64:79], v[148:151], v[100:103], v[64:79]
    buffer_load_dwordx4 v[100:103], v2, s[4:7], s39 offen offset:1024 sc1
    v_mov_b32 v124, 160872
    s_mov_b32 s50, 0
rc_14:
    ds_read_b32 v125, v124
    s_waitcnt lgkmcnt(0)
    v_readfirstlane_b32 s36, v125
    s_cmp_ge_u32 s36, 8
    s_cbranch_scc1 rc_14_ok
    s_add_u32 s50, s50, 1
    s_cmp_ge_u32 s50, 1600000
    s_cbranch_scc1 rc_14_ok
    s_sleep 1
    s_branch rc_14
rc_14_ok:
    s_waitcnt vmcnt(10)
    v_mfma_f32_32x32x16_bf16 v[48:63], v[152:155], v[104:107], v[48:63]
    v_mfma_f32_32x32x16_bf16 v[64:79], v[156:159], v[104:107], v[64:79]
    ds_write_b128 v10, v[16:19] offset:0
    s_waitcnt vmcnt(9)
    v_mfma_f32_32x32x16_bf16 v[48:63], v[160:163], v[108:111], v[48:63]
    v_mfma_f32_32x32x16_bf16 v[64:79], v[164:167], v[108:111], v[64:79]
    ds_write_b128 v10, v[20:23] offset:1024
    s_waitcnt vmcnt(8)
    v_mfma_f32_32x32x16_bf16 v[48:63], v[168:171], v[112:115], v[48:63]
    v_mfma_f32_32x32x16_bf16 v[64:79], v[172:175], v[112:115], v[64:79]
    ds_write_b128 v10, v[24:27] offset:2048
    s_waitcnt vmcnt(7)
    v_mfma_f32_32x32x16_bf16 v[48:63], v[176:179], v[116:119], v[48:63]
    v_mfma_f32_32x32x16_bf16 v[64:79], v[180:183], v[116:119], v[64:79]
    ds_write_b128 v10, v[28:31] offset:3072
    s_waitcnt vmcnt(6)
    v_mfma_f32_32x32x16_bf16 v[48:63], v[184:187], v[120:123], v[48:63]
    v_mfma_f32_32x32x16_bf16 v[64:79], v[188:191], v[120:123], v[64:79]
    ds_write_b128 v10, v[32:35] offset:4096
    s_waitcnt vmcnt(5)
    v_mfma_f32_32x32x16_bf16 v[48:63], v[192:195], v[80:83], v[48:63]
    v_mfma_f32_32x32x16_bf16 v[64:79], v[196:199], v[80:83], v[64:79]
    ds_write_b128 v10, v[36:39] offset:5120
    s_waitcnt vmcnt(4)
    v_mfma_f32_32x32x16_bf16 v[48:63], v[200:203], v[84:87], v[48:63]
    v_mfma_f32_32x32x16_bf16 v[64:79], v[204:207], v[84:87], v[64:79]
    ds_write_b128 v10, v[40:43] offset:6144
    s_waitcnt vmcnt(3)
    v_mfma_f32_32x32x16_bf16 v[48:63], v[208:211], v[88:91], v[48:63]
    v_mfma_f32_32x32x16_bf16 v[64:79], v[212:215], v[88:91], v[64:79]
    ds_write_b128 v10, v[44:47] offset:7168
    s_waitcnt vmcnt(2)
    v_mfma_f32_32x32x16_bf16 v[48:63], v[216:219], v[92:95], v[48:63]
    v_mfma_f32_32x32x16_bf16 v[64:79], v[220:223], v[92:95], v[64:79]
    s_waitcnt vmcnt(1)
    v_mfma_f32_32x32x16_bf16 v[48:63], v[224:227], v[96:99], v[48:63]
    v_mfma_f32_32x32x16_bf16 v[64:79], v[228:231], v[96:99], v[64:79]
    s_waitcnt vmcnt(0)
    v_mfma_f32_32x32x16_bf16 v[48:63], v[232:235], v[100:103], v[48:63]
    v_mfma_f32_32x32x16_bf16 v[64:79], v[236:239], v[100:103], v[64:79]
    v_add_u32 v10, 0x10000, v10
    s_nop 11
    ds_write_b128 v10, v[48:51] offset:0
    ds_write_b128 v10, v[52:55] offset:1024
    ds_write_b128 v10, v[56:59] offset:2048
    ds_write_b128 v10, v[60:63] offset:3072
    ds_write_b128 v10, v[64:67] offset:4096
    ds_write_b128 v10, v[68:71] offset:5120
    ds_write_b128 v10, v[72:75] offset:6144
    ds_write_b128 v10, v[76:79] offset:7168
    s_branch k_fin
k_g2B:
    v_mov_b32 v124, 160868
    s_mov_b32 s50, 0
hr_15:
    ds_read_b32 v125, v124
    s_waitcnt lgkmcnt(0)
    v_readfirstlane_b32 s36, v125
    s_cmp_ge_u32 s36, 1
    s_cbranch_scc1 hr_15_ok
    s_add_u32 s50, s50, 1
    s_cmp_ge_u32 s50, 1600000
    s_cbranch_scc1 hr_15_ok
    s_sleep 2
    s_branch hr_15
hr_15_ok:
    v_lshlrev_b32 v2, 4, v1
    s_mul_i32 s36, s56, 229376
    s_mul_i32 s37, s3, 14336
    s_add_u32 s38, s36, s37
    s_add_u32 s37, s38, 0
    buffer_load_dwordx4 v[80:83], v2, s[4:7], s37 offen offset:0 sc1
    buffer_load_dwordx4 v[84:87], v2, s[4:7], s37 offen offset:1024 sc1
    buffer_load_dwordx4 v[88:91], v2, s[4:7], s37 offen offset:2048 sc1
    buffer_load_dwordx4 v[92:95], v2, s[4:7], s37 offen offset:3072 sc1
    s_add_u32 s37, s38, 4096
    buffer_load_dwordx4 v[96:99], v2, s[4:7], s37 offen offset:0 sc1
    buffer_load_dwordx4 v[100:103], v2, s[4:7], s37 offen offset:1024 sc1
    buffer_load_dwordx4 v[104:107], v2, s[4:7], s37 offen offset:2048 sc1
    buffer_load_dwordx4 v[108:111], v2, s[4:7], s37 offen offset:3072 sc1
    s_add_u32 s37, s38, 8192
    buffer_load_dwordx4 v[112:115], v2, s[4:7], s37 offen offset:0 sc1
    buffer_load_dwordx4 v[116:119], v2, s[4:7], s37 offen offset:1024 sc1
    buffer_load_dwordx4 v[120:123], v2, s[4:7], s37 offen offset:2048 sc1
    s_mov_b32 s20, s40
    s_mov_b32 s21, s41
    s_mov_b32 s22, 1835008
    s_mov_b32 s23, 0x00020000
    s_mov_b32 s12, s66
    s_mov_b32 s13, s67
    s_mov_b32 s14, 1835008
    s_mov_b32 s15, 0x00020000
    v_and_b32 v4, 31, v1
    v_bfe_u32 v9, v4, 3, 1
    v_lshlrev_b32 v8, 4, v9
    v_bfe_u32 v9, v4, 1, 1
    v_lshl_or_b32 v8, v9, 3, v8
    v_and_b32 v9, 1, v4
    v_lshl_or_b32 v8, v9, 2, v8
    v_bfe_u32 v9, v4, 2, 1
    v_lshl_or_b32 v8, v9, 1, v8
    v_bfe_u32 v9, v4, 4, 1
    v_or_b32 v8, v9, v8
    s_lshr_b32 s42, s3, 2
    s_bfe_u32 s43, s3, 0x10001
    s_and_b32 s44, s3, 1
    s_lshl_b32 s45, s56, 1
    s_add_u32 s45, s45, s42
    s_lshl_b32 s45, s45, 5
    v_add_u32 v8, s45, v8
    v_mul_u32_u24 v8, 896, v8
    v_lshrrev_b32 v9, 5, v1
    v_lshl_add_u32 v8, v9, 5, v8
    s_lshl_b32 s46, s57, 7
    s_lshl_b32 s47, s43, 6
    s_add_u32 s46, s46, s47
    s_lshl_b32 s47, s44, 4
    s_add_u32 s46, s46, s47
    buffer_load_dwordx4 v[240:243], v8, s[20:23], s46 offen
    s_lshl_b32 s45, s3, 13
    v_add_u32 v10, s45, v2
    s_lshl_b32 s45, s42, 16
    s_lshl_b32 s47, s43, 12
    s_add_u32 s45, s45, s47
    s_lshl_b32 s47, s44, 11
    s_add_u32 s45, s45, s47
    v_add_u32 v11, s45, v2
    s_mul_i32 s45, s56, 7
    s_add_u32 s45, s45, s57
    s_lshl_b32 s45, s45, 8
    s_add_u32 s45, s45, 4224
    v_lshlrev_b32 v12, 2, v4
    v_add_u32 v12, s45, v12
    s_mul_i32 s45, s56, 57344
    s_lshl_b32 s47, s57, 13
    s_add_u32 s45, s45, s47
    s_lshl_b32 s47, s3, 10
    s_add_u32 s45, s45, s47
    s_add_u32 s47, s47, 131072
    v_add_u32 v13, s47, v2
    v_lshl_add_u32 v14, v9, 1, s44
    v_lshl_add_u32 v14, s43, 2, v14
    v_lshlrev_b32 v14, 3, v14
    v_bfe_u32 v15, v1, 2, 2
    v_add_u32 v14, v14, v15
    v_lshlrev_b32 v14, 7, v14
    v_bfe_u32 v15, v1, 4, 1
    v_lshl_add_u32 v14, v15, 5, v14
    v_and_b32 v15, 3, v1
    v_lshl_add_u32 v14, v15, 3, v14
    s_lshl_b32 s47, s42, 6
    s_add_u32 s47, s47, 131072
    v_add_u32 v14, s47, v14
    s_waitcnt vmcnt(11) lgkmcnt(0)
    v_mfma_f32_32x32x16_bf16 v[16:31], v[128:131], v[80:83], 0
    v_mfma_f32_32x32x16_bf16 v[32:47], v[132:135], v[80:83], 0
    buffer_load_dwordx4 v[80:83], v2, s[4:7], s37 offen offset:3072 sc1
    s_waitcnt vmcnt(11)
    v_mfma_f32_32x32x16_bf16 v[16:31], v[136:139], v[84:87], v[16:31]
    v_mfma_f32_32x32x16_bf16 v[32:47], v[140:143], v[84:87], v[32:47]
    s_add_u32 s37, s38, 12288
    buffer_load_dwordx4 v[84:87], v2, s[4:7], s37 offen offset:0 sc1
    s_waitcnt vmcnt(11)
    v_mfma_f32_32x32x16_bf16 v[16:31], v[144:147], v[88:91], v[16:31]
    v_mfma_f32_32x32x16_bf16 v[32:47], v[148:151], v[88:91], v[32:47]
    buffer_load_dwordx4 v[88:91], v2, s[4:7], s37 offen offset:1024 sc1
    s_waitcnt vmcnt(11)
    v_mfma_f32_32x32x16_bf16 v[16:31], v[152:155], v[92:95], v[16:31]
    v_mfma_f32_32x32x16_bf16 v[32:47], v[156:159], v[92:95], v[32:47]
    s_add_u32 s39, s38, 114688
    buffer_load_dwordx4 v[92:95], v2, s[4:7], s39 offen offset:0 sc1
    s_waitcnt vmcnt(11)
    v_mfma_f32_32x32x16_bf16 v[16:31], v[160:163], v[96:99], v[16:31]
    v_mfma_f32_32x32x16_bf16 v[32:47], v[164:167], v[96:99], v[32:47]
    buffer_load_dwordx4 v[96:99], v2, s[4:7], s39 offen offset:1024 sc1
    s_waitcnt vmcnt(11)
    v_mfma_f32_32x32x16_bf16 v[16:31], v[168:171], v[100:103], v[16:31]
    v_mfma_f32_32x32x16_bf16 v[32:47], v[172:175], v[100:103], v[32:47]
    buffer_load_dwordx4 v[100:103], v2, s[4:7], s39 offen offset:2048 sc1
    s_waitcnt vmcnt(11)
    v_mfma_f32_32x32x16_bf16 v[16:31], v[176:179], v[104:107], v[16:31]
    v_mfma_f32_32x32x16_bf16 v[32:47], v[180:183], v[104:107], v[32:47]
    buffer_load_dwordx4 v[104:107], v2, s[4:7], s39 offen offset:3072 sc1
    s_waitcnt vmcnt(11)
    v_mfma_f32_32x32x16_bf16 v[16:31], v[184:187], v[108:111], v[16:31]
    v_mfma_f32_32x32x16_bf16 v[32:47], v[188:191], v[108:111], v[32:47]
    s_add_u32 s39, s38, 118784
    buffer_load_dwordx4 v[108:111], v2, s[4:7], s39 offen offset:0 sc1
    s_waitcnt vmcnt(11)
    v_mfma_f32_32x32x16_bf16 v[16:31], v[192:195], v[112:115], v[16:31]
    v_mfma_f32_32x32x16_bf16 v[32:47], v[196:199], v[112:115], v[32:47]
    buffer_load_dwordx4 v[112:115], v2, s[4:7], s39 offen offset:1024 sc1
    s_waitcnt vmcnt(11)
    v_mfma_f32_32x32x16_bf16 v[16:31], v[200:203], v[116:119], v[16:31]
    v_mfma_f32_32x32x16_bf16 v[32:47], v[204:207], v[116:119], v[32:47]
    buffer_load_dwordx4 v[116:119], v2, s[4:7], s39 offen offset:2048 sc1
    s_waitcnt vmcnt(11)
    v_mfma_f32_32x32x16_bf16 v[16:31], v[208:211], v[120:123], v[16:31]
    v_mfma_f32_32x32x16_bf16 v[32:47], v[212:215], v[120:123], v[32:47]
    buffer_load_dwordx4 v[120:123], v2, s[4:7], s39 offen offset:3072 sc1
    s_waitcnt vmcnt(10)
    v_mfma_f32_32x32x16_bf16 v[16:31], v[216:219], v[80:83], v[16:31]
    v_mfma_f32_32x32x16_bf16 v[32:47], v[220:223], v[80:83], v[32:47]
    s_add_u32 s39, s38, 122880
    buffer_load_dwordx4 v[80:83], v2, s[4:7], s39 offen offset:0 sc1
    s_waitcnt vmcnt(10)
    v_mfma_f32_32x32x16_bf16 v[16:31], v[224:227], v[84:87], v[16:31]
    v_mfma_f32_32x32x16_bf16 v[32:47], v[228:231], v[84:87], v[32:47]
    buffer_load_dwordx4 v[84:87], v2, s[4:7], s39 offen offset:1024 sc1
    s_waitcnt vmcnt(10)
    v_mfma_f32_32x32x16_bf16 v[16:31], v[232:235], v[88:91], v[16:31]
    v_mfma_f32_32x32x16_bf16 v[32:47], v[236:239], v[88:91], v[32:47]
    buffer_load_dwordx4 v[88:91], v2, s[4:7], s39 offen offset:2048 sc1
    s_waitcnt vmcnt(10)
    v_mfma_f32_32x32x16_bf16 v[48:63], v[128:131], v[92:95], 0
    v_mfma_f32_32x32x16_bf16 v[64:79], v[132:135], v[92:95], 0
    buffer_load_dwordx4 v[92:95], v2, s[4:7], s39 offen offset:3072 sc1
    s_waitcnt vmcnt(10)
    v_mfma_f32_32x32x16_bf16 v[48:63], v[136:139], v[96:99], v[48:63]
    v_mfma_f32_32x32x16_bf16 v[64:79], v[140:143], v[96:99], v[64:79]
    s_add_u32 s39, s38, 126976
    buffer_load_dwordx4 v[96:99], v2, s[4:7], s39 offen offset:0 sc1
    s_waitcnt vmcnt(10)
    v_mfma_f32_32x32x16_bf16 v[48:63], v[144:147], v[100:103], v[48:63]
    v_mfma_f32_32x32x16_bf16 v[64:79], v[148:151], v[100:103], v[64:79]
    buffer_load_dwordx4 v[100:103], v2, s[4:7], s39 offen offset:1024 sc1
    s_waitcnt vmcnt(10)
    v_mfma_f32_32x32x16_bf16 v[48:63], v[152:155], v[104:107], v[48:63]
    v_mfma_f32_32x32x16_bf16 v[64:79], v[156:159], v[104:107], v[64:79]
    s_waitcnt vmcnt(9)
    v_mfma_f32_32x32x16_bf16 v[48:63], v[160:163], v[108:111], v[48:63]
    v_mfma_f32_32x32x16_bf16 v[64:79], v[164:167], v[108:111], v[64:79]
    s_waitcnt vmcnt(8)
    v_mfma_f32_32x32x16_bf16 v[48:63], v[168:171], v[112:115], v[48:63]
    v_mfma_f32_32x32x16_bf16 v[64:79], v[172:175], v[112:115], v[64:79]
    s_waitcnt vmcnt(7)
    v_mfma_f32_32x32x16_bf16 v[48:63], v[176:179], v[116:119], v[48:63]
    v_mfma_f32_32x32x16_bf16 v[64:79], v[180:183], v[116:119], v[64:79]
    s_waitcnt vmcnt(6)
    v_mfma_f32_32x32x16_bf16 v[48:63], v[184:187], v[120:123], v[48:63]
    v_mfma_f32_32x32x16_bf16 v[64:79], v[188:191], v[120:123], v[64:79]
    s_waitcnt vmcnt(5)
    v_mfma_f32_32x32x16_bf16 v[48:63], v[192:195], v[80:83], v[48:63]
    v_mfma_f32_32x32x16_bf16 v[64:79], v[196:199], v[80:83], v[64:79]
    s_waitcnt vmcnt(4)
    v_mfma_f32_32x32x16_bf16 v[48:63], v[200:203], v[84:87], v[48:63]
    v_mfma_f32_32x32x16_bf16 v[64:79], v[204:207], v[84:87], v[64:79]
    s_waitcnt vmcnt(3)
    v_mfma_f32_32x32x16_bf16 v[48:63], v[208:211], v[88:91], v[48:63]
    v_mfma_f32_32x32x16_bf16 v[64:79], v[212:215], v[88:91], v[64:79]
    s_waitcnt vmcnt(2)
    v_mfma_f32_32x32x16_bf16 v[48:63], v[216:219], v[92:95], v[48:63]
    v_mfma_f32_32x32x16_bf16 v[64:79], v[220:223], v[92:95], v[64:79]
    s_waitcnt vmcnt(1)
    v_mfma_f32_32x32x16_bf16 v[48:63], v[224:227], v[96:99], v[48:63]
    v_mfma_f32_32x32x16_bf16 v[64:79], v[228:231], v[96:99], v[64:79]
    s_waitcnt vmcnt(0)
    v_mfma_f32_32x32x16_bf16 v[48:63], v[232:235], v[100:103], v[48:63]
    v_mfma_f32_32x32x16_bf16 v[64:79], v[236:239], v[100:103], v[64:79]
    s_setprio 0
yf_16:
    s_nop 11
    v_mov_b32 v124, 160872
    s_mov_b32 s50, 0
rc_17:
    ds_read_b32 v125, v124
    s_waitcnt lgkmcnt(0)
    v_readfirstlane_b32 s36, v125
    s_cmp_ge_u32 s36, 8
    s_cbranch_scc1 rc_17_ok
    s_add_u32 s50, s50, 1
    s_cmp_ge_u32 s50, 1600000
    s_cbranch_scc1 rc_17_ok
    s_sleep 2
    s_branch rc_17
rc_17_ok:
    ds_write_b128 v10, v[16:19] offset:0
    ds_write_b128 v10, v[20:23] offset:1024
    ds_write_b128 v10, v[24:27] offset:2048
    ds_write_b128 v10, v[28:31] offset:3072
    ds_write_b128 v10, v[32:35] offset:4096
    ds_write_b128 v10, v[36:39] offset:5120
    ds_write_b128 v10, v[40:43] offset:6144
    ds_write_b128 v10, v[44:47] offset:7168
    v_add_u32 v10, 0x10000, v10
    ds_write_b128 v10, v[48:51] offset:0
    ds_write_b128 v10, v[52:55] offset:1024
    ds_write_b128 v10, v[56:59] offset:2048
    ds_write_b128 v10, v[60:63] offset:3072
    ds_write_b128 v10, v[64:67] offset:4096
    ds_write_b128 v10, v[68:71] offset:5120
    ds_write_b128 v10, v[72:75] offset:6144
    ds_write_b128 v10, v[76:79] offset:7168
    s_cmp_lg_u32 s3, 4
    s_cbranch_scc1 ychk_18
    s_mov_b32 s50, 0
ypoll_20:
    buffer_load_dword v5, v12, s[8:11], 0 offen sc1
    s_waitcnt vmcnt(0)
    v_cmp_eq_u32 vcc, 1, v5
    s_cmp_eq_u64 vcc, -1
    s_cbranch_scc1 ypoll_20_ok
    s_add_u32 s50, s50, 1
    s_cmp_ge_u32 s50, 200000
    s_cbranch_scc1 ypoll_20_ok
    s_sleep 8
    s_branch ypoll_20
ypoll_20_ok:
ye2_19:
    v_mov_b32 v124, 160896
    v_mov_b32 v125, 1
    s_mov_b64 exec, 1
    ds_add_u32 v124, v125
    s_mov_b64 exec, -1
ychk_18:
    v_mov_b32 v124, 160896
    s_mov_b32 s50, 0
yr_21:
    ds_read_b32 v125, v124
    s_waitcnt lgkmcnt(0)
    v_readfirstlane_b32 s36, v125
    s_cmp_ge_u32 s36, 1
    s_cbranch_scc1 yr_21_ok
    s_add_u32 s50, s50, 1
    s_cmp_ge_u32 s50, 1600000
    s_cbranch_scc1 yr_21_ok
    s_sleep 2
    s_branch yr_21
yr_21_ok:
    s_sub_u32 s47, s45, 4096
    v_subrev_u32 v13, 4096, v13
    buffer_load_dwordx4 v[244:247], v2, s[24:27], s47 offen sc1
    buffer_load_dwordx4 v[248:251], v2, s[24:27], s45 offen sc1
    s_waitcnt vmcnt(1)
    ds_write_b128 v13, v[244:247]
    s_waitcnt vmcnt(0)
    ds_write_b128 v13, v[248:251] offset:4096
k_fin:
    s_waitcnt vmcnt(0)
    v_lshlrev_b32 v96, 16, v240
    v_and_b32 v97, 0xffff0000, v240
    v_lshlrev_b32 v98, 16, v241
    v_and_b32 v99, 0xffff0000, v241
    v_lshlrev_b32 v100, 16, v242
    v_and_b32 v101, 0xffff0000, v242
    v_lshlrev_b32 v102, 16, v243
    v_and_b32 v103, 0xffff0000, v243
    s_waitcnt lgkmcnt(0)
    s_barrier
    ds_read_b64_tr_b16 v[244:245], v14
    ds_read_b64_tr_b16 v[246:247], v14 offset:512
    ds_read_b128 v[16:19], v11 offset:0
    ds_read_b128 v[20:23], v11 offset:1024
    ds_read_b128 v[24:27], v11 offset:8192
    ds_read_b128 v[28:31], v11 offset:9216
    ds_read_b128 v[32:35], v11 offset:16384
    ds_read_b128 v[36:39], v11 offset:17408
    ds_read_b128 v[40:43], v11 offset:24576
    ds_read_b128 v[44:47], v11 offset:25600
    ds_read_b128 v[48:51], v11 offset:32768
    ds_read_b128 v[52:55], v11 offset:33792
    ds_read_b128 v[56:59], v11 offset:40960
    ds_read_b128 v[60:63], v11 offset:41984
    ds_read_b128 v[64:67], v11 offset:49152
    ds_read_b128 v[68:71], v11 offset:50176
    ds_read_b128 v[72:75], v11 offset:57344
    ds_read_b128 v[76:79], v11 offset:58368
    s_waitcnt lgkmcnt(15)
    s_waitcnt lgkmcnt(14)
    v_lshlrev_b32 v104, 16, v244
    v_and_b32 v105, 0xffff0000, v244
    v_lshlrev_b32 v106, 16, v245
    v_and_b32 v107, 0xffff0000, v245
    v_lshlrev_b32 v108, 16, v246
    v_and_b32 v109, 0xffff0000, v246
    v_lshlrev_b32 v110, 16, v247
    v_and_b32 v111, 0xffff0000, v247
    v_pk_add_f32 v[96:97], v[96:97], v[104:105]
    v_pk_add_f32 v[98:99], v[98:99], v[106:107]
    v_pk_add_f32 v[100:101], v[100:101], v[108:109]
    v_pk_add_f32 v[102:103], v[102:103], v[110:111]
    s_waitcnt lgkmcnt(12)
    v_pk_add_f32 v[16:17], v[16:17], v[24:25]
    v_pk_add_f32 v[18:19], v[18:19], v[26:27]
    v_pk_add_f32 v[20:21], v[20:21], v[28:29]
    v_pk_add_f32 v[22:23], v[22:23], v[30:31]
    v_cvt_pk_bf16_f32 v104, v96, v97
    v_cvt_pk_bf16_f32 v105, v98, v99
    v_cvt_pk_bf16_f32 v106, v100, v101
    v_cvt_pk_bf16_f32 v107, v102, v103
    s_waitcnt lgkmcnt(8)
    v_pk_add_f32 v[32:33], v[32:33], v[40:41]
    v_pk_add_f32 v[34:35], v[34:35], v[42:43]
    v_pk_add_f32 v[36:37], v[36:37], v[44:45]
    v_pk_add_f32 v[38:39], v[38:39], v[46:47]
    v_lshlrev_b32 v96, 16, v104
    v_and_b32 v97, 0xffff0000, v104
    v_lshlrev_b32 v98, 16, v105
    v_and_b32 v99, 0xffff0000, v105
    v_lshlrev_b32 v100, 16, v106
    v_and_b32 v101, 0xffff0000, v106
    v_lshlrev_b32 v102, 16, v107
    v_and_b32 v103, 0xffff0000, v107
    v_pk_add_f32 v[16:17], v[16:17], v[32:33]
    v_pk_add_f32 v[18:19], v[18:19], v[34:35]
    v_pk_add_f32 v[20:21], v[20:21], v[36:37]
    v_pk_add_f32 v[22:23], v[22:23], v[38:39]
    s_waitcnt lgkmcnt(4)
    v_pk_add_f32 v[48:49], v[48:49], v[56:57]
    v_pk_add_f32 v[50:51], v[50:51], v[58:59]
    v_pk_add_f32 v[52:53], v[52:53], v[60:61]
    v_pk_add_f32 v[54:55], v[54:55], v[62:63]
    s_waitcnt lgkmcnt(0)
    v_pk_add_f32 v[64:65], v[64:65], v[72:73]
    v_pk_add_f32 v[66:67], v[66:67], v[74:75]
    v_pk_add_f32 v[68:69], v[68:69], v[76:77]
    v_pk_add_f32 v[70:71], v[70:71], v[78:79]
    v_pk_add_f32 v[48:49], v[48:49], v[64:65]
    v_pk_add_f32 v[50:51], v[50:51], v[66:67]
    v_pk_add_f32 v[52:53], v[52:53], v[68:69]
    v_pk_add_f32 v[54:55], v[54:55], v[70:71]
    v_pk_add_f32 v[16:17], v[16:17], v[48:49]
    v_pk_add_f32 v[18:19], v[18:19], v[50:51]
    v_pk_add_f32 v[20:21], v[20:21], v[52:53]
    v_pk_add_f32 v[22:23], v[22:23], v[54:55]
    v_cvt_pk_bf16_f32 v24, v16, v17
    v_cvt_pk_bf16_f32 v25, v18, v19
    v_cvt_pk_bf16_f32 v26, v20, v21
    v_cvt_pk_bf16_f32 v27, v22, v23
    v_lshlrev_b32 v16, 16, v24
    v_and_b32 v17, 0xffff0000, v24
    v_lshlrev_b32 v18, 16, v25
    v_and_b32 v19, 0xffff0000, v25
    v_lshlrev_b32 v20, 16, v26
    v_and_b32 v21, 0xffff0000, v26
    v_lshlrev_b32 v22, 16, v27
    v_and_b32 v23, 0xffff0000, v27
    v_pk_add_f32 v[16:17], v[16:17], v[96:97]
    v_pk_add_f32 v[18:19], v[18:19], v[98:99]
    v_pk_add_f32 v[20:21], v[20:21], v[100:101]
    v_pk_add_f32 v[22:23], v[22:23], v[102:103]
    v_cvt_pk_bf16_f32 v40, v16, v17
    v_cvt_pk_bf16_f32 v41, v18, v19
    v_cvt_pk_bf16_f32 v42, v20, v21
    v_cvt_pk_bf16_f32 v43, v22, v23
    buffer_store_dwordx4 v[40:43], v8, s[12:15], s46 offen
    s_endpgm
k_B:
    v_lshrrev_b32 v16, 3, v1
    s_lshl_b32 s37, s28, 7
    s_lshl_b32 s38, s31, 5
    s_add_u32 s37, s37, s38
    v_bfe_u32 v18, v16, 3, 1
    v_lshlrev_b32 v17, 4, v18
    v_bfe_u32 v18, v16, 1, 1
    v_lshl_or_b32 v17, v18, 3, v17
    v_and_b32 v18, 1, v16
    v_lshl_or_b32 v17, v18, 2, v17
    v_bfe_u32 v18, v16, 2, 1
    v_lshl_or_b32 v17, v18, 1, v17
    v_bfe_u32 v18, v16, 4, 1
    v_or_b32 v17, v18, v17
    v_add_u32 v17, s37, v17
    v_mul_u32_u24 v2, 896, v17
    v_bfe_u32 v17, v16, 1, 3
    v_and_b32 v18, 7, v1
    v_xor_b32 v17, v17, v18
    v_lshl_add_u32 v2, v17, 4, v2
    v_add_u32 v16, 8, v16
    v_bfe_u32 v18, v16, 3, 1
    v_lshlrev_b32 v17, 4, v18
    v_bfe_u32 v18, v16, 1, 1
    v_lshl_or_b32 v17, v18, 3, v17
    v_and_b32 v18, 1, v16
    v_lshl_or_b32 v17, v18, 2, v17
    v_bfe_u32 v18, v16, 2, 1
    v_lshl_or_b32 v17, v18, 1, v17
    v_bfe_u32 v18, v16, 4, 1
    v_or_b32 v17, v18, v17
    v_add_u32 v17, s37, v17
    v_mul_u32_u24 v3, 896, v17
    v_bfe_u32 v17, v16, 1, 3
    v_and_b32 v18, 7, v1
    v_xor_b32 v17, v17, v18
    v_lshl_add_u32 v3, v17, 4, v3
    v_add_u32 v16, 8, v16
    v_bfe_u32 v18, v16, 3, 1
    v_lshlrev_b32 v17, 4, v18
    v_bfe_u32 v18, v16, 1, 1
    v_lshl_or_b32 v17, v18, 3, v17
    v_and_b32 v18, 1, v16
    v_lshl_or_b32 v17, v18, 2, v17
    v_bfe_u32 v18, v16, 2, 1
    v_lshl_or_b32 v17, v18, 1, v17
    v_bfe_u32 v18, v16, 4, 1
    v_or_b32 v17, v18, v17
    v_add_u32 v17, s37, v17
    v_mul_u32_u24 v4, 896, v17
    v_bfe_u32 v17, v16, 1, 3
    v_and_b32 v18, 7, v1
    v_xor_b32 v17, v17, v18
    v_lshl_add_u32 v4, v17, 4, v4
    v_add_u32 v16, 8, v16
    v_bfe_u32 v18, v16, 3, 1
    v_lshlrev_b32 v17, 4, v18
    v_bfe_u32 v18, v16, 1, 1
    v_lshl_or_b32 v17, v18, 3, v17
    v_and_b32 v18, 1, v16
    v_lshl_or_b32 v17, v18, 2, v17
    v_bfe_u32 v18, v16, 2, 1
    v_lshl_or_b32 v17, v18, 1, v17
    v_bfe_u32 v18, v16, 4, 1
    v_or_b32 v17, v18, v17
    v_add_u32 v17, s37, v17
    v_mul_u32_u24 v5, 896, v17
    v_bfe_u32 v17, v16, 1, 3
    v_and_b32 v18, 7, v1
    v_xor_b32 v17, v17, v18
    v_lshl_add_u32 v5, v17, 4, v5
    v_lshrrev_b32 v16, 5, v1
    v_and_b32 v17, 3, v1
    v_lshl_add_u32 v17, v16, 2, v17
    v_lshlrev_b32 v17, 4, v17
    s_lshl_b32 s37, s29, 8
    v_add_u32 v17, s37, v17
    v_bfe_u32 v16, v1, 2, 3
    v_mul_u32_u24 v6, 3584, v16
    v_add_u32 v6, v6, v17
    v_xor_b32 v7, 32, v6
    s_mul_i32 s32, s31, 28672
    s_lshl_b32 s33, s31, 12
    s_and_b32 s37, s31, 1
    s_lshl_b32 s37, s37, 5
    v_xor_b32 v6, s37, v6
    v_mov_b32 v7, v6
    s_waitcnt lgkmcnt(0)
    s_mov_b32 s4, s40
    s_mov_b32 s5, s41
    s_mov_b32 s6, 1835008
    s_mov_b32 s7, 0x00020000
    s_mov_b32 s8, s60
    s_mov_b32 s9, s61
    s_mov_b32 s10, 1605632
    s_mov_b32 s11, 0x00020000
    s_mov_b32 s12, s62
    s_mov_b32 s13, s63
    s_mov_b32 s14, 1605632
    s_mov_b32 s15, 0x00020000
    s_lshr_b32 s42, s30, 1
    s_mul_i32 s45, s30, 8448
    s_add_u32 s45, s45, 126976
    s_mul_i32 s51, s42, 9216
    v_lshlrev_b32 v110, 3, v1
    v_add_u32 v110, s45, v110
    v_lshrrev_b32 v104, 4, v1
    v_lshlrev_b32 v104, 4, v104
    v_add_u32 v104, s45, v104
    v_and_b32 v105, 3, v1
    v_mul_u32_u24 v111, 528, v105
    v_add_u32 v111, v111, v104
    v_bfe_u32 v106, v1, 2, 2
    v_mul_u32_u24 v112, 528, v106
    v_add_u32 v112, v112, v104
    v_cmp_eq_u32 vcc, 0, v106
    v_add_u32 v113, 2112, v112
    v_and_b32 v107, 15, v1
    v_cndmask_b32 v113, v113, v104, vcc
    v_cmp_eq_u32 vcc, 2, v107
    v_add_u32 v114, 6336, v112
    v_add_u32 v104, 2112, v104
    v_cndmask_b32 v114, v114, v104, vcc
    v_mov_b32 v108, 0x3c00
    v_mov_b32 v109, 0x3c00
    v_lshlrev_b32 v119, 4, v1
    ds_write_b64 v110, v[108:109]
    v_and_b32 v104, 15, v1
    v_lshlrev_b32 v104, 3, v104
    v_lshrrev_b32 v105, 4, v1
    v_lshl_add_u32 v100, v105, 1, v104
    v_add_u32 v102, 1, v100
    v_lshlrev_b32 v101, 9, v105
    v_cmp_gt_u32 vcc, 2, v105
    v_lshlrev_b32 v105, 2, v105
    v_add_u32 v105, 512, v105
    v_cndmask_b32 v101, v101, v105, vcc
    v_add_u32 v101, v101, v104
    v_add_u32 v104, 2048, v104
    v_cvt_f32_u32 v100, v100
    v_cvt_f32_u32 v101, v101
    v_cvt_f32_u32 v102, v102
    v_cvt_f32_u32 v103, v104
    v_subrev_u32 v104, 16, v1
    v_mul_u32_u24 v122, 43691, v104
    v_lshrrev_b32 v122, 19, v122
    v_mul_u32_u24 v105, 12, v122
    v_sub_u32 v105, v104, v105
    v_mul_u32_u24 v122, 1216, v122
    v_lshlrev_b32 v106, 4, v105
    v_add_u32 v122, v122, v106
    v_add_u32 v106, 1024, v122
    v_cmp_gt_u32 vcc, 8, v105
    s_nop 1
    v_cndmask_b32 v122, v106, v122, vcc
    v_add_u32 v122, 4352, v122
    v_add_u32 v105, 4096, v119
    v_cmp_gt_u32 vcc, 8, v1
    s_nop 1
    v_cndmask_b32 v106, v105, v119, vcc
    v_cmp_gt_u32 vcc, 16, v1
    s_nop 1
    v_cndmask_b32 v122, v122, v106, vcc
    v_add_u32 v122, s51, v122
    v_add_u32 v122, 139264, v122
    v_add_u32 v121, s51, v121
    v_add_u32 v121, 139264, v121
    s_and_b32 s38, s2, 7
    s_lshr_b32 s39, s2, 3
    s_lshl_b32 s56, s38, 2
    s_and_b32 s38, s39, 3
    s_add_u32 s56, s56, s38
    s_lshr_b32 s57, s39, 2
    s_mov_b32 s16, s64
    s_mov_b32 s17, s65
    s_mov_b32 s18, 1605632
    s_mov_b32 s19, 0x00020000
    s_add_u32 s20, s70, 14680064
    s_addc_u32 s21, s71, 0
    s_mov_b32 s22, 79872
    s_mov_b32 s23, 0x00020000
    s_add_u32 s24, s70, 8388608
    s_addc_u32 s25, s71, 0
    s_mov_b32 s26, 1835008
    s_mov_b32 s27, 0x00020000
    s_lshl_b32 s36, s28, 11
    s_lshl_b32 s37, s30, 10
    s_add_u32 s36, s36, s37
    s_add_u32 s37, s37, 157696
    s_lshl_b32 s38, s29, 9
    s_add_u32 s38, s38, 65536
    s_cmp_lt_u32 s30, 2
    s_cselect_b32 s49, s36, s38
    s_cselect_b32 s37, s37, 159744
    s_cselect_b32 s38, 0, 6656
    v_lshlrev_b32 v123, 4, v1
    v_add_u32 v124, s37, v123
    v_lshrrev_b32 v16, 5, v1
    v_mul_u32_u24 v16, s38, v16
    v_add_u32 v123, v123, v16
    v_lshrrev_b32 v17, 3, v120
    s_mov_b32 s36, 57344
    v_mul_lo_u32 v125, v17, s36
    v_and_b32 v18, 3, v120
    v_lshl_add_u32 v125, v18, 4, v125
    v_bfe_u32 v18, v120, 2, 1
    v_mul_u32_u24 v18, 28672, v18
    v_add_u32 v125, v125, v18
    s_lshl_b32 s37, s2, 1
    s_add_u32 s37, s37, s42
    s_lshl_b32 s37, s37, 6
    v_add_u32 v125, s37, v125
    v_bfe_u32 v18, v120, 1, 2
    v_mul_u32_u24 v126, 1216, v18
    v_lshl_add_u32 v126, v17, 5, v126
    v_and_b32 v18, 1, v120
    v_lshl_add_u32 v126, v18, 4, v126
    s_add_u32 s36, s51, 143744
    v_add_u32 v126, s36, v126
    v_lshrrev_b32 v16, 3, v1
    v_mul_u32_u24 v127, 896, v16
    v_bfe_u32 v16, v1, 4, 1
    v_lshlrev_b32 v16, 2, v16
    v_and_b32 v17, 7, v1
    v_xor_b32 v16, v16, v17
    v_lshl_add_u32 v127, v16, 4, v127
    s_mul_i32 s58, s30, 200704
    s_lshl_b32 s36, s57, 7
    s_add_u32 s58, s58, s36
    v_lshlrev_b32 v16, 2, v1
    v_add_u32 v16, 160832, v16
    v_mov_b32 v17, 0
    s_mov_b64 exec, 0xffffff
    ds_write_b32 v16, v17
    s_mov_b64 exec, -1
    s_waitcnt vmcnt(0)
    v_lshlrev_b32 v117, 16, v117
    v_cmp_eq_u32 vcc, 0, v1
    v_mul_f32 v22, 0x3fb8aa00, v117
    v_mul_f32 v23, 0x36a407db, v117
    v_exp_f32 v22, v22
    v_lshlrev_b32 v118, 16, v118
    v_fma_f32 v22, v22, v23, v22
    v_cndmask_b32 v118, 0, v118, vcc
    v_cvt_pk_bf16_f32 v23, v22, v22
    v_lshlrev_b32 v117, 16, v23
    v_lshlrev_b32 v16, 16, v192
    v_and_b32 v46, 0xffff0000, v192
    v_lshlrev_b32 v17, 16, v193
    v_and_b32 v47, 0xffff0000, v193
    v_lshlrev_b32 v18, 16, v194
    v_and_b32 v48, 0xffff0000, v194
    v_lshlrev_b32 v19, 16, v195
    v_and_b32 v49, 0xffff0000, v195
    v_lshlrev_b32 v20, 16, v196
    v_and_b32 v50, 0xffff0000, v196
    v_lshlrev_b32 v21, 16, v197
    v_and_b32 v51, 0xffff0000, v197
    v_mul_f32 v24, 0x3fb8aa3b, v117
    v_mul_f32 v25, 0x3e22f983, v117
    s_mov_b32 s52, 0x41000000
    s_mov_b32 s53, 0x43000000
    v_pk_mul_f32 v[16:17], v[16:17], v[24:25]
    v_pk_mul_f32 v[46:47], v[46:47], v[24:25]
    v_pk_mul_f32 v[22:23], v[20:21], v[18:19] op_sel:[0,0] op_sel_hi:[0,1]
    v_pk_mul_f32 v[52:53], v[50:51], v[48:49] op_sel:[0,0] op_sel_hi:[0,1]
    v_pk_fma_f32 v[26:27], v[20:21], v[18:19], v[22:23] op_sel:[1,1,0] op_sel_hi:[1,0,1] neg_lo:[1,0,0]
    v_pk_fma_f32 v[56:57], v[50:51], v[48:49], v[52:53] op_sel:[1,1,0] op_sel_hi:[1,0,1] neg_lo:[1,0,0]
    v_max3_f32 v115, 0, v16, v46
    v_max3_f32 v116, |v26|, |v27|, |v56|
    v_max_f32 v116, |v57|, v116
    s_nop 1
    v_max_f32_dpp v115, v115, v115 quad_perm:[1,0,3,2] row_mask:0xf bank_mask:0xf
    v_max_f32_dpp v116, v116, v116 quad_perm:[1,0,3,2] row_mask:0xf bank_mask:0xf
    s_nop 1
    v_max_f32_dpp v115, v115, v115 quad_perm:[2,3,0,1] row_mask:0xf bank_mask:0xf
    v_max_f32_dpp v116, v116, v116 quad_perm:[2,3,0,1] row_mask:0xf bank_mask:0xf
    s_nop 1
    v_max_f32_dpp v115, v115, v115 row_half_mirror row_mask:0xf bank_mask:0xf
    v_max_f32_dpp v116, v116, v116 row_half_mirror row_mask:0xf bank_mask:0xf
    s_nop 1
    v_max_f32_dpp v115, v115, v115 row_mirror row_mask:0xf bank_mask:0xf
    v_max_f32_dpp v116, v116, v116 row_mirror row_mask:0xf bank_mask:0xf
    s_nop 0
    v_readlane_b32 s60, v115, 0
    v_readlane_b32 s61, v115, 16
    v_readlane_b32 s62, v115, 32
    v_readlane_b32 s63, v115, 48
    v_readlane_b32 s36, v116, 0
    v_readlane_b32 s37, v116, 16
    v_readlane_b32 s38, v116, 32
    v_readlane_b32 s39, v116, 48
    s_nop 0
    s_max_u32 s60, s60, s61
    s_max_u32 s62, s62, s63
    s_max_u32 s60, s60, s62
    s_max_u32 s36, s36, s37
    s_max_u32 s38, s38, s39
    s_max_u32 s36, s36, s38
    v_mov_b32 v115, s60
    s_lshr_b32 s36, s36, 23
    s_max_u32 s36, s36, 16
    s_min_u32 s36, s36, 254
    s_sub_u32 s38, 264, s36
    s_lshl_b32 s38, s38, 23
    s_sub_u32 s36, s36, 10
    s_lshl_b32 s36, s36, 23
    v_subrev_f32 v16, s60, v16
    v_subrev_f32 v46, s60, v46
    v_pk_mul_f32 v[26:27], v[26:27], s[38:39] op_sel:[0,0] op_sel_hi:[1,0]
    v_pk_mul_f32 v[56:57], v[56:57], s[38:39] op_sel:[0,0] op_sel_hi:[1,0]
    v_mul_f32 v116, s36, v117
    v_cvt_pk_f16_f32 v104, v26, -v27
    v_cvt_pk_f16_f32 v105, v56, -v57
    ds_write_b64 v110, v[104:105] offset:2112
    v_pk_mul_f32 v[22:23], v[16:17], s[52:53] op_sel:[0,0] op_sel_hi:[1,0]
    v_pk_mul_f32 v[52:53], v[46:47], s[52:53] op_sel:[0,0] op_sel_hi:[1,0]
    v_exp_f32 v22, v22
    v_exp_f32 v52, v52
    v_fract_f32 v23, v23
    v_fract_f32 v53, v53
    s_nop 0
    v_cos_f32 v24, v23
    v_sin_f32 v25, v23
    v_cos_f32 v54, v53
    v_sin_f32 v55, v53
    s_nop 0
    v_pk_mul_f32 v[34:35], v[22:23], v[24:25] op_sel:[0,0] op_sel_hi:[0,1]
    v_pk_mul_f32 v[64:65], v[52:53], v[54:55] op_sel:[0,0] op_sel_hi:[0,1]
    v_cvt_pk_f16_f32 v106, v34, -v35
    v_cvt_pk_f16_f32 v107, v64, -v65
    ds_write_b64 v110, v[106:107] offset:528
    v_pk_mul_f32 v[22:23], v[34:35], v[34:35] op_sel:[0,0] op_sel_hi:[0,1]
    v_pk_mul_f32 v[52:53], v[64:65], v[64:65] op_sel:[0,0] op_sel_hi:[0,1]
    v_pk_fma_f32 v[36:37], v[34:35], v[34:35], v[22:23] op_sel:[1,1,0] op_sel_hi:[1,0,1] neg_lo:[1,0,0]
    v_pk_fma_f32 v[66:67], v[64:65], v[64:65], v[52:53] op_sel:[1,1,0] op_sel_hi:[1,0,1] neg_lo:[1,0,0]
    v_cvt_pk_f16_f32 v104, v36, -v37
    v_cvt_pk_f16_f32 v105, v66, -v67
    ds_write_b64 v110, v[104:105] offset:1056
    v_pk_mul_f32 v[22:23], v[36:37], v[34:35] op_sel:[0,0] op_sel_hi:[0,1]
    v_pk_mul_f32 v[52:53], v[66:67], v[64:65] op_sel:[0,0] op_sel_hi:[0,1]
    v_pk_fma_f32 v[42:43], v[36:37], v[34:35], v[22:23] op_sel:[1,1,0] op_sel_hi:[1,0,1] neg_lo:[1,0,0]
    v_pk_fma_f32 v[72:73], v[66:67], v[64:65], v[52:53] op_sel:[1,1,0] op_sel_hi:[1,0,1] neg_lo:[1,0,0]
    v_cvt_pk_f16_f32 v106, v42, -v43
    v_cvt_pk_f16_f32 v107, v72, -v73
    ds_write_b64 v110, v[106:107] offset:1584
    v_pk_mul_f32 v[22:23], v[36:37], v[36:37] op_sel:[0,0] op_sel_hi:[0,1]
    v_pk_mul_f32 v[52:53], v[66:67], v[66:67] op_sel:[0,0] op_sel_hi:[0,1]
    v_pk_fma_f32 v[38:39], v[36:37], v[36:37], v[22:23] op_sel:[1,1,0] op_sel_hi:[1,0,1] neg_lo:[1,0,0]
    v_pk_fma_f32 v[68:69], v[66:67], v[66:67], v[52:53] op_sel:[1,1,0] op_sel_hi:[1,0,1] neg_lo:[1,0,0]
    v_pk_mul_f32 v[22:23], v[26:27], v[38:39] op_sel:[0,0] op_sel_hi:[0,1]
    v_pk_mul_f32 v[52:53], v[56:57], v[68:69] op_sel:[0,0] op_sel_hi:[0,1]
    v_pk_fma_f32 v[42:43], v[26:27], v[38:39], v[22:23] op_sel:[1,1,0] op_sel_hi:[1,0,1] neg_lo:[1,0,0]
    v_pk_fma_f32 v[72:73], v[56:57], v[68:69], v[52:53] op_sel:[1,1,0] op_sel_hi:[1,0,1] neg_lo:[1,0,0]
    v_cvt_pk_f16_f32 v104, v42, -v43
    v_cvt_pk_f16_f32 v105, v72, -v73
    ds_write_b64 v110, v[104:105] offset:2640
    v_pk_mul_f32 v[22:23], v[42:43], v[38:39] op_sel:[0,0] op_sel_hi:[0,1]
    v_pk_mul_f32 v[52:53], v[72:73], v[68:69] op_sel:[0,0] op_sel_hi:[0,1]
    v_pk_fma_f32 v[44:45], v[42:43], v[38:39], v[22:23] op_sel:[1,1,0] op_sel_hi:[1,0,1] neg_lo:[1,0,0]
    v_pk_fma_f32 v[74:75], v[72:73], v[68:69], v[52:53] op_sel:[1,1,0] op_sel_hi:[1,0,1] neg_lo:[1,0,0]
    v_cvt_pk_f16_f32 v106, v44, -v45
    v_cvt_pk_f16_f32 v107, v74, -v75
    ds_write_b64 v110, v[106:107] offset:3168
    v_pk_mul_f32 v[22:23], v[44:45], v[38:39] op_sel:[0,0] op_sel_hi:[0,1]
    v_pk_mul_f32 v[52:53], v[74:75], v[68:69] op_sel:[0,0] op_sel_hi:[0,1]
    v_pk_fma_f32 v[42:43], v[44:45], v[38:39], v[22:23] op_sel:[1,1,0] op_sel_hi:[1,0,1] neg_lo:[1,0,0]
    v_pk_fma_f32 v[72:73], v[74:75], v[68:69], v[52:53] op_sel:[1,1,0] op_sel_hi:[1,0,1] neg_lo:[1,0,0]
    v_cvt_pk_f16_f32 v104, v42, -v43
    v_cvt_pk_f16_f32 v105, v72, -v73
    ds_write_b64 v110, v[104:105] offset:3696
    ds_read_b128 v[224:227], v111 offset:0
    ds_read_b128 v[228:231], v111 offset:64
    ds_read_b128 v[232:235], v111 offset:128
    ds_read_b128 v[236:239], v111 offset:192
    ds_read_b128 v[240:243], v111 offset:256
    ds_read_b128 v[244:247], v111 offset:320
    ds_read_b128 v[248:251], v111 offset:384
    ds_read_b128 v[252:255], v111 offset:448
    ds_read_b128 v[128:131], v112 offset:2112
    ds_read_b128 v[132:135], v112 offset:2176
    ds_read_b128 v[136:139], v112 offset:2240
    ds_read_b128 v[140:143], v112 offset:2304
    ds_read_b128 v[144:147], v112 offset:2368
    ds_read_b128 v[148:151], v112 offset:2432
    ds_read_b128 v[152:155], v112 offset:2496
    ds_read_b128 v[156:159], v112 offset:2560
    v_exp_f32 v22, v16
    v_exp_f32 v52, v46
    v_fract_f32 v23, v17
    v_fract_f32 v53, v47
    s_nop 0
    v_cos_f32 v24, v23
    v_sin_f32 v25, v23
    v_cos_f32 v54, v53
    v_sin_f32 v55, v53
    s_nop 0
    v_pk_mul_f32 v[28:29], v[22:23], v[24:25] op_sel:[0,0] op_sel_hi:[0,1]
    v_pk_mul_f32 v[58:59], v[52:53], v[54:55] op_sel:[0,0] op_sel_hi:[0,1]
    v_pk_mul_f32 v[22:23], v[16:17], s[52:53] op_sel:[0,1] op_sel_hi:[1,1]
    v_pk_mul_f32 v[52:53], v[46:47], s[52:53] op_sel:[0,1] op_sel_hi:[1,1]
    v_exp_f32 v22, v22
    v_exp_f32 v52, v52
    v_fract_f32 v23, v23
    v_fract_f32 v53, v53
    s_nop 0
    v_cos_f32 v24, v23
    v_sin_f32 v25, v23
    v_cos_f32 v54, v53
    v_sin_f32 v55, v53
    s_nop 0
    v_pk_mul_f32 v[34:35], v[22:23], v[24:25] op_sel:[0,0] op_sel_hi:[0,1]
    v_pk_mul_f32 v[64:65], v[52:53], v[54:55] op_sel:[0,0] op_sel_hi:[0,1]
    v_cvt_pk_f16_f32 v106, v34, v35
    v_cvt_pk_f16_f32 v107, v64, v65
    ds_write_b64 v110, v[106:107] offset:528
    v_cvt_pk_f16_f32 v104, v28, v29
    v_cvt_pk_f16_f32 v105, v58, v59
    ds_write_b64 v110, v[104:105] offset:6336
    v_pk_mul_f32 v[22:23], v[34:35], v[34:35] op_sel:[0,0] op_sel_hi:[0,1]
    v_pk_mul_f32 v[52:53], v[64:65], v[64:65] op_sel:[0,0] op_sel_hi:[0,1]
    v_pk_fma_f32 v[36:37], v[34:35], v[34:35], v[22:23] op_sel:[1,1,0] op_sel_hi:[1,0,1] neg_lo:[1,0,0]
    v_pk_fma_f32 v[66:67], v[64:65], v[64:65], v[52:53] op_sel:[1,1,0] op_sel_hi:[1,0,1] neg_lo:[1,0,0]
    v_cvt_pk_f16_f32 v106, v36, v37
    v_cvt_pk_f16_f32 v107, v66, v67
    ds_write_b64 v110, v[106:107] offset:1056
    v_pk_mul_f32 v[22:23], v[28:29], v[28:29] op_sel:[0,0] op_sel_hi:[0,1]
    v_pk_mul_f32 v[52:53], v[58:59], v[58:59] op_sel:[0,0] op_sel_hi:[0,1]
    v_pk_fma_f32 v[30:31], v[28:29], v[28:29], v[22:23] op_sel:[1,1,0] op_sel_hi:[1,0,1] neg_lo:[1,0,0]
    v_pk_fma_f32 v[60:61], v[58:59], v[58:59], v[52:53] op_sel:[1,1,0] op_sel_hi:[1,0,1] neg_lo:[1,0,0]
    v_cvt_pk_f16_f32 v104, v30, v31
    v_cvt_pk_f16_f32 v105, v60, v61
    ds_write_b64 v110, v[104:105] offset:2640
    v_pk_mul_f32 v[22:23], v[36:37], v[34:35] op_sel:[0,0] op_sel_hi:[0,1]
    v_pk_mul_f32 v[52:53], v[66:67], v[64:65] op_sel:[0,0] op_sel_hi:[0,1]
    v_pk_fma_f32 v[42:43], v[36:37], v[34:35], v[22:23] op_sel:[1,1,0] op_sel_hi:[1,0,1] neg_lo:[1,0,0]
    v_pk_fma_f32 v[72:73], v[66:67], v[64:65], v[52:53] op_sel:[1,1,0] op_sel_hi:[1,0,1] neg_lo:[1,0,0]
    v_cvt_pk_f16_f32 v106, v42, v43
    v_cvt_pk_f16_f32 v107, v72, v73
    ds_write_b64 v110, v[106:107] offset:1584
    v_pk_mul_f32 v[22:23], v[30:31], v[30:31] op_sel:[0,0] op_sel_hi:[0,1]
    v_pk_mul_f32 v[52:53], v[60:61], v[60:61] op_sel:[0,0] op_sel_hi:[0,1]
    v_pk_fma_f32 v[32:33], v[30:31], v[30:31], v[22:23] op_sel:[1,1,0] op_sel_hi:[1,0,1] neg_lo:[1,0,0]
    v_pk_fma_f32 v[62:63], v[60:61], v[60:61], v[52:53] op_sel:[1,1,0] op_sel_hi:[1,0,1] neg_lo:[1,0,0]
    v_cvt_pk_f16_f32 v104, v32, v33
    v_cvt_pk_f16_f32 v105, v62, v63
    ds_write_b64 v110, v[104:105] offset:3168
    v_pk_mul_f32 v[22:23], v[32:33], v[30:31] op_sel:[0,0] op_sel_hi:[0,1]
    v_pk_mul_f32 v[52:53], v[62:63], v[60:61] op_sel:[0,0] op_sel_hi:[0,1]
    v_pk_fma_f32 v[42:43], v[32:33], v[30:31], v[22:23] op_sel:[1,1,0] op_sel_hi:[1,0,1] neg_lo:[1,0,0]
    v_pk_fma_f32 v[72:73], v[62:63], v[60:61], v[52:53] op_sel:[1,1,0] op_sel_hi:[1,0,1] neg_lo:[1,0,0]
    v_cvt_pk_f16_f32 v106, v42, v43
    v_cvt_pk_f16_f32 v107, v72, v73
    ds_write_b64 v110, v[106:107] offset:3696
    v_pk_mul_f32 v[22:23], v[42:43], v[28:29] op_sel:[0,0] op_sel_hi:[0,1]
    v_pk_mul_f32 v[52:53], v[72:73], v[58:59] op_sel:[0,0] op_sel_hi:[0,1]
    v_pk_fma_f32 v[44:45], v[42:43], v[28:29], v[22:23] op_sel:[1,1,0] op_sel_hi:[1,0,1] neg_lo:[1,0,0]
    v_pk_fma_f32 v[74:75], v[72:73], v[58:59], v[52:53] op_sel:[1,1,0] op_sel_hi:[1,0,1] neg_lo:[1,0,0]
    v_cvt_pk_f16_f32 v104, v44, v45
    v_cvt_pk_f16_f32 v105, v74, v75
    ds_write_b64 v110, v[104:105] offset:7920
    v_pk_mul_f32 v[22:23], v[36:37], v[36:37] op_sel:[0,0] op_sel_hi:[0,1]
    v_pk_mul_f32 v[52:53], v[66:67], v[66:67] op_sel:[0,0] op_sel_hi:[0,1]
    v_pk_fma_f32 v[38:39], v[36:37], v[36:37], v[22:23] op_sel:[1,1,0] op_sel_hi:[1,0,1] neg_lo:[1,0,0]
    v_pk_fma_f32 v[68:69], v[66:67], v[66:67], v[52:53] op_sel:[1,1,0] op_sel_hi:[1,0,1] neg_lo:[1,0,0]
    v_cvt_pk_f16_f32 v106, v38, v39
    v_cvt_pk_f16_f32 v107, v68, v69
    ds_write_b64 v110, v[106:107] offset:4224
    v_pk_mul_f32 v[22:23], v[32:33], v[38:39] op_sel:[0,0] op_sel_hi:[0,1]
    v_pk_mul_f32 v[52:53], v[62:63], v[68:69] op_sel:[0,0] op_sel_hi:[0,1]
    v_pk_fma_f32 v[42:43], v[32:33], v[38:39], v[22:23] op_sel:[1,1,0] op_sel_hi:[1,0,1] neg_lo:[1,0,0]
    v_pk_fma_f32 v[72:73], v[62:63], v[68:69], v[52:53] op_sel:[1,1,0] op_sel_hi:[1,0,1] neg_lo:[1,0,0]
    v_cvt_pk_f16_f32 v104, v42, v43
    v_cvt_pk_f16_f32 v105, v72, v73
    ds_write_b64 v110, v[104:105] offset:4752
    v_pk_mul_f32 v[22:23], v[38:39], v[38:39] op_sel:[0,0] op_sel_hi:[0,1]
    v_pk_mul_f32 v[52:53], v[68:69], v[68:69] op_sel:[0,0] op_sel_hi:[0,1]
    v_pk_fma_f32 v[40:41], v[38:39], v[38:39], v[22:23] op_sel:[1,1,0] op_sel_hi:[1,0,1] neg_lo:[1,0,0]
    v_pk_fma_f32 v[70:71], v[68:69], v[68:69], v[52:53] op_sel:[1,1,0] op_sel_hi:[1,0,1] neg_lo:[1,0,0]
    v_cvt_pk_f16_f32 v106, v40, v41
    v_cvt_pk_f16_f32 v107, v70, v71
    ds_write_b64 v110, v[106:107] offset:5280
    v_pk_mul_f32 v[22:23], v[40:41], v[38:39] op_sel:[0,0] op_sel_hi:[0,1]
    v_pk_mul_f32 v[52:53], v[70:71], v[68:69] op_sel:[0,0] op_sel_hi:[0,1]
    v_pk_fma_f32 v[42:43], v[40:41], v[38:39], v[22:23] op_sel:[1,1,0] op_sel_hi:[1,0,1] neg_lo:[1,0,0]
    v_pk_fma_f32 v[72:73], v[70:71], v[68:69], v[52:53] op_sel:[1,1,0] op_sel_hi:[1,0,1] neg_lo:[1,0,0]
    v_cvt_pk_f16_f32 v104, v42, v43
    v_cvt_pk_f16_f32 v105, v72, v73
    ds_write_b64 v110, v[104:105] offset:5808
    v_pk_mul_f32 v[22:23], v[42:43], v[36:37] op_sel:[0,0] op_sel_hi:[0,1]
    v_pk_mul_f32 v[52:53], v[72:73], v[66:67] op_sel:[0,0] op_sel_hi:[0,1]
    v_pk_fma_f32 v[44:45], v[42:43], v[36:37], v[22:23] op_sel:[1,1,0] op_sel_hi:[1,0,1] neg_lo:[1,0,0]
    v_pk_fma_f32 v[74:75], v[72:73], v[66:67], v[52:53] op_sel:[1,1,0] op_sel_hi:[1,0,1] neg_lo:[1,0,0]
    v_cvt_pk_f16_f32 v106, v44, v45
    v_cvt_pk_f16_f32 v107, v74, v75
    ds_write_b64 v110, v[106:107] offset:2112
    v_pk_mul_f32 v[22:23], v[30:31], v[28:29] op_sel:[0,0] op_sel_hi:[0,1]
    v_pk_mul_f32 v[52:53], v[60:61], v[58:59] op_sel:[0,0] op_sel_hi:[0,1]
    v_pk_fma_f32 v[42:43], v[30:31], v[28:29], v[22:23] op_sel:[1,1,0] op_sel_hi:[1,0,1] neg_lo:[1,0,0]
    v_pk_fma_f32 v[72:73], v[60:61], v[58:59], v[52:53] op_sel:[1,1,0] op_sel_hi:[1,0,1] neg_lo:[1,0,0]
    v_cvt_pk_f16_f32 v104, v42, v43
    v_cvt_pk_f16_f32 v105, v72, v73
    ds_write_b64 v110, v[104:105] offset:6864
    v_pk_mul_f32 v[22:23], v[32:33], v[28:29] op_sel:[0,0] op_sel_hi:[0,1]
    v_pk_mul_f32 v[52:53], v[62:63], v[58:59] op_sel:[0,0] op_sel_hi:[0,1]
    v_pk_fma_f32 v[44:45], v[32:33], v[28:29], v[22:23] op_sel:[1,1,0] op_sel_hi:[1,0,1] neg_lo:[1,0,0]
    v_pk_fma_f32 v[74:75], v[62:63], v[58:59], v[52:53] op_sel:[1,1,0] op_sel_hi:[1,0,1] neg_lo:[1,0,0]
    v_cvt_pk_f16_f32 v106, v44, v45
    v_cvt_pk_f16_f32 v107, v74, v75
    ds_write_b64 v110, v[106:107] offset:7392
    ds_read_b128 v[160:163], v113 offset:0
    ds_read_b128 v[164:167], v113 offset:64
    ds_read_b128 v[168:171], v113 offset:128
    ds_read_b128 v[172:175], v113 offset:192
    ds_read_b128 v[176:179], v113 offset:256
    ds_read_b128 v[180:183], v113 offset:320
    ds_read_b128 v[184:187], v113 offset:384
    ds_read_b128 v[188:191], v113 offset:448
    ds_read_b128 v[192:195], v112 offset:4224
    ds_read_b128 v[196:199], v112 offset:4288
    ds_read_b128 v[200:203], v112 offset:4352
    ds_read_b128 v[204:207], v112 offset:4416
    ds_read_b128 v[208:211], v112 offset:4480
    ds_read_b128 v[212:215], v112 offset:4544
    ds_read_b128 v[216:219], v112 offset:4608
    ds_read_b128 v[220:223], v112 offset:4672
    s_waitcnt lgkmcnt(15)
    v_pk_mul_f16 v104, v128, v224 op_sel:[0,0] op_sel_hi:[1,0]
    v_pk_mul_f16 v105, v129, v225 op_sel:[0,0] op_sel_hi:[1,0]
    v_pk_mul_f16 v106, v130, v226 op_sel:[0,0] op_sel_hi:[1,0]
    v_pk_mul_f16 v107, v131, v227 op_sel:[0,0] op_sel_hi:[1,0]
    v_pk_fma_f16 v128, v128, v224, v104 op_sel:[1,1,0] op_sel_hi:[0,1,1] neg_lo:[1,0,0]
    v_pk_fma_f16 v129, v129, v225, v105 op_sel:[1,1,0] op_sel_hi:[0,1,1] neg_lo:[1,0,0]
    v_pk_fma_f16 v130, v130, v226, v106 op_sel:[1,1,0] op_sel_hi:[0,1,1] neg_lo:[1,0,0]
    v_pk_fma_f16 v131, v131, v227, v107 op_sel:[1,1,0] op_sel_hi:[0,1,1] neg_lo:[1,0,0]
    v_pk_mul_f16 v104, v132, v228 op_sel:[0,0] op_sel_hi:[1,0]
    v_pk_mul_f16 v105, v133, v229 op_sel:[0,0] op_sel_hi:[1,0]
    v_pk_mul_f16 v106, v134, v230 op_sel:[0,0] op_sel_hi:[1,0]
    v_pk_mul_f16 v107, v135, v231 op_sel:[0,0] op_sel_hi:[1,0]
    v_pk_fma_f16 v132, v132, v228, v104 op_sel:[1,1,0] op_sel_hi:[0,1,1] neg_lo:[1,0,0]
    v_pk_fma_f16 v133, v133, v229, v105 op_sel:[1,1,0] op_sel_hi:[0,1,1] neg_lo:[1,0,0]
    v_pk_fma_f16 v134, v134, v230, v106 op_sel:[1,1,0] op_sel_hi:[0,1,1] neg_lo:[1,0,0]
    v_pk_fma_f16 v135, v135, v231, v107 op_sel:[1,1,0] op_sel_hi:[0,1,1] neg_lo:[1,0,0]
    v_pk_mul_f16 v104, v136, v232 op_sel:[0,0] op_sel_hi:[1,0]
    v_pk_mul_f16 v105, v137, v233 op_sel:[0,0] op_sel_hi:[1,0]
    v_pk_mul_f16 v106, v138, v234 op_sel:[0,0] op_sel_hi:[1,0]
    v_pk_mul_f16 v107, v139, v235 op_sel:[0,0] op_sel_hi:[1,0]
    v_pk_fma_f16 v136, v136, v232, v104 op_sel:[1,1,0] op_sel_hi:[0,1,1] neg_lo:[1,0,0]
    v_pk_fma_f16 v137, v137, v233, v105 op_sel:[1,1,0] op_sel_hi:[0,1,1] neg_lo:[1,0,0]
    v_pk_fma_f16 v138, v138, v234, v106 op_sel:[1,1,0] op_sel_hi:[0,1,1] neg_lo:[1,0,0]
    v_pk_fma_f16 v139, v139, v235, v107 op_sel:[1,1,0] op_sel_hi:[0,1,1] neg_lo:[1,0,0]
    v_pk_mul_f16 v104, v140, v236 op_sel:[0,0] op_sel_hi:[1,0]
    v_pk_mul_f16 v105, v141, v237 op_sel:[0,0] op_sel_hi:[1,0]
    v_pk_mul_f16 v106, v142, v238 op_sel:[0,0] op_sel_hi:[1,0]
    v_pk_mul_f16 v107, v143, v239 op_sel:[0,0] op_sel_hi:[1,0]
    v_pk_fma_f16 v140, v140, v236, v104 op_sel:[1,1,0] op_sel_hi:[0,1,1] neg_lo:[1,0,0]
    v_pk_fma_f16 v141, v141, v237, v105 op_sel:[1,1,0] op_sel_hi:[0,1,1] neg_lo:[1,0,0]
    v_pk_fma_f16 v142, v142, v238, v106 op_sel:[1,1,0] op_sel_hi:[0,1,1] neg_lo:[1,0,0]
    v_pk_fma_f16 v143, v143, v239, v107 op_sel:[1,1,0] op_sel_hi:[0,1,1] neg_lo:[1,0,0]
    s_barrier
    v_pk_mul_f16 v104, v144, v240 op_sel:[0,0] op_sel_hi:[1,0]
    v_pk_mul_f16 v105, v145, v241 op_sel:[0,0] op_sel_hi:[1,0]
    v_pk_mul_f16 v106, v146, v242 op_sel:[0,0] op_sel_hi:[1,0]
    v_pk_mul_f16 v107, v147, v243 op_sel:[0,0] op_sel_hi:[1,0]
    v_pk_fma_f16 v144, v144, v240, v104 op_sel:[1,1,0] op_sel_hi:[0,1,1] neg_lo:[1,0,0]
    v_pk_fma_f16 v145, v145, v241, v105 op_sel:[1,1,0] op_sel_hi:[0,1,1] neg_lo:[1,0,0]
    v_pk_fma_f16 v146, v146, v242, v106 op_sel:[1,1,0] op_sel_hi:[0,1,1] neg_lo:[1,0,0]
    v_pk_fma_f16 v147, v147, v243, v107 op_sel:[1,1,0] op_sel_hi:[0,1,1] neg_lo:[1,0,0]
    v_pk_mul_f16 v104, v148, v244 op_sel:[0,0] op_sel_hi:[1,0]
    v_pk_mul_f16 v105, v149, v245 op_sel:[0,0] op_sel_hi:[1,0]
    v_pk_mul_f16 v106, v150, v246 op_sel:[0,0] op_sel_hi:[1,0]
    v_pk_mul_f16 v107, v151, v247 op_sel:[0,0] op_sel_hi:[1,0]
    v_pk_fma_f16 v148, v148, v244, v104 op_sel:[1,1,0] op_sel_hi:[0,1,1] neg_lo:[1,0,0]
    v_pk_fma_f16 v149, v149, v245, v105 op_sel:[1,1,0] op_sel_hi:[0,1,1] neg_lo:[1,0,0]
    v_pk_fma_f16 v150, v150, v246, v106 op_sel:[1,1,0] op_sel_hi:[0,1,1] neg_lo:[1,0,0]
    v_pk_fma_f16 v151, v151, v247, v107 op_sel:[1,1,0] op_sel_hi:[0,1,1] neg_lo:[1,0,0]
    v_pk_mul_f16 v104, v152, v248 op_sel:[0,0] op_sel_hi:[1,0]
    v_pk_mul_f16 v105, v153, v249 op_sel:[0,0] op_sel_hi:[1,0]
    v_pk_mul_f16 v106, v154, v250 op_sel:[0,0] op_sel_hi:[1,0]
    v_pk_mul_f16 v107, v155, v251 op_sel:[0,0] op_sel_hi:[1,0]
    v_pk_fma_f16 v152, v152, v248, v104 op_sel:[1,1,0] op_sel_hi:[0,1,1] neg_lo:[1,0,0]
    v_pk_fma_f16 v153, v153, v249, v105 op_sel:[1,1,0] op_sel_hi:[0,1,1] neg_lo:[1,0,0]
    v_pk_fma_f16 v154, v154, v250, v106 op_sel:[1,1,0] op_sel_hi:[0,1,1] neg_lo:[1,0,0]
    v_pk_fma_f16 v155, v155, v251, v107 op_sel:[1,1,0] op_sel_hi:[0,1,1] neg_lo:[1,0,0]
    v_pk_mul_f16 v104, v156, v252 op_sel:[0,0] op_sel_hi:[1,0]
    v_pk_mul_f16 v105, v157, v253 op_sel:[0,0] op_sel_hi:[1,0]
    v_pk_mul_f16 v106, v158, v254 op_sel:[0,0] op_sel_hi:[1,0]
    v_pk_mul_f16 v107, v159, v255 op_sel:[0,0] op_sel_hi:[1,0]
    v_pk_fma_f16 v156, v156, v252, v104 op_sel:[1,1,0] op_sel_hi:[0,1,1] neg_lo:[1,0,0]
    v_pk_fma_f16 v157, v157, v253, v105 op_sel:[1,1,0] op_sel_hi:[0,1,1] neg_lo:[1,0,0]
    v_pk_fma_f16 v158, v158, v254, v106 op_sel:[1,1,0] op_sel_hi:[0,1,1] neg_lo:[1,0,0]
    v_pk_fma_f16 v159, v159, v255, v107 op_sel:[1,1,0] op_sel_hi:[0,1,1] neg_lo:[1,0,0]
    s_setprio 0
    ds_read_b128 v[224:227], v111 offset:0
    ds_read_b128 v[228:231], v111 offset:64
    ds_read_b128 v[232:235], v111 offset:128
    ds_read_b128 v[236:239], v111 offset:192
    ds_read_b128 v[240:243], v111 offset:256
    ds_read_b128 v[244:247], v111 offset:320
    ds_read_b128 v[248:251], v111 offset:384
    ds_read_b128 v[252:255], v111 offset:448
    s_setprio 2
    v_mul_f32 v88, v100, v115
    v_mul_f32 v92, v101, v115
    v_mul_f32 v96, v102, v115
    v_mul_f32 v98, v103, v115
    v_mul_f32 v22, 0x43000000, v115
    v_exp_f32 v88, v88
    v_exp_f32 v92, v92
    v_exp_f32 v96, v96
    v_exp_f32 v98, v98
    v_exp_f32 v22, v22
    v_cmp_gt_u32 vcc, 16, v1
    v_mul_f32 v88, v88, v116
    v_mul_f32 v92, v92, v116
    v_mul_f32 v96, v96, v116
    v_mul_f32 v98, v98, v116
    v_mul_f32 v89, v88, v22
    v_mul_f32 v93, v92, v22
    v_mul_f32 v97, v96, v22
    v_cndmask_b32 v98, 0, v98, vcc
    v_mul_f32 v90, v89, v22
    v_mul_f32 v94, v93, v22
    v_mov_b32 v99, 0
    v_mul_f32 v91, v90, v22
    v_mul_f32 v95, v94, v22
    s_waitcnt lgkmcnt(0)
    s_barrier
    s_add_u32 m0, s33, 49152
    s_add_u32 s35, s32, 458752
    buffer_load_dwordx4 v6, s[8:11], s35 offen lds
    v_pk_mul_f16 v104, v160, v224 op_sel:[0,0] op_sel_hi:[1,0]
    v_pk_mul_f16 v105, v161, v225 op_sel:[0,0] op_sel_hi:[1,0]
    v_pk_mul_f16 v106, v162, v226 op_sel:[0,0] op_sel_hi:[1,0]
    v_pk_mul_f16 v107, v163, v227 op_sel:[0,0] op_sel_hi:[1,0]
    v_pk_fma_f16 v160, v160, v224, v104 op_sel:[1,1,0] op_sel_hi:[0,1,1] neg_lo:[1,0,0]
    v_pk_fma_f16 v161, v161, v225, v105 op_sel:[1,1,0] op_sel_hi:[0,1,1] neg_lo:[1,0,0]
    v_pk_fma_f16 v162, v162, v226, v106 op_sel:[1,1,0] op_sel_hi:[0,1,1] neg_lo:[1,0,0]
    v_pk_fma_f16 v163, v163, v227, v107 op_sel:[1,1,0] op_sel_hi:[0,1,1] neg_lo:[1,0,0]
    v_pk_mul_f16 v104, v164, v228 op_sel:[0,0] op_sel_hi:[1,0]
    v_pk_mul_f16 v105, v165, v229 op_sel:[0,0] op_sel_hi:[1,0]
    s_add_u32 m0, s33, 50176
    s_nop 0
    buffer_load_dwordx4 v7, s[12:15], s35 offen lds
    v_pk_mul_f16 v106, v166, v230 op_sel:[0,0] op_sel_hi:[1,0]
    v_pk_mul_f16 v107, v167, v231 op_sel:[0,0] op_sel_hi:[1,0]
    v_pk_fma_f16 v164, v164, v228, v104 op_sel:[1,1,0] op_sel_hi:[0,1,1] neg_lo:[1,0,0]
    v_pk_fma_f16 v165, v165, v229, v105 op_sel:[1,1,0] op_sel_hi:[0,1,1] neg_lo:[1,0,0]
    v_pk_fma_f16 v166, v166, v230, v106 op_sel:[1,1,0] op_sel_hi:[0,1,1] neg_lo:[1,0,0]
    v_pk_fma_f16 v167, v167, v231, v107 op_sel:[1,1,0] op_sel_hi:[0,1,1] neg_lo:[1,0,0]
    v_mfma_f32_16x16x32_f16 v[76:79], v[160:163], v[128:131], 0
    s_add_u32 m0, s33, 51200
    s_add_u32 s35, s32, 458880
    buffer_load_dwordx4 v6, s[8:11], s35 offen lds
    v_pk_mul_f16 v104, v168, v232 op_sel:[0,0] op_sel_hi:[1,0]
    v_pk_mul_f16 v105, v169, v233 op_sel:[0,0] op_sel_hi:[1,0]
    v_pk_mul_f16 v106, v170, v234 op_sel:[0,0] op_sel_hi:[1,0]
    v_pk_mul_f16 v107, v171, v235 op_sel:[0,0] op_sel_hi:[1,0]
    v_pk_fma_f16 v168, v168, v232, v104 op_sel:[1,1,0] op_sel_hi:[0,1,1] neg_lo:[1,0,0]
    v_pk_fma_f16 v169, v169, v233, v105 op_sel:[1,1,0] op_sel_hi:[0,1,1] neg_lo:[1,0,0]
    v_pk_fma_f16 v170, v170, v234, v106 op_sel:[1,1,0] op_sel_hi:[0,1,1] neg_lo:[1,0,0]
    v_pk_fma_f16 v171, v171, v235, v107 op_sel:[1,1,0] op_sel_hi:[0,1,1] neg_lo:[1,0,0]
    v_mfma_f32_16x16x32_f16 v[76:79], v[164:167], v[132:135], v[76:79]
    s_add_u32 m0, s33, 52224
    s_nop 0
    buffer_load_dwordx4 v7, s[12:15], s35 offen lds
    v_pk_mul_f16 v104, v172, v236 op_sel:[0,0] op_sel_hi:[1,0]
    v_pk_mul_f16 v105, v173, v237 op_sel:[0,0] op_sel_hi:[1,0]
    v_pk_mul_f16 v106, v174, v238 op_sel:[0,0] op_sel_hi:[1,0]
    v_pk_mul_f16 v107, v175, v239 op_sel:[0,0] op_sel_hi:[1,0]
    v_pk_fma_f16 v172, v172, v236, v104 op_sel:[1,1,0] op_sel_hi:[0,1,1] neg_lo:[1,0,0]
    v_pk_fma_f16 v173, v173, v237, v105 op_sel:[1,1,0] op_sel_hi:[0,1,1] neg_lo:[1,0,0]
    v_pk_fma_f16 v174, v174, v238, v106 op_sel:[1,1,0] op_sel_hi:[0,1,1] neg_lo:[1,0,0]
    v_pk_fma_f16 v175, v175, v239, v107 op_sel:[1,1,0] op_sel_hi:[0,1,1] neg_lo:[1,0,0]
    v_mfma_f32_16x16x32_f16 v[76:79], v[168:171], v[136:139], v[76:79]
    s_barrier
    s_add_u32 m0, s33, 65536
    s_add_u32 s35, s32, 573440
    buffer_load_dwordx4 v6, s[8:11], s35 offen lds
    v_pk_mul_f16 v104, v176, v240 op_sel:[0,0] op_sel_hi:[1,0]
    v_pk_mul_f16 v105, v177, v241 op_sel:[0,0] op_sel_hi:[1,0]
    v_pk_mul_f16 v106, v178, v242 op_sel:[0,0] op_sel_hi:[1,0]
    v_pk_mul_f16 v107, v179, v243 op_sel:[0,0] op_sel_hi:[1,0]
    v_pk_fma_f16 v176, v176, v240, v104 op_sel:[1,1,0] op_sel_hi:[0,1,1] neg_lo:[1,0,0]
    v_pk_fma_f16 v177, v177, v241, v105 op_sel:[1,1,0] op_sel_hi:[0,1,1] neg_lo:[1,0,0]
    v_pk_fma_f16 v178, v178, v242, v106 op_sel:[1,1,0] op_sel_hi:[0,1,1] neg_lo:[1,0,0]
    v_pk_fma_f16 v179, v179, v243, v107 op_sel:[1,1,0] op_sel_hi:[0,1,1] neg_lo:[1,0,0]
    v_mfma_f32_16x16x32_f16 v[76:79], v[172:175], v[140:143], v[76:79]
    s_add_u32 m0, s33, 66560
    s_nop 0
    buffer_load_dwordx4 v7, s[12:15], s35 offen lds
    v_pk_mul_f16 v104, v180, v244 op_sel:[0,0] op_sel_hi:[1,0]
    v_pk_mul_f16 v105, v181, v245 op_sel:[0,0] op_sel_hi:[1,0]
    v_pk_mul_f16 v106, v182, v246 op_sel:[0,0] op_sel_hi:[1,0]
    v_pk_mul_f16 v107, v183, v247 op_sel:[0,0] op_sel_hi:[1,0]
    v_pk_fma_f16 v180, v180, v244, v104 op_sel:[1,1,0] op_sel_hi:[0,1,1] neg_lo:[1,0,0]
    v_pk_fma_f16 v181, v181, v245, v105 op_sel:[1,1,0] op_sel_hi:[0,1,1] neg_lo:[1,0,0]
    v_pk_fma_f16 v182, v182, v246, v106 op_sel:[1,1,0] op_sel_hi:[0,1,1] neg_lo:[1,0,0]
    v_pk_fma_f16 v183, v183, v247, v107 op_sel:[1,1,0] op_sel_hi:[0,1,1] neg_lo:[1,0,0]
    v_mfma_f32_16x16x32_f16 v[76:79], v[176:179], v[144:147], v[76:79]
    s_add_u32 m0, s33, 67584
    s_add_u32 s35, s32, 573568
    buffer_load_dwordx4 v6, s[8:11], s35 offen lds
    v_pk_mul_f16 v104, v184, v248 op_sel:[0,0] op_sel_hi:[1,0]
    v_pk_mul_f16 v105, v185, v249 op_sel:[0,0] op_sel_hi:[1,0]
    v_pk_mul_f16 v106, v186, v250 op_sel:[0,0] op_sel_hi:[1,0]
    v_pk_mul_f16 v107, v187, v251 op_sel:[0,0] op_sel_hi:[1,0]
    v_pk_fma_f16 v184, v184, v248, v104 op_sel:[1,1,0] op_sel_hi:[0,1,1] neg_lo:[1,0,0]
    v_pk_fma_f16 v185, v185, v249, v105 op_sel:[1,1,0] op_sel_hi:[0,1,1] neg_lo:[1,0,0]
    v_pk_fma_f16 v186, v186, v250, v106 op_sel:[1,1,0] op_sel_hi:[0,1,1] neg_lo:[1,0,0]
    v_pk_fma_f16 v187, v187, v251, v107 op_sel:[1,1,0] op_sel_hi:[0,1,1] neg_lo:[1,0,0]
    v_mfma_f32_16x16x32_f16 v[76:79], v[180:183], v[148:151], v[76:79]
    s_add_u32 m0, s33, 68608
    s_nop 0
    buffer_load_dwordx4 v7, s[12:15], s35 offen lds
    v_pk_mul_f16 v104, v188, v252 op_sel:[0,0] op_sel_hi:[1,0]
    v_pk_mul_f16 v105, v189, v253 op_sel:[0,0] op_sel_hi:[1,0]
    v_pk_mul_f16 v106, v190, v254 op_sel:[0,0] op_sel_hi:[1,0]
    v_pk_mul_f16 v107, v191, v255 op_sel:[0,0] op_sel_hi:[1,0]
    v_pk_fma_f16 v188, v188, v252, v104 op_sel:[1,1,0] op_sel_hi:[0,1,1] neg_lo:[1,0,0]
    s_add_u32 m0, s33, 0
    s_movk_i32 s35, 384
    buffer_load_dwordx4 v2, s[4:7], s35 offen lds
    s_add_u32 m0, s33, 1024
    s_movk_i32 s35, 384
    buffer_load_dwordx4 v3, s[4:7], s35 offen lds
    s_barrier
    s_add_u32 m0, s33, 81920
    s_add_u32 s35, s32, 688128
    buffer_load_dwordx4 v6, s[8:11], s35 offen lds
    v_pk_fma_f16 v189, v189, v253, v105 op_sel:[1,1,0] op_sel_hi:[0,1,1] neg_lo:[1,0,0]
    v_pk_fma_f16 v190, v190, v254, v106 op_sel:[1,1,0] op_sel_hi:[0,1,1] neg_lo:[1,0,0]
    v_pk_fma_f16 v191, v191, v255, v107 op_sel:[1,1,0] op_sel_hi:[0,1,1] neg_lo:[1,0,0]
    v_mfma_f32_16x16x32_f16 v[76:79], v[184:187], v[152:155], v[76:79]
    s_nop 1
    v_mfma_f32_16x16x32_f16 v[76:79], v[188:191], v[156:159], v[76:79]
    s_add_u32 m0, s33, 82944
    s_nop 0
    buffer_load_dwordx4 v7, s[12:15], s35 offen lds
    s_setprio 0
    ds_read_b128 v[160:163], v114 offset:0
    ds_read_b128 v[164:167], v114 offset:64
    ds_read_b128 v[168:171], v114 offset:128
    ds_read_b128 v[172:175], v114 offset:192
    ds_read_b128 v[176:179], v114 offset:256
    ds_read_b128 v[180:183], v114 offset:320
    ds_read_b128 v[184:187], v114 offset:384
    ds_read_b128 v[188:191], v114 offset:448
    s_setprio 2
    v_pk_mul_f16 v104, v192, v224 op_sel:[0,0] op_sel_hi:[1,0]
    v_pk_mul_f16 v105, v193, v225 op_sel:[0,0] op_sel_hi:[1,0]
    s_add_u32 m0, s33, 83968
    s_add_u32 s35, s32, 688256
    buffer_load_dwordx4 v6, s[8:11], s35 offen lds
    v_pk_mul_f16 v106, v194, v226 op_sel:[0,0] op_sel_hi:[1,0]
    v_pk_mul_f16 v107, v195, v227 op_sel:[0,0] op_sel_hi:[1,0]
    v_pk_fma_f16 v192, v192, v224, v104 op_sel:[1,1,0] op_sel_hi:[0,1,1] neg_lo:[1,0,0]
    v_pk_fma_f16 v193, v193, v225, v105 op_sel:[1,1,0] op_sel_hi:[0,1,1] neg_lo:[1,0,0]
    v_pk_fma_f16 v194, v194, v226, v106 op_sel:[1,1,0] op_sel_hi:[0,1,1] neg_lo:[1,0,0]
    v_pk_fma_f16 v195, v195, v227, v107 op_sel:[1,1,0] op_sel_hi:[0,1,1] neg_lo:[1,0,0]
    v_pk_mul_f16 v104, v196, v228 op_sel:[0,0] op_sel_hi:[1,0]
    v_pk_mul_f16 v105, v197, v229 op_sel:[0,0] op_sel_hi:[1,0]
    v_pk_mul_f16 v106, v198, v230 op_sel:[0,0] op_sel_hi:[1,0]
    v_pk_mul_f16 v107, v199, v231 op_sel:[0,0] op_sel_hi:[1,0]
    s_add_u32 m0, s33, 84992
    s_nop 0
    buffer_load_dwordx4 v7, s[12:15], s35 offen lds
    v_pk_fma_f16 v196, v196, v228, v104 op_sel:[1,1,0] op_sel_hi:[0,1,1] neg_lo:[1,0,0]
    v_pk_fma_f16 v197, v197, v229, v105 op_sel:[1,1,0] op_sel_hi:[0,1,1] neg_lo:[1,0,0]
    v_pk_fma_f16 v198, v198, v230, v106 op_sel:[1,1,0] op_sel_hi:[0,1,1] neg_lo:[1,0,0]
    v_pk_fma_f16 v199, v199, v231, v107 op_sel:[1,1,0] op_sel_hi:[0,1,1] neg_lo:[1,0,0]
    v_mfma_f32_16x16x32_f16 v[80:83], v[192:195], v[128:131], 0
    v_pk_mul_f16 v104, v200, v232 op_sel:[0,0] op_sel_hi:[1,0]
    s_add_u32 m0, s33, 2048
    s_movk_i32 s35, 384
    buffer_load_dwordx4 v4, s[4:7], s35 offen lds
    s_add_u32 m0, s33, 3072
    s_movk_i32 s35, 384
    buffer_load_dwordx4 v5, s[4:7], s35 offen lds
    s_waitcnt vmcnt(12)
    s_barrier
    s_add_u32 m0, s33, 98304
    s_add_u32 s35, s32, 802816
    buffer_load_dwordx4 v6, s[8:11], s35 offen lds
    v_pk_mul_f16 v105, v201, v233 op_sel:[0,0] op_sel_hi:[1,0]
    v_pk_mul_f16 v106, v202, v234 op_sel:[0,0] op_sel_hi:[1,0]
    v_pk_mul_f16 v107, v203, v235 op_sel:[0,0] op_sel_hi:[1,0]
    v_pk_fma_f16 v200, v200, v232, v104 op_sel:[1,1,0] op_sel_hi:[0,1,1] neg_lo:[1,0,0]
    v_pk_fma_f16 v201, v201, v233, v105 op_sel:[1,1,0] op_sel_hi:[0,1,1] neg_lo:[1,0,0]
    v_pk_fma_f16 v202, v202, v234, v106 op_sel:[1,1,0] op_sel_hi:[0,1,1] neg_lo:[1,0,0]
    v_pk_fma_f16 v203, v203, v235, v107 op_sel:[1,1,0] op_sel_hi:[0,1,1] neg_lo:[1,0,0]
    v_mfma_f32_16x16x32_f16 v[80:83], v[196:199], v[132:135], v[80:83]
    s_add_u32 m0, s33, 99328
    s_nop 0
    buffer_load_dwordx4 v7, s[12:15], s35 offen lds
    v_pk_mul_f16 v104, v204, v236 op_sel:[0,0] op_sel_hi:[1,0]
    v_pk_mul_f16 v105, v205, v237 op_sel:[0,0] op_sel_hi:[1,0]
    v_pk_mul_f16 v106, v206, v238 op_sel:[0,0] op_sel_hi:[1,0]
    v_pk_mul_f16 v107, v207, v239 op_sel:[0,0] op_sel_hi:[1,0]
    v_pk_fma_f16 v204, v204, v236, v104 op_sel:[1,1,0] op_sel_hi:[0,1,1] neg_lo:[1,0,0]
    v_pk_fma_f16 v205, v205, v237, v105 op_sel:[1,1,0] op_sel_hi:[0,1,1] neg_lo:[1,0,0]
    v_pk_fma_f16 v206, v206, v238, v106 op_sel:[1,1,0] op_sel_hi:[0,1,1] neg_lo:[1,0,0]
    v_pk_fma_f16 v207, v207, v239, v107 op_sel:[1,1,0] op_sel_hi:[0,1,1] neg_lo:[1,0,0]
    v_mfma_f32_16x16x32_f16 v[80:83], v[200:203], v[136:139], v[80:83]
    s_add_u32 m0, s33, 100352
    s_add_u32 s35, s32, 802944
    buffer_load_dwordx4 v6, s[8:11], s35 offen lds
    v_pk_mul_f16 v104, v208, v240 op_sel:[0,0] op_sel_hi:[1,0]
    v_pk_mul_f16 v105, v209, v241 op_sel:[0,0] op_sel_hi:[1,0]
    v_pk_mul_f16 v106, v210, v242 op_sel:[0,0] op_sel_hi:[1,0]
    v_pk_mul_f16 v107, v211, v243 op_sel:[0,0] op_sel_hi:[1,0]
    v_pk_fma_f16 v208, v208, v240, v104 op_sel:[1,1,0] op_sel_hi:[0,1,1] neg_lo:[1,0,0]
    v_pk_fma_f16 v209, v209, v241, v105 op_sel:[1,1,0] op_sel_hi:[0,1,1] neg_lo:[1,0,0]
    v_pk_fma_f16 v210, v210, v242, v106 op_sel:[1,1,0] op_sel_hi:[0,1,1] neg_lo:[1,0,0]
    v_pk_fma_f16 v211, v211, v243, v107 op_sel:[1,1,0] op_sel_hi:[0,1,1] neg_lo:[1,0,0]
    v_mfma_f32_16x16x32_f16 v[80:83], v[204:207], v[140:143], v[80:83]
    s_add_u32 m0, s33, 101376
    s_nop 0
    buffer_load_dwordx4 v7, s[12:15], s35 offen lds
    v_pk_mul_f16 v104, v212, v244 op_sel:[0,0] op_sel_hi:[1,0]
    v_pk_mul_f16 v105, v213, v245 op_sel:[0,0] op_sel_hi:[1,0]
    v_pk_mul_f16 v106, v214, v246 op_sel:[0,0] op_sel_hi:[1,0]
    v_pk_mul_f16 v107, v215, v247 op_sel:[0,0] op_sel_hi:[1,0]
    v_pk_fma_f16 v212, v212, v244, v104 op_sel:[1,1,0] op_sel_hi:[0,1,1] neg_lo:[1,0,0]
    v_pk_fma_f16 v213, v213, v245, v105 op_sel:[1,1,0] op_sel_hi:[0,1,1] neg_lo:[1,0,0]
    s_add_u32 m0, s33, 16384
    s_movk_i32 s35, 512
    buffer_load_dwordx4 v2, s[4:7], s35 offen lds
    s_add_u32 m0, s33, 17408
    s_movk_i32 s35, 512
    buffer_load_dwordx4 v3, s[4:7], s35 offen lds
    s_waitcnt vmcnt(14)
    s_barrier
    s_add_u32 m0, s33, 49152
    s_add_u32 s35, s32, 917504
    buffer_load_dwordx4 v6, s[8:11], s35 offen lds
    v_pk_fma_f16 v214, v214, v246, v106 op_sel:[1,1,0] op_sel_hi:[0,1,1] neg_lo:[1,0,0]
    v_pk_fma_f16 v215, v215, v247, v107 op_sel:[1,1,0] op_sel_hi:[0,1,1] neg_lo:[1,0,0]
    v_mfma_f32_16x16x32_f16 v[80:83], v[208:211], v[144:147], v[80:83]
    v_pk_mul_f16 v104, v216, v248 op_sel:[0,0] op_sel_hi:[1,0]
    v_pk_mul_f16 v105, v217, v249 op_sel:[0,0] op_sel_hi:[1,0]
    v_pk_mul_f16 v106, v218, v250 op_sel:[0,0] op_sel_hi:[1,0]
    v_pk_mul_f16 v107, v219, v251 op_sel:[0,0] op_sel_hi:[1,0]
    s_add_u32 m0, s33, 50176
    s_nop 0
    buffer_load_dwordx4 v7, s[12:15], s35 offen lds
    v_pk_fma_f16 v216, v216, v248, v104 op_sel:[1,1,0] op_sel_hi:[0,1,1] neg_lo:[1,0,0]
    v_pk_fma_f16 v217, v217, v249, v105 op_sel:[1,1,0] op_sel_hi:[0,1,1] neg_lo:[1,0,0]
    v_pk_fma_f16 v218, v218, v250, v106 op_sel:[1,1,0] op_sel_hi:[0,1,1] neg_lo:[1,0,0]
    v_pk_fma_f16 v219, v219, v251, v107 op_sel:[1,1,0] op_sel_hi:[0,1,1] neg_lo:[1,0,0]
    v_mfma_f32_16x16x32_f16 v[80:83], v[212:215], v[148:151], v[80:83]
    v_pk_mul_f16 v104, v220, v252 op_sel:[0,0] op_sel_hi:[1,0]
    v_pk_mul_f16 v105, v221, v253 op_sel:[0,0] op_sel_hi:[1,0]
    s_add_u32 m0, s33, 51200
    s_add_u32 s35, s32, 917632
    buffer_load_dwordx4 v6, s[8:11], s35 offen lds
    v_pk_mul_f16 v106, v222, v254 op_sel:[0,0] op_sel_hi:[1,0]
    v_pk_mul_f16 v107, v223, v255 op_sel:[0,0] op_sel_hi:[1,0]
    v_pk_fma_f16 v220, v220, v252, v104 op_sel:[1,1,0] op_sel_hi:[0,1,1] neg_lo:[1,0,0]
    v_pk_fma_f16 v221, v221, v253, v105 op_sel:[1,1,0] op_sel_hi:[0,1,1] neg_lo:[1,0,0]
    v_pk_fma_f16 v222, v222, v254, v106 op_sel:[1,1,0] op_sel_hi:[0,1,1] neg_lo:[1,0,0]
    v_pk_fma_f16 v223, v223, v255, v107 op_sel:[1,1,0] op_sel_hi:[0,1,1] neg_lo:[1,0,0]
    v_mfma_f32_16x16x32_f16 v[80:83], v[216:219], v[152:155], v[80:83]
    s_add_u32 m0, s33, 52224
    s_nop 0
    buffer_load_dwordx4 v7, s[12:15], s35 offen lds
    s_nop 1
    v_mfma_f32_16x16x32_f16 v[80:83], v[220:223], v[156:159], v[80:83]
    s_waitcnt lgkmcnt(0)
    s_add_u32 m0, s33, 18432
    s_movk_i32 s35, 512
    buffer_load_dwordx4 v4, s[4:7], s35 offen lds
    s_add_u32 m0, s33, 19456
    s_movk_i32 s35, 512
    buffer_load_dwordx4 v5, s[4:7], s35 offen lds
    s_waitcnt vmcnt(12)
    s_barrier
    s_add_u32 m0, s33, 65536
    s_add_u32 s35, s32, 1032192
    buffer_load_dwordx4 v6, s[8:11], s35 offen lds
    v_pk_mul_f16 v104, v160, v224 op_sel:[0,0] op_sel_hi:[1,0]
    v_pk_mul_f16 v105, v161, v225 op_sel:[0,0] op_sel_hi:[1,0]
    v_pk_mul_f16 v106, v162, v226 op_sel:[0,0] op_sel_hi:[1,0]
    v_pk_mul_f16 v107, v163, v227 op_sel:[0,0] op_sel_hi:[1,0]
    v_pk_fma_f16 v160, v160, v224, v104 op_sel:[1,1,0] op_sel_hi:[0,1,1] neg_lo:[1,0,0]
    v_pk_fma_f16 v161, v161, v225, v105 op_sel:[1,1,0] op_sel_hi:[0,1,1] neg_lo:[1,0,0]
    v_pk_fma_f16 v162, v162, v226, v106 op_sel:[1,1,0] op_sel_hi:[0,1,1] neg_lo:[1,0,0]
    v_pk_fma_f16 v163, v163, v227, v107 op_sel:[1,1,0] op_sel_hi:[0,1,1] neg_lo:[1,0,0]
    v_pk_mul_f16 v104, v164, v228 op_sel:[0,0] op_sel_hi:[1,0]
    v_pk_mul_f16 v105, v165, v229 op_sel:[0,0] op_sel_hi:[1,0]
    s_add_u32 m0, s33, 66560
    s_nop 0
    buffer_load_dwordx4 v7, s[12:15], s35 offen lds
    v_pk_mul_f16 v106, v166, v230 op_sel:[0,0] op_sel_hi:[1,0]
    v_pk_mul_f16 v107, v167, v231 op_sel:[0,0] op_sel_hi:[1,0]
    v_pk_fma_f16 v164, v164, v228, v104 op_sel:[1,1,0] op_sel_hi:[0,1,1] neg_lo:[1,0,0]
    v_pk_fma_f16 v165, v165, v229, v105 op_sel:[1,1,0] op_sel_hi:[0,1,1] neg_lo:[1,0,0]
    v_pk_fma_f16 v166, v166, v230, v106 op_sel:[1,1,0] op_sel_hi:[0,1,1] neg_lo:[1,0,0]
    v_pk_fma_f16 v167, v167, v231, v107 op_sel:[1,1,0] op_sel_hi:[0,1,1] neg_lo:[1,0,0]
    v_mfma_f32_16x16x32_f16 v[84:87], v[160:163], v[128:131], 0
    s_add_u32 m0, s33, 67584
    s_add_u32 s35, s32, 1032320
    buffer_load_dwordx4 v6, s[8:11], s35 offen lds
    v_pk_mul_f16 v104, v168, v232 op_sel:[0,0] op_sel_hi:[1,0]
    v_pk_mul_f16 v105, v169, v233 op_sel:[0,0] op_sel_hi:[1,0]
    v_pk_mul_f16 v106, v170, v234 op_sel:[0,0] op_sel_hi:[1,0]
    v_pk_mul_f16 v107, v171, v235 op_sel:[0,0] op_sel_hi:[1,0]
    v_pk_fma_f16 v168, v168, v232, v104 op_sel:[1,1,0] op_sel_hi:[0,1,1] neg_lo:[1,0,0]
    v_pk_fma_f16 v169, v169, v233, v105 op_sel:[1,1,0] op_sel_hi:[0,1,1] neg_lo:[1,0,0]
    v_pk_fma_f16 v170, v170, v234, v106 op_sel:[1,1,0] op_sel_hi:[0,1,1] neg_lo:[1,0,0]
    v_pk_fma_f16 v171, v171, v235, v107 op_sel:[1,1,0] op_sel_hi:[0,1,1] neg_lo:[1,0,0]
    v_mfma_f32_16x16x32_f16 v[84:87], v[164:167], v[132:135], v[84:87]
    s_add_u32 m0, s33, 68608
    s_nop 0
    buffer_load_dwordx4 v7, s[12:15], s35 offen lds
    v_pk_mul_f16 v104, v172, v236 op_sel:[0,0] op_sel_hi:[1,0]
    v_pk_mul_f16 v105, v173, v237 op_sel:[0,0] op_sel_hi:[1,0]
    v_pk_mul_f16 v106, v174, v238 op_sel:[0,0] op_sel_hi:[1,0]
    v_pk_mul_f16 v107, v175, v239 op_sel:[0,0] op_sel_hi:[1,0]
    v_pk_fma_f16 v172, v172, v236, v104 op_sel:[1,1,0] op_sel_hi:[0,1,1] neg_lo:[1,0,0]
    v_pk_fma_f16 v173, v173, v237, v105 op_sel:[1,1,0] op_sel_hi:[0,1,1] neg_lo:[1,0,0]
    v_pk_fma_f16 v174, v174, v238, v106 op_sel:[1,1,0] op_sel_hi:[0,1,1] neg_lo:[1,0,0]
    v_pk_fma_f16 v175, v175, v239, v107 op_sel:[1,1,0] op_sel_hi:[0,1,1] neg_lo:[1,0,0]
    v_mfma_f32_16x16x32_f16 v[84:87], v[168:171], v[136:139], v[84:87]
    s_add_u32 m0, s33, 32768
    s_movk_i32 s35, 640
    buffer_load_dwordx4 v2, s[4:7], s35 offen lds
    s_add_u32 m0, s33, 33792
    s_movk_i32 s35, 640
    buffer_load_dwordx4 v3, s[4:7], s35 offen lds
    s_waitcnt vmcnt(14)
    s_barrier
    s_add_u32 m0, s33, 81920
    s_add_u32 s35, s32, 1146880
    buffer_load_dwordx4 v6, s[8:11], s35 offen lds
    v_pk_mul_f16 v104, v176, v240 op_sel:[0,0] op_sel_hi:[1,0]
    v_pk_mul_f16 v105, v177, v241 op_sel:[0,0] op_sel_hi:[1,0]
    v_pk_mul_f16 v106, v178, v242 op_sel:[0,0] op_sel_hi:[1,0]
    v_pk_mul_f16 v107, v179, v243 op_sel:[0,0] op_sel_hi:[1,0]
    v_pk_fma_f16 v176, v176, v240, v104 op_sel:[1,1,0] op_sel_hi:[0,1,1] neg_lo:[1,0,0]
    v_pk_fma_f16 v177, v177, v241, v105 op_sel:[1,1,0] op_sel_hi:[0,1,1] neg_lo:[1,0,0]
    v_pk_fma_f16 v178, v178, v242, v106 op_sel:[1,1,0] op_sel_hi:[0,1,1] neg_lo:[1,0,0]
    v_pk_fma_f16 v179, v179, v243, v107 op_sel:[1,1,0] op_sel_hi:[0,1,1] neg_lo:[1,0,0]
    v_mfma_f32_16x16x32_f16 v[84:87], v[172:175], v[140:143], v[84:87]
    s_add_u32 m0, s33, 82944
    s_nop 0
    buffer_load_dwordx4 v7, s[12:15], s35 offen lds
    v_pk_mul_f16 v104, v180, v244 op_sel:[0,0] op_sel_hi:[1,0]
    v_pk_mul_f16 v105, v181, v245 op_sel:[0,0] op_sel_hi:[1,0]
    v_pk_mul_f16 v106, v182, v246 op_sel:[0,0] op_sel_hi:[1,0]
    v_pk_mul_f16 v107, v183, v247 op_sel:[0,0] op_sel_hi:[1,0]
    v_pk_fma_f16 v180, v180, v244, v104 op_sel:[1,1,0] op_sel_hi:[0,1,1] neg_lo:[1,0,0]
    v_pk_fma_f16 v181, v181, v245, v105 op_sel:[1,1,0] op_sel_hi:[0,1,1] neg_lo:[1,0,0]
    v_pk_fma_f16 v182, v182, v246, v106 op_sel:[1,1,0] op_sel_hi:[0,1,1] neg_lo:[1,0,0]
    v_pk_fma_f16 v183, v183, v247, v107 op_sel:[1,1,0] op_sel_hi:[0,1,1] neg_lo:[1,0,0]
    v_mfma_f32_16x16x32_f16 v[84:87], v[176:179], v[144:147], v[84:87]
    s_add_u32 m0, s33, 83968
    s_add_u32 s35, s32, 1147008
    buffer_load_dwordx4 v6, s[8:11], s35 offen lds
    v_pk_mul_f16 v104, v184, v248 op_sel:[0,0] op_sel_hi:[1,0]
    v_pk_mul_f16 v105, v185, v249 op_sel:[0,0] op_sel_hi:[1,0]
    v_pk_mul_f16 v106, v186, v250 op_sel:[0,0] op_sel_hi:[1,0]
    v_pk_mul_f16 v107, v187, v251 op_sel:[0,0] op_sel_hi:[1,0]
    v_pk_fma_f16 v184, v184, v248, v104 op_sel:[1,1,0] op_sel_hi:[0,1,1] neg_lo:[1,0,0]
    v_pk_fma_f16 v185, v185, v249, v105 op_sel:[1,1,0] op_sel_hi:[0,1,1] neg_lo:[1,0,0]
    v_pk_fma_f16 v186, v186, v250, v106 op_sel:[1,1,0] op_sel_hi:[0,1,1] neg_lo:[1,0,0]
    v_pk_fma_f16 v187, v187, v251, v107 op_sel:[1,1,0] op_sel_hi:[0,1,1] neg_lo:[1,0,0]
    v_mfma_f32_16x16x32_f16 v[84:87], v[180:183], v[148:151], v[84:87]
    s_add_u32 m0, s33, 84992
    s_nop 0
    buffer_load_dwordx4 v7, s[12:15], s35 offen lds
    v_pk_mul_f16 v104, v188, v252 op_sel:[0,0] op_sel_hi:[1,0]
    v_pk_mul_f16 v105, v189, v253 op_sel:[0,0] op_sel_hi:[1,0]
    v_pk_mul_f16 v106, v190, v254 op_sel:[0,0] op_sel_hi:[1,0]
    v_pk_mul_f16 v107, v191, v255 op_sel:[0,0] op_sel_hi:[1,0]
    v_pk_fma_f16 v188, v188, v252, v104 op_sel:[1,1,0] op_sel_hi:[0,1,1] neg_lo:[1,0,0]
    s_add_u32 m0, s33, 34816
    s_movk_i32 s35, 640
    buffer_load_dwordx4 v4, s[4:7], s35 offen lds
    s_add_u32 m0, s33, 35840
    s_movk_i32 s35, 640
    buffer_load_dwordx4 v5, s[4:7], s35 offen lds
    s_waitcnt vmcnt(12)
    s_barrier
    s_add_u32 m0, s33, 98304
    s_add_u32 s35, s32, 1261568
    buffer_load_dwordx4 v6, s[8:11], s35 offen lds
    v_pk_fma_f16 v189, v189, v253, v105 op_sel:[1,1,0] op_sel_hi:[0,1,1] neg_lo:[1,0,0]
    v_pk_fma_f16 v190, v190, v254, v106 op_sel:[1,1,0] op_sel_hi:[0,1,1] neg_lo:[1,0,0]
    v_pk_fma_f16 v191, v191, v255, v107 op_sel:[1,1,0] op_sel_hi:[0,1,1] neg_lo:[1,0,0]
    v_mfma_f32_16x16x32_f16 v[84:87], v[184:187], v[152:155], v[84:87]
    s_nop 1
    v_mfma_f32_16x16x32_f16 v[84:87], v[188:191], v[156:159], v[84:87]
    s_add_u32 m0, s33, 99328
    s_nop 0
    buffer_load_dwordx4 v7, s[12:15], s35 offen lds
    s_mul_i32 s46, s30, 3072
    s_xor_b32 s47, s30, 1
    s_mul_i32 s47, s47, 3072
    v_add_u32 v18, s46, v119
    v_add_u32 v16, 114688, v18
    v_add_u32 v18, 126976, v18
    v_add_u32 v17, s47, v119
    v_add_u32 v17, 114688, v17
    s_add_u32 s46, s46, 126976
    v_add_u32_sdwa v20, s46, v8 dst_sel:DWORD dst_unused:UNUSED_PAD src0_sel:DWORD src1_sel:WORD_0
    v_add_u32_sdwa v21, s46, v8 dst_sel:DWORD dst_unused:UNUSED_PAD src0_sel:DWORD src1_sel:WORD_1
    v_add_u32_sdwa v22, s46, v9 dst_sel:DWORD dst_unused:UNUSED_PAD src0_sel:DWORD src1_sel:WORD_0
    s_add_u32 m0, s33, 100352
    s_add_u32 s35, s32, 1261696
    buffer_load_dwordx4 v6, s[8:11], s35 offen lds
    v_add_u32_sdwa v23, s46, v9 dst_sel:DWORD dst_unused:UNUSED_PAD src0_sel:DWORD src1_sel:WORD_1
    v_add_u32_sdwa v24, s46, v10 dst_sel:DWORD dst_unused:UNUSED_PAD src0_sel:DWORD src1_sel:WORD_0
    v_add_u32_sdwa v25, s46, v10 dst_sel:DWORD dst_unused:UNUSED_PAD src0_sel:DWORD src1_sel:WORD_1
    v_add_u32_sdwa v26, s46, v11 dst_sel:DWORD dst_unused:UNUSED_PAD src0_sel:DWORD src1_sel:WORD_0
    v_add_u32_sdwa v27, s46, v11 dst_sel:DWORD dst_unused:UNUSED_PAD src0_sel:DWORD src1_sel:WORD_1
    v_add_u32_sdwa v28, s46, v12 dst_sel:DWORD dst_unused:UNUSED_PAD src0_sel:DWORD src1_sel:WORD_0
    v_add_u32_sdwa v29, s46, v12 dst_sel:DWORD dst_unused:UNUSED_PAD src0_sel:DWORD src1_sel:WORD_1
    v_add_u32_sdwa v30, s46, v13 dst_sel:DWORD dst_unused:UNUSED_PAD src0_sel:DWORD src1_sel:WORD_0
    v_add_u32_sdwa v31, s46, v13 dst_sel:DWORD dst_unused:UNUSED_PAD src0_sel:DWORD src1_sel:WORD_1
    v_add_u32_sdwa v32, s46, v14 dst_sel:DWORD dst_unused:UNUSED_PAD src0_sel:DWORD src1_sel:WORD_0
    s_add_u32 m0, s33, 101376
    s_nop 0
    buffer_load_dwordx4 v7, s[12:15], s35 offen lds
    v_add_u32_sdwa v33, s46, v14 dst_sel:DWORD dst_unused:UNUSED_PAD src0_sel:DWORD src1_sel:WORD_1
    v_add_u32_sdwa v34, s46, v15 dst_sel:DWORD dst_unused:UNUSED_PAD src0_sel:DWORD src1_sel:WORD_0
    v_add_u32_sdwa v35, s46, v15 dst_sel:DWORD dst_unused:UNUSED_PAD src0_sel:DWORD src1_sel:WORD_1
    v_mul_f32 v76, v76, v88
    v_mul_f32 v77, v77, v89
    v_mul_f32 v78, v78, v90
    v_mul_f32 v79, v79, v91
    v_mul_f32 v80, v80, v92
    v_mul_f32 v81, v81, v93
    s_add_u32 m0, s33, 0
    s_movk_i32 s35, 768
    buffer_load_dwordx4 v2, s[4:7], s35 offen lds
    s_add_u32 m0, s33, 1024
    s_movk_i32 s35, 768
    buffer_load_dwordx4 v3, s[4:7], s35 offen lds
    s_waitcnt vmcnt(14)
    s_barrier
    s_add_u32 m0, s33, 49152
    s_add_u32 s35, s32, 1376256
    buffer_load_dwordx4 v6, s[8:11], s35 offen lds
    v_mul_f32 v82, v82, v94
    v_mul_f32 v83, v83, v95
    v_mul_f32 v84, v84, v96
    v_mul_f32 v85, v85, v97
    v_mul_f32 v86, v86, v98
    v_mul_f32 v87, v87, v99
    s_setprio 0
    ds_write_b128 v16, v[76:79] offset:0
    s_add_u32 m0, s33, 50176
    s_nop 0
    buffer_load_dwordx4 v7, s[12:15], s35 offen lds
    ds_write_b128 v16, v[80:83] offset:1024
    ds_write_b128 v16, v[84:87] offset:2048
    s_add_u32 m0, s33, 51200
    s_add_u32 s35, s32, 1376384
    buffer_load_dwordx4 v6, s[8:11], s35 offen lds
    s_add_u32 m0, s33, 52224
    s_nop 0
    buffer_load_dwordx4 v7, s[12:15], s35 offen lds
    s_add_u32 m0, s33, 2048
    s_movk_i32 s35, 768
    buffer_load_dwordx4 v4, s[4:7], s35 offen lds
    s_add_u32 m0, s33, 3072
    s_movk_i32 s35, 768
    buffer_load_dwordx4 v5, s[4:7], s35 offen lds
    s_waitcnt vmcnt(12) lgkmcnt(0)
    s_barrier
    s_add_u32 m0, s33, 65536
    s_add_u32 s35, s32, 1490944
    buffer_load_dwordx4 v6, s[8:11], s35 offen lds
    ds_read_b128 v[40:43], v17 offset:0
    ds_read_b128 v[44:47], v17 offset:1024
    ds_read_b128 v[48:51], v17 offset:2048
    s_setprio 2
    v_mov_b32 v52, 0
    v_mov_b32 v53, 0
    v_mov_b32 v54, 0
    v_mov_b32 v55, 0
    s_setprio 0
    ds_write_b128 v122, v[52:55]
    s_add_u32 m0, s33, 66560
    s_nop 0
    buffer_load_dwordx4 v7, s[12:15], s35 offen lds
    s_waitcnt lgkmcnt(1)
    s_add_u32 m0, s33, 67584
    s_add_u32 s35, s32, 1491072
    buffer_load_dwordx4 v6, s[8:11], s35 offen lds
    s_setprio 2
    v_add_f32 v40, v40, v76
    v_add_f32 v41, v41, v77
    v_add_f32 v42, v42, v78
    v_add_f32 v43, v43, v79
    v_add_f32 v44, v44, v80
    v_add_f32 v45, v45, v81
    v_add_f32 v46, v46, v82
    v_add_f32 v47, v47, v83
    v_add_f32 v48, v48, v84
    v_add_f32 v49, v49, v85
    s_add_u32 m0, s33, 68608
    s_nop 0
    buffer_load_dwordx4 v7, s[12:15], s35 offen lds
    v_add_f32 v50, v50, v86
    v_add_f32 v51, v51, v87
    v_add_f32 v40, v40, v118
    s_setprio 0
    ds_write_b128 v18, v[40:43] offset:0
    s_waitcnt vmcnt(12)
    s_barrier
    s_add_u32 m0, s33, 16384
    s_add_u32 s35, s58, 802816
    buffer_load_dwordx4 v127, s[16:19], s35 offen lds
    ds_write_b128 v18, v[44:47] offset:1024
    ds_write_b128 v18, v[48:51] offset:2048
    s_add_u32 m0, s33, 17408
    s_add_u32 s35, s58, 809984
    buffer_load_dwordx4 v127, s[16:19], s35 offen lds
    ds_read_b32 v60, v20
    ds_read_b32 v61, v21
    ds_read_b32 v62, v22
    ds_read_b32 v63, v23
    ds_read_b32 v64, v24
    ds_read_b32 v65, v25
    ds_read_b32 v66, v26
    ds_read_b32 v67, v27
    ds_read_b32 v68, v28
    ds_read_b32 v69, v29
    s_add_u32 m0, s33, 18432
    s_add_u32 s35, s58, 817152
    buffer_load_dwordx4 v127, s[16:19], s35 offen lds
    ds_read_b32 v70, v30
    ds_read_b32 v71, v31
    ds_read_b32 v72, v32
    ds_read_b32 v73, v33
    ds_read_b32 v74, v34
    ds_read_b32 v75, v35
    s_setprio 2
    v_max3_f32 v36, |v40|, |v41|, |v42|
    v_max3_f32 v36, v36, |v43|, |v44|
    v_max3_f32 v36, v36, |v45|, |v46|
    v_max3_f32 v36, v36, |v47|, |v48|
    s_add_u32 m0, s33, 19456
    s_add_u32 s35, s58, 824320
    buffer_load_dwordx4 v127, s[16:19], s35 offen lds
    v_max3_f32 v36, v36, |v49|, |v50|
    s_nop 1
    v_max_f32_dpp v36, v36, v36 quad_perm:[1,0,3,2] row_mask:0xf bank_mask:0xf
    s_nop 1
    v_max_f32_dpp v36, v36, v36 quad_perm:[2,3,0,1] row_mask:0xf bank_mask:0xf
    s_nop 1
    v_max_f32_dpp v36, v36, v36 row_half_mirror row_mask:0xf bank_mask:0xf
    s_nop 1
    v_max_f32_dpp v36, v36, v36 row_mirror row_mask:0xf bank_mask:0xf
    s_nop 0
    v_readlane_b32 s60, v36, 0
    v_readlane_b32 s61, v36, 16
    s_waitcnt vmcnt(8)
    s_barrier
    buffer_load_dwordx4 v[2:5], v123, s[20:23], s49 offen sc1
    v_readlane_b32 s62, v36, 32
    v_readlane_b32 s63, v36, 48
    s_nop 0
    s_max_u32 s60, s60, s61
    s_max_u32 s62, s62, s63
    s_max_u32 s60, s60, s62
    s_lshr_b32 s60, s60, 23
    s_max_u32 s60, s60, 16
    s_min_u32 s60, s60, 254
    s_sub_u32 s61, 268, s60
    s_lshl_b32 s61, s61, 23
    s_sub_u32 s60, s60, 14
    s_lshl_b32 s60, s60, 23
    s_lshl_b32 s46, s42, 2
    s_add_u32 s46, s46, 160768
    v_mov_b32 v36, s60
    s_add_u32 m0, s33, 81920
    s_add_u32 s35, s58, 831488
    buffer_load_dwordx4 v127, s[16:19], s35 offen lds
    v_mov_b32 v38, s46
    s_setprio 0
    ds_write_b32 v38, v36
    s_waitcnt lgkmcnt(1)
    s_add_u32 m0, s33, 82944
    s_add_u32 s35, s58, 838656
    buffer_load_dwordx4 v127, s[16:19], s35 offen lds
    s_setprio 2
    v_mul_f32 v60, s61, v60
    v_mul_f32 v61, s61, v61
    v_mul_f32 v62, s61, v62
    v_mul_f32 v63, s61, v63
    v_mul_f32 v64, s61, v64
    v_mul_f32 v65, s61, v65
    v_mul_f32 v66, s61, v66
    v_mul_f32 v67, s61, v67
    v_mul_f32 v68, s61, v68
    v_mul_f32 v69, s61, v69
    s_add_u32 m0, s33, 83968
    s_add_u32 s35, s58, 845824
    buffer_load_dwordx4 v127, s[16:19], s35 offen lds
    v_mul_f32 v70, s61, v70
    s_add_u32 m0, s33, 84992
    s_add_u32 s35, s58, 852992
    buffer_load_dwordx4 v127, s[16:19], s35 offen lds
    s_add_u32 m0, s33, 98304
    s_add_u32 s35, s58, 860160
    buffer_load_dwordx4 v127, s[16:19], s35 offen lds
    s_add_u32 m0, s33, 99328
    s_add_u32 s35, s58, 867328
    buffer_load_dwordx4 v127, s[16:19], s35 offen lds
    s_add_u32 m0, s33, 100352
    s_add_u32 s35, s58, 874496
    buffer_load_dwordx4 v127, s[16:19], s35 offen lds
    s_add_u32 m0, s33, 101376
    s_add_u32 s35, s58, 881664
    buffer_load_dwordx4 v127, s[16:19], s35 offen lds
    s_waitcnt vmcnt(13)
    s_barrier
    s_waitcnt vmcnt(8)
    s_setprio 0
    ds_write_b128 v124, v[2:5]
    s_add_u32 m0, s33, 32768
    s_add_u32 s35, s58, 888832
    buffer_load_dwordx4 v127, s[16:19], s35 offen lds
    s_setprio 2
    v_mul_f32 v71, s61, v71
    v_mul_f32 v72, s61, v72
    v_mul_f32 v73, s61, v73
    v_mul_f32 v74, s61, v74
    v_mul_f32 v75, s61, v75
    v_cvt_pk_f16_f32 v40, v60, v61
    v_cvt_pk_f16_f32 v41, v62, v63
    v_cvt_pk_f16_f32 v42, v64, v65
    v_cvt_pk_f16_f32 v43, v66, v67
    v_cvt_pk_f16_f32 v44, v68, v69
    s_add_u32 m0, s33, 33792
    s_add_u32 s35, s58, 896000
    buffer_load_dwordx4 v127, s[16:19], s35 offen lds
    v_cvt_pk_f16_f32 v45, v70, v71
    v_cvt_pk_f16_f32 v46, v72, v73
    v_cvt_pk_f16_f32 v47, v74, v75
    s_setprio 0
    ds_write_b128 v121, v[40:43] offset:128
    ds_write_b128 v121, v[44:47] offset:144
    s_add_u32 m0, s33, 34816
    s_add_u32 s35, s58, 903168
    buffer_load_dwordx4 v127, s[16:19], s35 offen lds
    s_add_u32 m0, s33, 35840
    s_add_u32 s35, s58, 910336
    buffer_load_dwordx4 v127, s[16:19], s35 offen lds
    s_add_u32 m0, s33, 49152
    s_add_u32 s35, s58, 917504
    buffer_load_dwordx4 v127, s[16:19], s35 offen lds
    s_add_u32 m0, s33, 50176
    s_add_u32 s35, s58, 924672
    buffer_load_dwordx4 v127, s[16:19], s35 offen lds
    s_add_u32 m0, s33, 51200
    s_add_u32 s35, s58, 931840
    buffer_load_dwordx4 v127, s[16:19], s35 offen lds
    s_add_u32 m0, s33, 52224
    s_add_u32 s35, s58, 939008
    buffer_load_dwordx4 v127, s[16:19], s35 offen lds
    s_waitcnt lgkmcnt(0)
    s_barrier
    s_setprio 2
    s_add_u32 m0, s33, 65536
    s_add_u32 s35, s58, 946176
    buffer_load_dwordx4 v127, s[16:19], s35 offen lds
    s_add_u32 m0, s33, 66560
    s_add_u32 s35, s58, 953344
    buffer_load_dwordx4 v127, s[16:19], s35 offen lds
    s_add_u32 m0, s33, 67584
    s_add_u32 s35, s58, 960512
    buffer_load_dwordx4 v127, s[16:19], s35 offen lds
    s_add_u32 m0, s33, 68608
    s_add_u32 s35, s58, 967680
    buffer_load_dwordx4 v127, s[16:19], s35 offen lds
    s_add_u32 m0, s33, 0
    s_add_u32 s35, s58, 974848
    buffer_load_dwordx4 v127, s[16:19], s35 offen lds
    s_add_u32 m0, s33, 1024
    s_add_u32 s35, s58, 982016
    buffer_load_dwordx4 v127, s[16:19], s35 offen lds
    s_add_u32 m0, s33, 2048
    s_add_u32 s35, s58, 989184
    buffer_load_dwordx4 v127, s[16:19], s35 offen lds
    s_add_u32 m0, s33, 3072
    s_add_u32 s35, s58, 996352
    buffer_load_dwordx4 v127, s[16:19], s35 offen lds
    v_lshrrev_b32 v252, 5, v1
    v_lshlrev_b32 v252, 9, v252
    v_bfe_u32 v88, v1, 2, 2
    v_lshl_add_u32 v252, v88, 7, v252
    v_and_b32 v88, 1, v1
    v_lshl_add_u32 v252, v88, 5, v252
    v_bfe_u32 v88, v1, 4, 1
    v_lshl_add_u32 v252, v88, 4, v252
    v_bfe_u32 v88, v1, 1, 1
    v_lshl_add_u32 v252, v88, 3, v252
    v_bfe_u32 v88, v1, 3, 1
    v_lshl_add_u32 v252, v88, 6, v252
    v_add_u32 v252, s33, v252
    v_xor_b32 v253, 64, v252
    v_add_u32 v254, 0x10000, v252
    v_add_u32 v255, 0x10000, v253
    s_mov_b32 s8, s68
    s_mov_b32 s9, s69
    s_mov_b32 s10, 256
    s_mov_b32 s11, 0x00020000
    s_waitcnt vmcnt(25)
    ds_read_b64_tr_b16 v[128:129], v252 offset:16384
    ds_read_b64_tr_b16 v[130:131], v252 offset:18432
    ds_read_b64_tr_b16 v[132:133], v253 offset:16384
    ds_read_b64_tr_b16 v[134:135], v253 offset:18432
    ds_read_b64_tr_b16 v[136:137], v252 offset:17408
    ds_read_b64_tr_b16 v[138:139], v252 offset:19456
    ds_read_b64_tr_b16 v[140:141], v253 offset:17408
    ds_read_b64_tr_b16 v[142:143], v253 offset:19456
    s_waitcnt vmcnt(20)
    ds_read_b64_tr_b16 v[144:145], v254 offset:16384
    ds_read_b64_tr_b16 v[146:147], v254 offset:18432
    ds_read_b64_tr_b16 v[148:149], v255 offset:16384
    ds_read_b64_tr_b16 v[150:151], v255 offset:18432
    ds_read_b64_tr_b16 v[152:153], v254 offset:17408
    ds_read_b64_tr_b16 v[154:155], v254 offset:19456
    ds_read_b64_tr_b16 v[156:157], v255 offset:17408
    ds_read_b64_tr_b16 v[158:159], v255 offset:19456
    s_waitcnt vmcnt(16)
    ds_read_b64_tr_b16 v[160:161], v254 offset:32768
    ds_read_b64_tr_b16 v[162:163], v254 offset:34816
    ds_read_b64_tr_b16 v[164:165], v255 offset:32768
    ds_read_b64_tr_b16 v[166:167], v255 offset:34816
    ds_read_b64_tr_b16 v[168:169], v254 offset:33792
    ds_read_b64_tr_b16 v[170:171], v254 offset:35840
    ds_read_b64_tr_b16 v[172:173], v255 offset:33792
    ds_read_b64_tr_b16 v[174:175], v255 offset:35840
    s_waitcnt vmcnt(12)
    ds_read_b64_tr_b16 v[176:177], v252 offset:32768
    ds_read_b64_tr_b16 v[178:179], v252 offset:34816
    ds_read_b64_tr_b16 v[180:181], v253 offset:32768
    ds_read_b64_tr_b16 v[182:183], v253 offset:34816
    ds_read_b64_tr_b16 v[184:185], v252 offset:33792
    ds_read_b64_tr_b16 v[186:187], v252 offset:35840
    ds_read_b64_tr_b16 v[188:189], v253 offset:33792
    ds_read_b64_tr_b16 v[190:191], v253 offset:35840
    v_and_b32 v6, 31, v1
    v_lshlrev_b32 v6, 2, v6
    s_cmp_lg_u32 s3, 4
    s_cbranch_scc1 g2_22
    s_mov_b32 s50, 0
g2spin_23:
    buffer_load_dword v7, v6, s[8:11], 0 offen offset:128 sc1
    s_waitcnt vmcnt(0)
    v_cmp_eq_u32 vcc, 1, v7
    s_cmp_eq_u64 vcc, -1
    s_cbranch_scc1 g2spin_23_ok
    s_add_u32 s50, s50, 1
    s_cmp_ge_u32 s50, 200000
    s_cbranch_scc1 g2spin_23_ok
    s_sleep 16
    s_branch g2spin_23
g2spin_23_ok:
    v_mov_b32 v16, 160904
    v_mov_b32 v17, 1
    s_mov_b64 exec, 1
    ds_add_u32 v16, v17
    s_mov_b64 exec, -1
g2_22:
    v_mov_b32 v16, 160904
    s_mov_b32 s50, 0
f2_24:
    ds_read_b32 v17, v16
    s_waitcnt lgkmcnt(0)
    v_readfirstlane_b32 s36, v17
    s_cmp_ge_u32 s36, 1
    s_cbranch_scc1 f2_24_ok
    s_add_u32 s50, s50, 1
    s_cmp_ge_u32 s50, 1600000
    s_cbranch_scc1 f2_24_ok
    s_sleep 1
    s_branch f2_24
f2_24_ok:
    buffer_load_dwordx4 v[8:11], v125, s[24:27], 0 offen sc1
    s_mov_b32 s36, 917504
    buffer_load_dwordx4 v[12:15], v125, s[24:27], s36 offen sc1
    s_waitcnt vmcnt(10)
    ds_read_b64_tr_b16 v[192:193], v252 offset:49152
    ds_read_b64_tr_b16 v[194:195], v252 offset:51200
    ds_read_b64_tr_b16 v[196:197], v253 offset:49152
    ds_read_b64_tr_b16 v[198:199], v253 offset:51200
    ds_read_b64_tr_b16 v[200:201], v252 offset:50176
    ds_read_b64_tr_b16 v[202:203], v252 offset:52224
    ds_read_b64_tr_b16 v[204:205], v253 offset:50176
    ds_read_b64_tr_b16 v[206:207], v253 offset:52224
    s_waitcnt vmcnt(6)
    ds_read_b64_tr_b16 v[208:209], v254 offset:0
    ds_read_b64_tr_b16 v[210:211], v254 offset:2048
    ds_read_b64_tr_b16 v[212:213], v255 offset:0
    ds_read_b64_tr_b16 v[214:215], v255 offset:2048
    ds_read_b64_tr_b16 v[216:217], v254 offset:1024
    ds_read_b64_tr_b16 v[218:219], v254 offset:3072
    ds_read_b64_tr_b16 v[220:221], v255 offset:1024
    ds_read_b64_tr_b16 v[222:223], v255 offset:3072
    s_waitcnt vmcnt(2)
    ds_read_b64_tr_b16 v[224:225], v252 offset:0
    ds_read_b64_tr_b16 v[226:227], v252 offset:2048
    ds_read_b64_tr_b16 v[228:229], v253 offset:0
    ds_read_b64_tr_b16 v[230:231], v253 offset:2048
    ds_read_b64_tr_b16 v[232:233], v252 offset:1024
    ds_read_b64_tr_b16 v[234:235], v252 offset:3072
    ds_read_b64_tr_b16 v[236:237], v253 offset:1024
    ds_read_b64_tr_b16 v[238:239], v253 offset:3072
    s_waitcnt vmcnt(0)
    ds_write_b128 v126, v[8:11]
    ds_write_b128 v126, v[12:15] offset:512
    s_lshl_b32 s37, s42, 2
    s_add_u32 s37, s37, 160832
    v_mov_b32 v16, s37
    v_mov_b32 v17, 1
    s_mov_b64 exec, 1
    ds_add_u32 v16, v17
    s_mov_b64 exec, -1
    s_setprio 0
    v_mov_b32 v16, 160872
    v_mov_b32 v17, 1
    s_mov_b64 exec, 1
    ds_add_u32 v16, v17
    s_mov_b64 exec, -1
    v_mov_b32 v16, 160880
    s_mov_b32 s50, 0
ed_25:
    ds_read_b32 v17, v16
    s_waitcnt lgkmcnt(0)
    v_readfirstlane_b32 s36, v17
    s_cmp_ge_u32 s36, 4
    s_cbranch_scc1 ed_25_ok
    s_add_u32 s50, s50, 1
    s_cmp_ge_u32 s50, 1600000
    s_cbranch_scc1 ed_25_ok
    s_sleep 2
    s_branch ed_25
ed_25_ok:
    s_add_u32 m0, s33, 16384
    s_add_u32 s35, s58, 0
    buffer_load_dwordx4 v127, s[16:19], s35 offen lds
    s_add_u32 m0, s33, 17408
    s_add_u32 s35, s58, 7168
    buffer_load_dwordx4 v127, s[16:19], s35 offen lds
    s_add_u32 m0, s33, 18432
    s_add_u32 s35, s58, 14336
    buffer_load_dwordx4 v127, s[16:19], s35 offen lds
    s_add_u32 m0, s33, 19456
    s_add_u32 s35, s58, 21504
    buffer_load_dwordx4 v127, s[16:19], s35 offen lds
    s_add_u32 m0, s33, 81920
    s_add_u32 s35, s58, 28672
    buffer_load_dwordx4 v127, s[16:19], s35 offen lds
    s_add_u32 m0, s33, 82944
    s_add_u32 s35, s58, 35840
    buffer_load_dwordx4 v127, s[16:19], s35 offen lds
    s_add_u32 m0, s33, 83968
    s_add_u32 s35, s58, 43008
    buffer_load_dwordx4 v127, s[16:19], s35 offen lds
    s_add_u32 m0, s33, 84992
    s_add_u32 s35, s58, 50176
    buffer_load_dwordx4 v127, s[16:19], s35 offen lds
    s_add_u32 m0, s33, 98304
    s_add_u32 s35, s58, 57344
    buffer_load_dwordx4 v127, s[16:19], s35 offen lds
    s_add_u32 m0, s33, 99328
    s_add_u32 s35, s58, 64512
    buffer_load_dwordx4 v127, s[16:19], s35 offen lds
    s_add_u32 m0, s33, 100352
    s_add_u32 s35, s58, 71680
    buffer_load_dwordx4 v127, s[16:19], s35 offen lds
    s_add_u32 m0, s33, 101376
    s_add_u32 s35, s58, 78848
    buffer_load_dwordx4 v127, s[16:19], s35 offen lds
    s_add_u32 m0, s33, 32768
    s_add_u32 s35, s58, 86016
    buffer_load_dwordx4 v127, s[16:19], s35 offen lds
    s_add_u32 m0, s33, 33792
    s_add_u32 s35, s58, 93184
    buffer_load_dwordx4 v127, s[16:19], s35 offen lds
    s_add_u32 m0, s33, 34816
    s_add_u32 s35, s58, 100352
    buffer_load_dwordx4 v127, s[16:19], s35 offen lds
    s_add_u32 m0, s33, 35840
    s_add_u32 s35, s58, 107520
    buffer_load_dwordx4 v127, s[16:19], s35 offen lds
    s_add_u32 m0, s33, 49152
    s_add_u32 s35, s58, 114688
    buffer_load_dwordx4 v127, s[16:19], s35 offen lds
    s_add_u32 m0, s33, 50176
    s_add_u32 s35, s58, 121856
    buffer_load_dwordx4 v127, s[16:19], s35 offen lds
    s_add_u32 m0, s33, 51200
    s_add_u32 s35, s58, 129024
    buffer_load_dwordx4 v127, s[16:19], s35 offen lds
    s_add_u32 m0, s33, 52224
    s_add_u32 s35, s58, 136192
    buffer_load_dwordx4 v127, s[16:19], s35 offen lds
    s_add_u32 m0, s33, 65536
    s_add_u32 s35, s58, 143360
    buffer_load_dwordx4 v127, s[16:19], s35 offen lds
    s_add_u32 m0, s33, 66560
    s_add_u32 s35, s58, 150528
    buffer_load_dwordx4 v127, s[16:19], s35 offen lds
    s_add_u32 m0, s33, 67584
    s_add_u32 s35, s58, 157696
    buffer_load_dwordx4 v127, s[16:19], s35 offen lds
    s_add_u32 m0, s33, 68608
    s_add_u32 s35, s58, 164864
    buffer_load_dwordx4 v127, s[16:19], s35 offen lds
    s_add_u32 m0, s33, 0
    s_add_u32 s35, s58, 172032
    buffer_load_dwordx4 v127, s[16:19], s35 offen lds
    s_add_u32 m0, s33, 1024
    s_add_u32 s35, s58, 179200
    buffer_load_dwordx4 v127, s[16:19], s35 offen lds
    s_add_u32 m0, s33, 2048
    s_add_u32 s35, s58, 186368
    buffer_load_dwordx4 v127, s[16:19], s35 offen lds
    s_add_u32 m0, s33, 3072
    s_add_u32 s35, s58, 193536
    buffer_load_dwordx4 v127, s[16:19], s35 offen lds
    s_mov_b32 s4, s70
    s_mov_b32 s5, s71
    s_mov_b32 s6, 7340032
    s_mov_b32 s7, 0x00020000
    s_add_u32 s24, s70, 10485760
    s_addc_u32 s25, s71, 0
    s_mov_b32 s26, 1835008
    s_mov_b32 s27, 0x00020000
    s_add_u32 s8, s70, 14811136
    s_addc_u32 s9, s71, 0
    s_mov_b32 s10, 61440
    s_mov_b32 s11, 0x00020000
    s_waitcnt vmcnt(0)
    s_lshl_b32 s37, s30, 2
    s_add_u32 s37, s37, 160848
    v_mov_b32 v16, s37
    v_mov_b32 v17, 1
    s_mov_b64 exec, 1
    ds_add_u32 v16, v17
    s_mov_b64 exec, -1
    s_setprio 1
    s_mul_i32 s36, s56, 7
    s_add_u32 s36, s36, s57
    s_lshl_b32 s36, s36, 8
    s_add_u32 s36, s36, 4096
    v_and_b32 v3, 15, v1
    v_lshlrev_b32 v3, 2, v3
    v_add_u32 v3, s36, v3
    s_movk_i32 s38, 0x3fff
    s_cmp_lg_u32 s3, 4
    s_cbranch_scc1 hw_26
    s_mov_b32 s50, 0
hpoll_27:
    buffer_load_dword v4, v3, s[8:11], 0 offen sc1
    s_waitcnt vmcnt(0)
    v_cmp_eq_u32 vcc, 1, v4
    s_and_b32 s39, vcc_lo, s38
    s_cmp_eq_u32 s39, s38
    s_cbranch_scc1 hpoll_27_ok
    s_add_u32 s50, s50, 1
    s_cmp_ge_u32 s50, 200000
    s_cbranch_scc1 hpoll_27_ok
    s_sleep 4
    s_branch hpoll_27
hpoll_27_ok:
    v_mov_b32 v16, 160868
    v_mov_b32 v17, 1
    s_mov_b64 exec, 1
    ds_add_u32 v16, v17
    s_mov_b64 exec, -1
hw_26:
    s_branch k_g2B
k_helper:
    s_sub_u32 s28, s2, 224
    s_and_b32 s29, s28, 3
    s_lshl_b32 s29, s29, 3
    s_and_b32 s36, s28, 4
    s_add_u32 s29, s29, s36
    s_lshr_b32 s36, s28, 3
    s_add_u32 s29, s29, s36
    s_mov_b32 s29, s28
    v_lshrrev_b32 v6, 5, v1
    v_bfe_u32 v7, v1, 4, 1
    v_bfe_u32 v74, v1, 2, 2
    v_lshl_add_u32 v74, v7, 3, v74
    v_lshl_add_u32 v74, v74, 2, v6
    s_cmp_ge_u32 s3, 4
    s_cbranch_scc1 h_C
    v_lshrrev_b32 v4, 3, v1
    v_and_b32 v5, 7, v1
    s_lshl_b32 s30, s29, 6
    s_lshl_b32 s31, s3, 4
    s_add_u32 s30, s30, s31
    s_mul_i32 s31, s30, 896
    s_add_u32 s32, s31, 7168
    v_mul_u32_u24 v2, 896, v4
    v_lshl_add_u32 v2, v5, 4, v2
    s_waitcnt lgkmcnt(0)
    s_mov_b32 s4, s40
    s_mov_b32 s5, s41
    s_mov_b32 s6, 1835008
    s_mov_b32 s7, 0x00020000
    buffer_load_dwordx4 v[16:19], v2, s[4:7], s31 offen offset:0
    buffer_load_dwordx4 v[20:23], v2, s[4:7], s31 offen offset:128
    buffer_load_dwordx4 v[24:27], v2, s[4:7], s31 offen offset:256
    buffer_load_dwordx4 v[28:31], v2, s[4:7], s31 offen offset:384
    buffer_load_dwordx4 v[32:35], v2, s[4:7], s31 offen offset:512
    buffer_load_dwordx4 v[36:39], v2, s[4:7], s31 offen offset:640
    buffer_load_dwordx4 v[40:43], v2, s[4:7], s31 offen offset:768
    buffer_load_dwordx4 v[44:47], v2, s[4:7], s32 offen offset:0
    buffer_load_dwordx4 v[48:51], v2, s[4:7], s32 offen offset:128
    buffer_load_dwordx4 v[52:55], v2, s[4:7], s32 offen offset:256
    buffer_load_dwordx4 v[56:59], v2, s[4:7], s32 offen offset:384
    buffer_load_dwordx4 v[60:63], v2, s[4:7], s32 offen offset:512
    buffer_load_dwordx4 v[64:67], v2, s[4:7], s32 offen offset:640
    buffer_load_dwordx4 v[68:71], v2, s[4:7], s32 offen offset:768
    v_mov_b32 v8, 0
    v_mov_b32 v9, 0
    v_mov_b32 v10, 120064
    ds_write_b64 v10, v[8:9]
    ds_write_b64 v10, v[8:9] offset:8
    s_waitcnt lgkmcnt(0)
    s_barrier
    s_lshl_b32 s36, s3, 21
    s_add_u32 s36, s70, s36
    s_addc_u32 s37, s71, 0
    s_load_dword s100, s[36:37], 0
    s_load_dword s101, s[66:67], 0
    s_load_dword s101, s[68:69], 0
    s_add_u32 s36, s36, 8388608
    s_addc_u32 s37, s37, 0
    s_load_dword s100, s[36:37], 0
    s_load_dword s101, s[64:65], 0
    s_add_u32 s16, s70, 14680064
    s_addc_u32 s17, s71, 0
    s_mov_b32 s18, 79872
    s_mov_b32 s19, 0x00020000
    s_add_u32 s24, s70, 14811136
    s_addc_u32 s25, s71, 0
    s_mov_b32 s26, 61440
    s_mov_b32 s27, 0x00020000
    s_add_u32 s20, s70, 8388608
    s_addc_u32 s21, s71, 0
    s_mov_b32 s22, 1835008
    s_mov_b32 s23, 0x00020000
    v_mul_u32_u24 v74, 912, v74
    v_and_b32 v75, 3, v1
    v_lshl_add_u32 v74, v75, 3, v74
    v_lshl_add_u32 v6, v6, 1, v7
    v_bfe_u32 v7, v1, 1, 2
    v_xor_b32 v6, v6, v7
    v_and_b32 v75, 15, v1
    v_lshlrev_b32 v75, 6, v75
    v_lshl_add_u32 v75, v6, 4, v75
    s_mul_i32 s37, s3, 14336
    s_add_u32 s37, s37, 59392
    v_add_u32 v75, s37, v75
    v_bfe_u32 v6, v1, 3, 2
    v_and_b32 v7, 3, v1
    v_xor_b32 v6, v6, v7
    v_lshrrev_b32 v76, 2, v1
    v_lshlrev_b32 v76, 6, v76
    v_lshl_add_u32 v76, v6, 4, v76
    v_add_u32 v76, s37, v76
    v_lshlrev_b32 v77, 4, v1
    s_mul_i32 s36, s29, 57344
    s_mul_i32 s37, s3, 7
    s_lshl_b32 s38, s37, 5
    v_add_u32 v200, s38, v74
    s_lshl_b32 s38, s37, 10
    s_add_u32 s52, s36, s38
    s_add_u32 s53, s52, 28672
    s_add_u32 s54, s52, 4096
    s_add_u32 s55, s53, 4096
    v_and_b32 v6, 3, v1
    v_lshlrev_b32 v6, 4, v6
    s_lshr_b32 s36, s28, 1
    s_and_b32 s37, s28, 1
    s_lshl_b32 s37, s37, 4
    s_add_u32 s36, s36, s37
    s_lshl_b32 s36, s36, 6
    v_add_u32 v6, s36, v6
    s_mul_i32 s36, s29, 1792
    s_mul_i32 s37, s3, 448
    s_add_u32 s36, s36, s37
    s_add_u32 s36, s36, 4096
    v_lshlrev_b32 v7, 4, v1
    v_add_u32 v7, s36, v7
    v_cmp_gt_u32 vcc, 28, v1
    s_mov_b32 s36, 0
    v_cndmask_b32 v6, v6, v7, vcc
    v_mov_b32 v8, 0
    v_mov_b32 v9, 0
    v_mov_b32 v10, 0
    v_mov_b32 v11, 0
    v_mov_b32 v12, 0
    v_mov_b32 v13, 0
    v_mov_b32 v14, 0
    v_mov_b32 v15, 0
    buffer_store_dwordx4 v[8:11], v6, s[24:27], s36 offen sc1
    s_mov_b32 s33, 0x3f803f80
    v_lshlrev_b32 v72, 4, v4
    v_mov_b32 v73, 0x7fffff00
    v_cmp_eq_u32 vcc, 0, v5
    s_lshl_b32 s34, s30, 4
    s_lshl_b32 s36, s3, 4
    v_cndmask_b32 v72, v73, v72, vcc
    v_add_u32 v73, s36, v4
    v_mul_u32_u24 v73, 912, v73
    v_lshl_add_u32 v73, v5, 4, v73
    s_waitcnt vmcnt(14)
    v_dot2_f32_bf16 v8, v16, s33, v8
    v_dot2_f32_bf16 v9, v17, s33, v9
    v_dot2_f32_bf16 v8, v18, s33, v8
    v_dot2_f32_bf16 v9, v19, s33, v9
    s_waitcnt vmcnt(13)
    v_dot2_f32_bf16 v8, v20, s33, v8
    v_dot2_f32_bf16 v9, v21, s33, v9
    v_dot2_f32_bf16 v8, v22, s33, v8
    v_dot2_f32_bf16 v9, v23, s33, v9
    s_waitcnt vmcnt(12)
    v_dot2_f32_bf16 v8, v24, s33, v8
    v_dot2_f32_bf16 v9, v25, s33, v9
    v_dot2_f32_bf16 v8, v26, s33, v8
    v_dot2_f32_bf16 v9, v27, s33, v9
    s_waitcnt vmcnt(11)
    v_dot2_f32_bf16 v8, v28, s33, v8
    v_dot2_f32_bf16 v9, v29, s33, v9
    v_dot2_f32_bf16 v8, v30, s33, v8
    v_dot2_f32_bf16 v9, v31, s33, v9
    s_waitcnt vmcnt(10)
    v_dot2_f32_bf16 v8, v32, s33, v8
    v_dot2_f32_bf16 v9, v33, s33, v9
    v_dot2_f32_bf16 v8, v34, s33, v8
    v_dot2_f32_bf16 v9, v35, s33, v9
    s_waitcnt vmcnt(9)
    v_dot2_f32_bf16 v8, v36, s33, v8
    v_dot2_f32_bf16 v9, v37, s33, v9
    v_dot2_f32_bf16 v8, v38, s33, v8
    v_dot2_f32_bf16 v9, v39, s33, v9
    s_waitcnt vmcnt(8)
    v_dot2_f32_bf16 v8, v40, s33, v8
    v_dot2_f32_bf16 v9, v41, s33, v9
    v_dot2_f32_bf16 v8, v42, s33, v8
    v_dot2_f32_bf16 v9, v43, s33, v9
    s_nop 2
    v_add_f32 v9, v8, v9
    s_nop 1
    v_add_f32_dpp v9, v9, v9 quad_perm:[1,0,3,2] row_mask:0xf bank_mask:0xf
    s_nop 1
    v_add_f32_dpp v9, v9, v9 quad_perm:[2,3,0,1] row_mask:0xf bank_mask:0xf
    s_nop 1
    v_add_f32_dpp v9, v9, v9 row_half_mirror row_mask:0xf bank_mask:0xf
    v_mul_f32 v9, 0x3b124925, v9
    v_cvt_pk_bf16_f32 v6, v9, v9
    v_lshlrev_b32 v8, 16, v6
    v_sub_f32 v106, v9, v8
    v_mov_b32 v104, 0
    v_mov_b32 v105, 0
    v_lshlrev_b32 v108, 16, v16
    v_and_b32 v109, 0xffff0000, v16
    v_lshlrev_b32 v110, 16, v17
    v_and_b32 v111, 0xffff0000, v17
    v_lshlrev_b32 v112, 16, v18
    v_and_b32 v113, 0xffff0000, v18
    v_lshlrev_b32 v114, 16, v19
    v_and_b32 v115, 0xffff0000, v19
    v_pk_add_f32 v[108:109], v[108:109], v[8:9] op_sel:[0,0] op_sel_hi:[1,0] neg_lo:[0,1] neg_hi:[0,1]
    v_pk_add_f32 v[110:111], v[110:111], v[8:9] op_sel:[0,0] op_sel_hi:[1,0] neg_lo:[0,1] neg_hi:[0,1]
    v_pk_add_f32 v[112:113], v[112:113], v[8:9] op_sel:[0,0] op_sel_hi:[1,0] neg_lo:[0,1] neg_hi:[0,1]
    v_pk_add_f32 v[114:115], v[114:115], v[8:9] op_sel:[0,0] op_sel_hi:[1,0] neg_lo:[0,1] neg_hi:[0,1]
    v_pk_fma_f32 v[10:11], v[108:109], v[108:109], v[10:11]
    v_pk_fma_f32 v[104:105], v[110:111], v[110:111], v[104:105]
    v_pk_fma_f32 v[10:11], v[112:113], v[112:113], v[10:11]
    v_pk_fma_f32 v[104:105], v[114:115], v[114:115], v[104:105]
    v_cvt_pk_bf16_f32 v16, v108, v109
    v_cvt_pk_bf16_f32 v17, v110, v111
    v_cvt_pk_bf16_f32 v18, v112, v113
    v_cvt_pk_bf16_f32 v19, v114, v115
    v_lshlrev_b32 v108, 16, v20
    v_and_b32 v109, 0xffff0000, v20
    v_lshlrev_b32 v110, 16, v21
    v_and_b32 v111, 0xffff0000, v21
    v_lshlrev_b32 v112, 16, v22
    v_and_b32 v113, 0xffff0000, v22
    v_lshlrev_b32 v114, 16, v23
    v_and_b32 v115, 0xffff0000, v23
    v_pk_add_f32 v[108:109], v[108:109], v[8:9] op_sel:[0,0] op_sel_hi:[1,0] neg_lo:[0,1] neg_hi:[0,1]
    v_pk_add_f32 v[110:111], v[110:111], v[8:9] op_sel:[0,0] op_sel_hi:[1,0] neg_lo:[0,1] neg_hi:[0,1]
    v_pk_add_f32 v[112:113], v[112:113], v[8:9] op_sel:[0,0] op_sel_hi:[1,0] neg_lo:[0,1] neg_hi:[0,1]
    v_pk_add_f32 v[114:115], v[114:115], v[8:9] op_sel:[0,0] op_sel_hi:[1,0] neg_lo:[0,1] neg_hi:[0,1]
    v_pk_fma_f32 v[10:11], v[108:109], v[108:109], v[10:11]
    v_pk_fma_f32 v[104:105], v[110:111], v[110:111], v[104:105]
    v_pk_fma_f32 v[10:11], v[112:113], v[112:113], v[10:11]
    v_pk_fma_f32 v[104:105], v[114:115], v[114:115], v[104:105]
    v_cvt_pk_bf16_f32 v20, v108, v109
    v_cvt_pk_bf16_f32 v21, v110, v111
    v_cvt_pk_bf16_f32 v22, v112, v113
    v_cvt_pk_bf16_f32 v23, v114, v115
    v_lshlrev_b32 v108, 16, v24
    v_and_b32 v109, 0xffff0000, v24
    v_lshlrev_b32 v110, 16, v25
    v_and_b32 v111, 0xffff0000, v25
    v_lshlrev_b32 v112, 16, v26
    v_and_b32 v113, 0xffff0000, v26
    v_lshlrev_b32 v114, 16, v27
    v_and_b32 v115, 0xffff0000, v27
    v_pk_add_f32 v[108:109], v[108:109], v[8:9] op_sel:[0,0] op_sel_hi:[1,0] neg_lo:[0,1] neg_hi:[0,1]
    v_pk_add_f32 v[110:111], v[110:111], v[8:9] op_sel:[0,0] op_sel_hi:[1,0] neg_lo:[0,1] neg_hi:[0,1]
    v_pk_add_f32 v[112:113], v[112:113], v[8:9] op_sel:[0,0] op_sel_hi:[1,0] neg_lo:[0,1] neg_hi:[0,1]
    v_pk_add_f32 v[114:115], v[114:115], v[8:9] op_sel:[0,0] op_sel_hi:[1,0] neg_lo:[0,1] neg_hi:[0,1]
    v_pk_fma_f32 v[10:11], v[108:109], v[108:109], v[10:11]
    v_pk_fma_f32 v[104:105], v[110:111], v[110:111], v[104:105]
    v_pk_fma_f32 v[10:11], v[112:113], v[112:113], v[10:11]
    v_pk_fma_f32 v[104:105], v[114:115], v[114:115], v[104:105]
    v_cvt_pk_bf16_f32 v24, v108, v109
    v_cvt_pk_bf16_f32 v25, v110, v111
    v_cvt_pk_bf16_f32 v26, v112, v113
    v_cvt_pk_bf16_f32 v27, v114, v115
    v_lshlrev_b32 v108, 16, v28
    v_and_b32 v109, 0xffff0000, v28
    v_lshlrev_b32 v110, 16, v29
    v_and_b32 v111, 0xffff0000, v29
    v_lshlrev_b32 v112, 16, v30
    v_and_b32 v113, 0xffff0000, v30
    v_lshlrev_b32 v114, 16, v31
    v_and_b32 v115, 0xffff0000, v31
    v_pk_add_f32 v[108:109], v[108:109], v[8:9] op_sel:[0,0] op_sel_hi:[1,0] neg_lo:[0,1] neg_hi:[0,1]
    v_pk_add_f32 v[110:111], v[110:111], v[8:9] op_sel:[0,0] op_sel_hi:[1,0] neg_lo:[0,1] neg_hi:[0,1]
    v_pk_add_f32 v[112:113], v[112:113], v[8:9] op_sel:[0,0] op_sel_hi:[1,0] neg_lo:[0,1] neg_hi:[0,1]
    v_pk_add_f32 v[114:115], v[114:115], v[8:9] op_sel:[0,0] op_sel_hi:[1,0] neg_lo:[0,1] neg_hi:[0,1]
    v_pk_fma_f32 v[10:11], v[108:109], v[108:109], v[10:11]
    v_pk_fma_f32 v[104:105], v[110:111], v[110:111], v[104:105]
    v_pk_fma_f32 v[10:11], v[112:113], v[112:113], v[10:11]
    v_pk_fma_f32 v[104:105], v[114:115], v[114:115], v[104:105]
    v_cvt_pk_bf16_f32 v28, v108, v109
    v_cvt_pk_bf16_f32 v29, v110, v111
    v_cvt_pk_bf16_f32 v30, v112, v113
    v_cvt_pk_bf16_f32 v31, v114, v115
    v_lshlrev_b32 v108, 16, v32
    v_and_b32 v109, 0xffff0000, v32
    v_lshlrev_b32 v110, 16, v33
    v_and_b32 v111, 0xffff0000, v33
    v_lshlrev_b32 v112, 16, v34
    v_and_b32 v113, 0xffff0000, v34
    v_lshlrev_b32 v114, 16, v35
    v_and_b32 v115, 0xffff0000, v35
    v_pk_add_f32 v[108:109], v[108:109], v[8:9] op_sel:[0,0] op_sel_hi:[1,0] neg_lo:[0,1] neg_hi:[0,1]
    v_pk_add_f32 v[110:111], v[110:111], v[8:9] op_sel:[0,0] op_sel_hi:[1,0] neg_lo:[0,1] neg_hi:[0,1]
    v_pk_add_f32 v[112:113], v[112:113], v[8:9] op_sel:[0,0] op_sel_hi:[1,0] neg_lo:[0,1] neg_hi:[0,1]
    v_pk_add_f32 v[114:115], v[114:115], v[8:9] op_sel:[0,0] op_sel_hi:[1,0] neg_lo:[0,1] neg_hi:[0,1]
    v_pk_fma_f32 v[10:11], v[108:109], v[108:109], v[10:11]
    v_pk_fma_f32 v[104:105], v[110:111], v[110:111], v[104:105]
    v_pk_fma_f32 v[10:11], v[112:113], v[112:113], v[10:11]
    v_pk_fma_f32 v[104:105], v[114:115], v[114:115], v[104:105]
    v_cvt_pk_bf16_f32 v32, v108, v109
    v_cvt_pk_bf16_f32 v33, v110, v111
    v_cvt_pk_bf16_f32 v34, v112, v113
    v_cvt_pk_bf16_f32 v35, v114, v115
    v_lshlrev_b32 v108, 16, v36
    v_and_b32 v109, 0xffff0000, v36
    v_lshlrev_b32 v110, 16, v37
    v_and_b32 v111, 0xffff0000, v37
    v_lshlrev_b32 v112, 16, v38
    v_and_b32 v113, 0xffff0000, v38
    v_lshlrev_b32 v114, 16, v39
    v_and_b32 v115, 0xffff0000, v39
    v_pk_add_f32 v[108:109], v[108:109], v[8:9] op_sel:[0,0] op_sel_hi:[1,0] neg_lo:[0,1] neg_hi:[0,1]
    v_pk_add_f32 v[110:111], v[110:111], v[8:9] op_sel:[0,0] op_sel_hi:[1,0] neg_lo:[0,1] neg_hi:[0,1]
    v_pk_add_f32 v[112:113], v[112:113], v[8:9] op_sel:[0,0] op_sel_hi:[1,0] neg_lo:[0,1] neg_hi:[0,1]
    v_pk_add_f32 v[114:115], v[114:115], v[8:9] op_sel:[0,0] op_sel_hi:[1,0] neg_lo:[0,1] neg_hi:[0,1]
    v_pk_fma_f32 v[10:11], v[108:109], v[108:109], v[10:11]
    v_pk_fma_f32 v[104:105], v[110:111], v[110:111], v[104:105]
    v_pk_fma_f32 v[10:11], v[112:113], v[112:113], v[10:11]
    v_pk_fma_f32 v[104:105], v[114:115], v[114:115], v[104:105]
    v_cvt_pk_bf16_f32 v36, v108, v109
    v_cvt_pk_bf16_f32 v37, v110, v111
    v_cvt_pk_bf16_f32 v38, v112, v113
    v_cvt_pk_bf16_f32 v39, v114, v115
    v_lshlrev_b32 v108, 16, v40
    v_and_b32 v109, 0xffff0000, v40
    v_lshlrev_b32 v110, 16, v41
    v_and_b32 v111, 0xffff0000, v41
    v_lshlrev_b32 v112, 16, v42
    v_and_b32 v113, 0xffff0000, v42
    v_lshlrev_b32 v114, 16, v43
    v_and_b32 v115, 0xffff0000, v43
    v_pk_add_f32 v[108:109], v[108:109], v[8:9] op_sel:[0,0] op_sel_hi:[1,0] neg_lo:[0,1] neg_hi:[0,1]
    v_pk_add_f32 v[110:111], v[110:111], v[8:9] op_sel:[0,0] op_sel_hi:[1,0] neg_lo:[0,1] neg_hi:[0,1]
    v_pk_add_f32 v[112:113], v[112:113], v[8:9] op_sel:[0,0] op_sel_hi:[1,0] neg_lo:[0,1] neg_hi:[0,1]
    v_pk_add_f32 v[114:115], v[114:115], v[8:9] op_sel:[0,0] op_sel_hi:[1,0] neg_lo:[0,1] neg_hi:[0,1]
    v_pk_fma_f32 v[10:11], v[108:109], v[108:109], v[10:11]
    v_pk_fma_f32 v[104:105], v[110:111], v[110:111], v[104:105]
    v_pk_fma_f32 v[10:11], v[112:113], v[112:113], v[10:11]
    v_pk_fma_f32 v[104:105], v[114:115], v[114:115], v[104:105]
    v_cvt_pk_bf16_f32 v40, v108, v109
    v_cvt_pk_bf16_f32 v41, v110, v111
    v_cvt_pk_bf16_f32 v42, v112, v113
    v_cvt_pk_bf16_f32 v43, v114, v115
    v_add_f32 v10, v10, v104
    v_add_f32 v11, v11, v105
    v_add_f32 v10, v10, v11
    s_nop 1
    v_add_f32_dpp v10, v10, v10 quad_perm:[1,0,3,2] row_mask:0xf bank_mask:0xf
    s_nop 1
    v_add_f32_dpp v10, v10, v10 quad_perm:[2,3,0,1] row_mask:0xf bank_mask:0xf
    s_nop 1
    v_add_f32_dpp v10, v10, v10 row_half_mirror row_mask:0xf bank_mask:0xf
    v_mul_f32 v10, 0x3b124925, v10
    v_fma_f32 v10, -v106, v106, v10
    v_max_f32 v10, 0, v10
    v_cvt_pk_bf16_f32 v6, v10, v10
    v_lshlrev_b32 v10, 16, v6
    v_add_f32 v10, 0x3727c5ac, v10
    v_cvt_pk_bf16_f32 v6, v10, v10
    v_lshlrev_b32 v10, 16, v6
    v_sqrt_f32 v10, v10
    s_nop 0
    v_cvt_pk_bf16_f32 v6, v10, v10
    v_lshlrev_b32 v10, 16, v6
    v_rcp_f32 v9, v10
    v_mov_b32 v96, v8
    v_mul_f32 v99, v10, v10
    v_mul_f32 v98, v9, v9
    v_mul_f32 v97, 0xc0135761, v9
    v_mul_f32 v98, v98, v9
    v_mul_f32 v98, 0xbdd2d3e8, v98
    buffer_store_dwordx4 v[96:99], v72, s[16:19], s34 offen offset:0 sc1
    s_waitcnt vmcnt(8)
    v_dot2_f32_bf16 v12, v44, s33, v12
    v_dot2_f32_bf16 v13, v45, s33, v13
    v_dot2_f32_bf16 v12, v46, s33, v12
    v_dot2_f32_bf16 v13, v47, s33, v13
    s_waitcnt vmcnt(7)
    v_dot2_f32_bf16 v12, v48, s33, v12
    v_dot2_f32_bf16 v13, v49, s33, v13
    v_dot2_f32_bf16 v12, v50, s33, v12
    v_dot2_f32_bf16 v13, v51, s33, v13
    s_waitcnt vmcnt(6)
    v_dot2_f32_bf16 v12, v52, s33, v12
    v_dot2_f32_bf16 v13, v53, s33, v13
    v_dot2_f32_bf16 v12, v54, s33, v12
    v_dot2_f32_bf16 v13, v55, s33, v13
    s_waitcnt vmcnt(5)
    v_dot2_f32_bf16 v12, v56, s33, v12
    v_dot2_f32_bf16 v13, v57, s33, v13
    v_dot2_f32_bf16 v12, v58, s33, v12
    v_dot2_f32_bf16 v13, v59, s33, v13
    s_waitcnt vmcnt(4)
    v_dot2_f32_bf16 v12, v60, s33, v12
    v_dot2_f32_bf16 v13, v61, s33, v13
    v_dot2_f32_bf16 v12, v62, s33, v12
    v_dot2_f32_bf16 v13, v63, s33, v13
    s_waitcnt vmcnt(3)
    v_dot2_f32_bf16 v12, v64, s33, v12
    v_dot2_f32_bf16 v13, v65, s33, v13
    v_dot2_f32_bf16 v12, v66, s33, v12
    v_dot2_f32_bf16 v13, v67, s33, v13
    s_waitcnt vmcnt(2)
    v_dot2_f32_bf16 v12, v68, s33, v12
    v_dot2_f32_bf16 v13, v69, s33, v13
    v_dot2_f32_bf16 v12, v70, s33, v12
    v_dot2_f32_bf16 v13, v71, s33, v13
    s_nop 2
    v_add_f32 v13, v12, v13
    s_nop 1
    v_add_f32_dpp v13, v13, v13 quad_perm:[1,0,3,2] row_mask:0xf bank_mask:0xf
    s_nop 1
    v_add_f32_dpp v13, v13, v13 quad_perm:[2,3,0,1] row_mask:0xf bank_mask:0xf
    s_nop 1
    v_add_f32_dpp v13, v13, v13 row_half_mirror row_mask:0xf bank_mask:0xf
    v_mul_f32 v13, 0x3b124925, v13
    v_cvt_pk_bf16_f32 v6, v13, v13
    v_lshlrev_b32 v12, 16, v6
    v_sub_f32 v106, v13, v12
    v_mov_b32 v104, 0
    v_mov_b32 v105, 0
    v_lshlrev_b32 v108, 16, v44
    v_and_b32 v109, 0xffff0000, v44
    v_lshlrev_b32 v110, 16, v45
    v_and_b32 v111, 0xffff0000, v45
    v_lshlrev_b32 v112, 16, v46
    v_and_b32 v113, 0xffff0000, v46
    v_lshlrev_b32 v114, 16, v47
    v_and_b32 v115, 0xffff0000, v47
    v_pk_add_f32 v[108:109], v[108:109], v[12:13] op_sel:[0,0] op_sel_hi:[1,0] neg_lo:[0,1] neg_hi:[0,1]
    v_pk_add_f32 v[110:111], v[110:111], v[12:13] op_sel:[0,0] op_sel_hi:[1,0] neg_lo:[0,1] neg_hi:[0,1]
    v_pk_add_f32 v[112:113], v[112:113], v[12:13] op_sel:[0,0] op_sel_hi:[1,0] neg_lo:[0,1] neg_hi:[0,1]
    v_pk_add_f32 v[114:115], v[114:115], v[12:13] op_sel:[0,0] op_sel_hi:[1,0] neg_lo:[0,1] neg_hi:[0,1]
    v_pk_fma_f32 v[14:15], v[108:109], v[108:109], v[14:15]
    v_pk_fma_f32 v[104:105], v[110:111], v[110:111], v[104:105]
    v_pk_fma_f32 v[14:15], v[112:113], v[112:113], v[14:15]
    v_pk_fma_f32 v[104:105], v[114:115], v[114:115], v[104:105]
    v_cvt_pk_bf16_f32 v44, v108, v109
    v_cvt_pk_bf16_f32 v45, v110, v111
    v_cvt_pk_bf16_f32 v46, v112, v113
    v_cvt_pk_bf16_f32 v47, v114, v115
    v_lshlrev_b32 v108, 16, v48
    v_and_b32 v109, 0xffff0000, v48
    v_lshlrev_b32 v110, 16, v49
    v_and_b32 v111, 0xffff0000, v49
    v_lshlrev_b32 v112, 16, v50
    v_and_b32 v113, 0xffff0000, v50
    v_lshlrev_b32 v114, 16, v51
    v_and_b32 v115, 0xffff0000, v51
    v_pk_add_f32 v[108:109], v[108:109], v[12:13] op_sel:[0,0] op_sel_hi:[1,0] neg_lo:[0,1] neg_hi:[0,1]
    v_pk_add_f32 v[110:111], v[110:111], v[12:13] op_sel:[0,0] op_sel_hi:[1,0] neg_lo:[0,1] neg_hi:[0,1]
    v_pk_add_f32 v[112:113], v[112:113], v[12:13] op_sel:[0,0] op_sel_hi:[1,0] neg_lo:[0,1] neg_hi:[0,1]
    v_pk_add_f32 v[114:115], v[114:115], v[12:13] op_sel:[0,0] op_sel_hi:[1,0] neg_lo:[0,1] neg_hi:[0,1]
    v_pk_fma_f32 v[14:15], v[108:109], v[108:109], v[14:15]
    v_pk_fma_f32 v[104:105], v[110:111], v[110:111], v[104:105]
    v_pk_fma_f32 v[14:15], v[112:113], v[112:113], v[14:15]
    v_pk_fma_f32 v[104:105], v[114:115], v[114:115], v[104:105]
    v_cvt_pk_bf16_f32 v48, v108, v109
    v_cvt_pk_bf16_f32 v49, v110, v111
    v_cvt_pk_bf16_f32 v50, v112, v113
    v_cvt_pk_bf16_f32 v51, v114, v115
    v_lshlrev_b32 v108, 16, v52
    v_and_b32 v109, 0xffff0000, v52
    v_lshlrev_b32 v110, 16, v53
    v_and_b32 v111, 0xffff0000, v53
    v_lshlrev_b32 v112, 16, v54
    v_and_b32 v113, 0xffff0000, v54
    v_lshlrev_b32 v114, 16, v55
    v_and_b32 v115, 0xffff0000, v55
    v_pk_add_f32 v[108:109], v[108:109], v[12:13] op_sel:[0,0] op_sel_hi:[1,0] neg_lo:[0,1] neg_hi:[0,1]
    v_pk_add_f32 v[110:111], v[110:111], v[12:13] op_sel:[0,0] op_sel_hi:[1,0] neg_lo:[0,1] neg_hi:[0,1]
    v_pk_add_f32 v[112:113], v[112:113], v[12:13] op_sel:[0,0] op_sel_hi:[1,0] neg_lo:[0,1] neg_hi:[0,1]
    v_pk_add_f32 v[114:115], v[114:115], v[12:13] op_sel:[0,0] op_sel_hi:[1,0] neg_lo:[0,1] neg_hi:[0,1]
    v_pk_fma_f32 v[14:15], v[108:109], v[108:109], v[14:15]
    v_pk_fma_f32 v[104:105], v[110:111], v[110:111], v[104:105]
    v_pk_fma_f32 v[14:15], v[112:113], v[112:113], v[14:15]
    v_pk_fma_f32 v[104:105], v[114:115], v[114:115], v[104:105]
    v_cvt_pk_bf16_f32 v52, v108, v109
    v_cvt_pk_bf16_f32 v53, v110, v111
    v_cvt_pk_bf16_f32 v54, v112, v113
    v_cvt_pk_bf16_f32 v55, v114, v115
    v_lshlrev_b32 v108, 16, v56
    v_and_b32 v109, 0xffff0000, v56
    v_lshlrev_b32 v110, 16, v57
    v_and_b32 v111, 0xffff0000, v57
    v_lshlrev_b32 v112, 16, v58
    v_and_b32 v113, 0xffff0000, v58
    v_lshlrev_b32 v114, 16, v59
    v_and_b32 v115, 0xffff0000, v59
    v_pk_add_f32 v[108:109], v[108:109], v[12:13] op_sel:[0,0] op_sel_hi:[1,0] neg_lo:[0,1] neg_hi:[0,1]
    v_pk_add_f32 v[110:111], v[110:111], v[12:13] op_sel:[0,0] op_sel_hi:[1,0] neg_lo:[0,1] neg_hi:[0,1]
    v_pk_add_f32 v[112:113], v[112:113], v[12:13] op_sel:[0,0] op_sel_hi:[1,0] neg_lo:[0,1] neg_hi:[0,1]
    v_pk_add_f32 v[114:115], v[114:115], v[12:13] op_sel:[0,0] op_sel_hi:[1,0] neg_lo:[0,1] neg_hi:[0,1]
    v_pk_fma_f32 v[14:15], v[108:109], v[108:109], v[14:15]
    v_pk_fma_f32 v[104:105], v[110:111], v[110:111], v[104:105]
    v_pk_fma_f32 v[14:15], v[112:113], v[112:113], v[14:15]
    v_pk_fma_f32 v[104:105], v[114:115], v[114:115], v[104:105]
    v_cvt_pk_bf16_f32 v56, v108, v109
    v_cvt_pk_bf16_f32 v57, v110, v111
    v_cvt_pk_bf16_f32 v58, v112, v113
    v_cvt_pk_bf16_f32 v59, v114, v115
    v_lshlrev_b32 v108, 16, v60
    v_and_b32 v109, 0xffff0000, v60
    v_lshlrev_b32 v110, 16, v61
    v_and_b32 v111, 0xffff0000, v61
    v_lshlrev_b32 v112, 16, v62
    v_and_b32 v113, 0xffff0000, v62
    v_lshlrev_b32 v114, 16, v63
    v_and_b32 v115, 0xffff0000, v63
    v_pk_add_f32 v[108:109], v[108:109], v[12:13] op_sel:[0,0] op_sel_hi:[1,0] neg_lo:[0,1] neg_hi:[0,1]
    v_pk_add_f32 v[110:111], v[110:111], v[12:13] op_sel:[0,0] op_sel_hi:[1,0] neg_lo:[0,1] neg_hi:[0,1]
    v_pk_add_f32 v[112:113], v[112:113], v[12:13] op_sel:[0,0] op_sel_hi:[1,0] neg_lo:[0,1] neg_hi:[0,1]
    v_pk_add_f32 v[114:115], v[114:115], v[12:13] op_sel:[0,0] op_sel_hi:[1,0] neg_lo:[0,1] neg_hi:[0,1]
    v_pk_fma_f32 v[14:15], v[108:109], v[108:109], v[14:15]
    v_pk_fma_f32 v[104:105], v[110:111], v[110:111], v[104:105]
    v_pk_fma_f32 v[14:15], v[112:113], v[112:113], v[14:15]
    v_pk_fma_f32 v[104:105], v[114:115], v[114:115], v[104:105]
    v_cvt_pk_bf16_f32 v60, v108, v109
    v_cvt_pk_bf16_f32 v61, v110, v111
    v_cvt_pk_bf16_f32 v62, v112, v113
    v_cvt_pk_bf16_f32 v63, v114, v115
    v_lshlrev_b32 v108, 16, v64
    v_and_b32 v109, 0xffff0000, v64
    v_lshlrev_b32 v110, 16, v65
    v_and_b32 v111, 0xffff0000, v65
    v_lshlrev_b32 v112, 16, v66
    v_and_b32 v113, 0xffff0000, v66
    v_lshlrev_b32 v114, 16, v67
    v_and_b32 v115, 0xffff0000, v67
    v_pk_add_f32 v[108:109], v[108:109], v[12:13] op_sel:[0,0] op_sel_hi:[1,0] neg_lo:[0,1] neg_hi:[0,1]
    v_pk_add_f32 v[110:111], v[110:111], v[12:13] op_sel:[0,0] op_sel_hi:[1,0] neg_lo:[0,1] neg_hi:[0,1]
    v_pk_add_f32 v[112:113], v[112:113], v[12:13] op_sel:[0,0] op_sel_hi:[1,0] neg_lo:[0,1] neg_hi:[0,1]
    v_pk_add_f32 v[114:115], v[114:115], v[12:13] op_sel:[0,0] op_sel_hi:[1,0] neg_lo:[0,1] neg_hi:[0,1]
    v_pk_fma_f32 v[14:15], v[108:109], v[108:109], v[14:15]
    v_pk_fma_f32 v[104:105], v[110:111], v[110:111], v[104:105]
    v_pk_fma_f32 v[14:15], v[112:113], v[112:113], v[14:15]
    v_pk_fma_f32 v[104:105], v[114:115], v[114:115], v[104:105]
    v_cvt_pk_bf16_f32 v64, v108, v109
    v_cvt_pk_bf16_f32 v65, v110, v111
    v_cvt_pk_bf16_f32 v66, v112, v113
    v_cvt_pk_bf16_f32 v67, v114, v115
    v_lshlrev_b32 v108, 16, v68
    v_and_b32 v109, 0xffff0000, v68
    v_lshlrev_b32 v110, 16, v69
    v_and_b32 v111, 0xffff0000, v69
    v_lshlrev_b32 v112, 16, v70
    v_and_b32 v113, 0xffff0000, v70
    v_lshlrev_b32 v114, 16, v71
    v_and_b32 v115, 0xffff0000, v71
    v_pk_add_f32 v[108:109], v[108:109], v[12:13] op_sel:[0,0] op_sel_hi:[1,0] neg_lo:[0,1] neg_hi:[0,1]
    v_pk_add_f32 v[110:111], v[110:111], v[12:13] op_sel:[0,0] op_sel_hi:[1,0] neg_lo:[0,1] neg_hi:[0,1]
    v_pk_add_f32 v[112:113], v[112:113], v[12:13] op_sel:[0,0] op_sel_hi:[1,0] neg_lo:[0,1] neg_hi:[0,1]
    v_pk_add_f32 v[114:115], v[114:115], v[12:13] op_sel:[0,0] op_sel_hi:[1,0] neg_lo:[0,1] neg_hi:[0,1]
    v_pk_fma_f32 v[14:15], v[108:109], v[108:109], v[14:15]
    v_pk_fma_f32 v[104:105], v[110:111], v[110:111], v[104:105]
    v_pk_fma_f32 v[14:15], v[112:113], v[112:113], v[14:15]
    v_pk_fma_f32 v[104:105], v[114:115], v[114:115], v[104:105]
    v_cvt_pk_bf16_f32 v68, v108, v109
    v_cvt_pk_bf16_f32 v69, v110, v111
    v_cvt_pk_bf16_f32 v70, v112, v113
    v_cvt_pk_bf16_f32 v71, v114, v115
    v_add_f32 v14, v14, v104
    v_add_f32 v15, v15, v105
    v_add_f32 v14, v14, v15
    s_nop 1
    v_add_f32_dpp v14, v14, v14 quad_perm:[1,0,3,2] row_mask:0xf bank_mask:0xf
    s_nop 1
    v_add_f32_dpp v14, v14, v14 quad_perm:[2,3,0,1] row_mask:0xf bank_mask:0xf
    s_nop 1
    v_add_f32_dpp v14, v14, v14 row_half_mirror row_mask:0xf bank_mask:0xf
    v_mul_f32 v14, 0x3b124925, v14
    v_fma_f32 v14, -v106, v106, v14
    v_max_f32 v14, 0, v14
    v_cvt_pk_bf16_f32 v6, v14, v14
    v_lshlrev_b32 v14, 16, v6
    v_add_f32 v14, 0x3727c5ac, v14
    v_cvt_pk_bf16_f32 v6, v14, v14
    v_lshlrev_b32 v14, 16, v6
    v_sqrt_f32 v14, v14
    s_nop 0
    v_cvt_pk_bf16_f32 v6, v14, v14
    v_lshlrev_b32 v14, 16, v6
    v_rcp_f32 v13, v14
    v_mov_b32 v100, v12
    v_mul_f32 v103, v14, v14
    v_mul_f32 v102, v13, v13
    v_mul_f32 v101, 0xc0135761, v13
    v_mul_f32 v102, v102, v13
    v_mul_f32 v102, 0xbdd2d3e8, v102
    buffer_store_dwordx4 v[100:103], v72, s[16:19], s34 offen offset:128 sc1
    v_lshlrev_b32 v144, 16, v16
    v_and_b32 v145, 0xffff0000, v16
    v_lshlrev_b32 v150, 16, v17
    v_and_b32 v151, 0xffff0000, v17
    v_lshlrev_b32 v156, 16, v18
    v_and_b32 v157, 0xffff0000, v18
    v_lshlrev_b32 v162, 16, v19
    v_and_b32 v163, 0xffff0000, v19
    v_pk_mul_f32 v[146:147], v[144:145], v[8:9] op_sel:[0,1] op_sel_hi:[1,1]
    v_pk_mul_f32 v[152:153], v[150:151], v[8:9] op_sel:[0,1] op_sel_hi:[1,1]
    v_pk_mul_f32 v[158:159], v[156:157], v[8:9] op_sel:[0,1] op_sel_hi:[1,1]
    v_pk_mul_f32 v[164:165], v[162:163], v[8:9] op_sel:[0,1] op_sel_hi:[1,1]
    v_cvt_pk_bf16_f32 v144, v146, v147
    v_cvt_pk_bf16_f32 v150, v152, v153
    v_cvt_pk_bf16_f32 v156, v158, v159
    v_cvt_pk_bf16_f32 v162, v164, v165
    v_lshlrev_b32 v146, 16, v144
    v_and_b32 v147, 0xffff0000, v144
    v_lshlrev_b32 v152, 16, v150
    v_and_b32 v153, 0xffff0000, v150
    v_lshlrev_b32 v158, 16, v156
    v_and_b32 v159, 0xffff0000, v156
    v_lshlrev_b32 v164, 16, v162
    v_and_b32 v165, 0xffff0000, v162
    v_cvt_pk_f16_f32 v16, v146, v147
    v_cvt_pk_f16_f32 v17, v152, v153
    v_cvt_pk_f16_f32 v18, v158, v159
    v_cvt_pk_f16_f32 v19, v164, v165
    ds_write_b128 v73, v[16:19] offset:0
    v_lshlrev_b32 v144, 16, v20
    v_and_b32 v145, 0xffff0000, v20
    v_lshlrev_b32 v150, 16, v21
    v_and_b32 v151, 0xffff0000, v21
    v_lshlrev_b32 v156, 16, v22
    v_and_b32 v157, 0xffff0000, v22
    v_lshlrev_b32 v162, 16, v23
    v_and_b32 v163, 0xffff0000, v23
    v_pk_mul_f32 v[146:147], v[144:145], v[8:9] op_sel:[0,1] op_sel_hi:[1,1]
    v_pk_mul_f32 v[152:153], v[150:151], v[8:9] op_sel:[0,1] op_sel_hi:[1,1]
    v_pk_mul_f32 v[158:159], v[156:157], v[8:9] op_sel:[0,1] op_sel_hi:[1,1]
    v_pk_mul_f32 v[164:165], v[162:163], v[8:9] op_sel:[0,1] op_sel_hi:[1,1]
    v_cvt_pk_bf16_f32 v144, v146, v147
    v_cvt_pk_bf16_f32 v150, v152, v153
    v_cvt_pk_bf16_f32 v156, v158, v159
    v_cvt_pk_bf16_f32 v162, v164, v165
    v_lshlrev_b32 v146, 16, v144
    v_and_b32 v147, 0xffff0000, v144
    v_lshlrev_b32 v152, 16, v150
    v_and_b32 v153, 0xffff0000, v150
    v_lshlrev_b32 v158, 16, v156
    v_and_b32 v159, 0xffff0000, v156
    v_lshlrev_b32 v164, 16, v162
    v_and_b32 v165, 0xffff0000, v162
    v_cvt_pk_f16_f32 v20, v146, v147
    v_cvt_pk_f16_f32 v21, v152, v153
    v_cvt_pk_f16_f32 v22, v158, v159
    v_cvt_pk_f16_f32 v23, v164, v165
    ds_write_b128 v73, v[20:23] offset:128
    v_lshlrev_b32 v144, 16, v24
    v_and_b32 v145, 0xffff0000, v24
    v_lshlrev_b32 v150, 16, v25
    v_and_b32 v151, 0xffff0000, v25
    v_lshlrev_b32 v156, 16, v26
    v_and_b32 v157, 0xffff0000, v26
    v_lshlrev_b32 v162, 16, v27
    v_and_b32 v163, 0xffff0000, v27
    v_pk_mul_f32 v[146:147], v[144:145], v[8:9] op_sel:[0,1] op_sel_hi:[1,1]
    v_pk_mul_f32 v[152:153], v[150:151], v[8:9] op_sel:[0,1] op_sel_hi:[1,1]
    v_pk_mul_f32 v[158:159], v[156:157], v[8:9] op_sel:[0,1] op_sel_hi:[1,1]
    v_pk_mul_f32 v[164:165], v[162:163], v[8:9] op_sel:[0,1] op_sel_hi:[1,1]
    v_cvt_pk_bf16_f32 v144, v146, v147
    v_cvt_pk_bf16_f32 v150, v152, v153
    v_cvt_pk_bf16_f32 v156, v158, v159
    v_cvt_pk_bf16_f32 v162, v164, v165
    v_lshlrev_b32 v146, 16, v144
    v_and_b32 v147, 0xffff0000, v144
    v_lshlrev_b32 v152, 16, v150
    v_and_b32 v153, 0xffff0000, v150
    v_lshlrev_b32 v158, 16, v156
    v_and_b32 v159, 0xffff0000, v156
    v_lshlrev_b32 v164, 16, v162
    v_and_b32 v165, 0xffff0000, v162
    v_cvt_pk_f16_f32 v24, v146, v147
    v_cvt_pk_f16_f32 v25, v152, v153
    v_cvt_pk_f16_f32 v26, v158, v159
    v_cvt_pk_f16_f32 v27, v164, v165
    ds_write_b128 v73, v[24:27] offset:256
    v_lshlrev_b32 v144, 16, v28
    v_and_b32 v145, 0xffff0000, v28
    v_lshlrev_b32 v150, 16, v29
    v_and_b32 v151, 0xffff0000, v29
    v_lshlrev_b32 v156, 16, v30
    v_and_b32 v157, 0xffff0000, v30
    v_lshlrev_b32 v162, 16, v31
    v_and_b32 v163, 0xffff0000, v31
    v_pk_mul_f32 v[146:147], v[144:145], v[8:9] op_sel:[0,1] op_sel_hi:[1,1]
    v_pk_mul_f32 v[152:153], v[150:151], v[8:9] op_sel:[0,1] op_sel_hi:[1,1]
    v_pk_mul_f32 v[158:159], v[156:157], v[8:9] op_sel:[0,1] op_sel_hi:[1,1]
    v_pk_mul_f32 v[164:165], v[162:163], v[8:9] op_sel:[0,1] op_sel_hi:[1,1]
    v_cvt_pk_bf16_f32 v144, v146, v147
    v_cvt_pk_bf16_f32 v150, v152, v153
    v_cvt_pk_bf16_f32 v156, v158, v159
    v_cvt_pk_bf16_f32 v162, v164, v165
    v_lshlrev_b32 v146, 16, v144
    v_and_b32 v147, 0xffff0000, v144
    v_lshlrev_b32 v152, 16, v150
    v_and_b32 v153, 0xffff0000, v150
    v_lshlrev_b32 v158, 16, v156
    v_and_b32 v159, 0xffff0000, v156
    v_lshlrev_b32 v164, 16, v162
    v_and_b32 v165, 0xffff0000, v162
    v_cvt_pk_f16_f32 v28, v146, v147
    v_cvt_pk_f16_f32 v29, v152, v153
    v_cvt_pk_f16_f32 v30, v158, v159
    v_cvt_pk_f16_f32 v31, v164, v165
    ds_write_b128 v73, v[28:31] offset:384
    v_lshlrev_b32 v144, 16, v32
    v_and_b32 v145, 0xffff0000, v32
    v_lshlrev_b32 v150, 16, v33
    v_and_b32 v151, 0xffff0000, v33
    v_lshlrev_b32 v156, 16, v34
    v_and_b32 v157, 0xffff0000, v34
    v_lshlrev_b32 v162, 16, v35
    v_and_b32 v163, 0xffff0000, v35
    v_pk_mul_f32 v[146:147], v[144:145], v[8:9] op_sel:[0,1] op_sel_hi:[1,1]
    v_pk_mul_f32 v[152:153], v[150:151], v[8:9] op_sel:[0,1] op_sel_hi:[1,1]
    v_pk_mul_f32 v[158:159], v[156:157], v[8:9] op_sel:[0,1] op_sel_hi:[1,1]
    v_pk_mul_f32 v[164:165], v[162:163], v[8:9] op_sel:[0,1] op_sel_hi:[1,1]
    v_cvt_pk_bf16_f32 v144, v146, v147
    v_cvt_pk_bf16_f32 v150, v152, v153
    v_cvt_pk_bf16_f32 v156, v158, v159
    v_cvt_pk_bf16_f32 v162, v164, v165
    v_lshlrev_b32 v146, 16, v144
    v_and_b32 v147, 0xffff0000, v144
    v_lshlrev_b32 v152, 16, v150
    v_and_b32 v153, 0xffff0000, v150
    v_lshlrev_b32 v158, 16, v156
    v_and_b32 v159, 0xffff0000, v156
    v_lshlrev_b32 v164, 16, v162
    v_and_b32 v165, 0xffff0000, v162
    v_cvt_pk_f16_f32 v32, v146, v147
    v_cvt_pk_f16_f32 v33, v152, v153
    v_cvt_pk_f16_f32 v34, v158, v159
    v_cvt_pk_f16_f32 v35, v164, v165
    ds_write_b128 v73, v[32:35] offset:512
    v_lshlrev_b32 v144, 16, v36
    v_and_b32 v145, 0xffff0000, v36
    v_lshlrev_b32 v150, 16, v37
    v_and_b32 v151, 0xffff0000, v37
    v_lshlrev_b32 v156, 16, v38
    v_and_b32 v157, 0xffff0000, v38
    v_lshlrev_b32 v162, 16, v39
    v_and_b32 v163, 0xffff0000, v39
    v_pk_mul_f32 v[146:147], v[144:145], v[8:9] op_sel:[0,1] op_sel_hi:[1,1]
    v_pk_mul_f32 v[152:153], v[150:151], v[8:9] op_sel:[0,1] op_sel_hi:[1,1]
    v_pk_mul_f32 v[158:159], v[156:157], v[8:9] op_sel:[0,1] op_sel_hi:[1,1]
    v_pk_mul_f32 v[164:165], v[162:163], v[8:9] op_sel:[0,1] op_sel_hi:[1,1]
    v_cvt_pk_bf16_f32 v144, v146, v147
    v_cvt_pk_bf16_f32 v150, v152, v153
    v_cvt_pk_bf16_f32 v156, v158, v159
    v_cvt_pk_bf16_f32 v162, v164, v165
    v_lshlrev_b32 v146, 16, v144
    v_and_b32 v147, 0xffff0000, v144
    v_lshlrev_b32 v152, 16, v150
    v_and_b32 v153, 0xffff0000, v150
    v_lshlrev_b32 v158, 16, v156
    v_and_b32 v159, 0xffff0000, v156
    v_lshlrev_b32 v164, 16, v162
    v_and_b32 v165, 0xffff0000, v162
    v_cvt_pk_f16_f32 v36, v146, v147
    v_cvt_pk_f16_f32 v37, v152, v153
    v_cvt_pk_f16_f32 v38, v158, v159
    v_cvt_pk_f16_f32 v39, v164, v165
    ds_write_b128 v73, v[36:39] offset:640
    v_lshlrev_b32 v144, 16, v40
    v_and_b32 v145, 0xffff0000, v40
    v_lshlrev_b32 v150, 16, v41
    v_and_b32 v151, 0xffff0000, v41
    v_lshlrev_b32 v156, 16, v42
    v_and_b32 v157, 0xffff0000, v42
    v_lshlrev_b32 v162, 16, v43
    v_and_b32 v163, 0xffff0000, v43
    v_pk_mul_f32 v[146:147], v[144:145], v[8:9] op_sel:[0,1] op_sel_hi:[1,1]
    v_pk_mul_f32 v[152:153], v[150:151], v[8:9] op_sel:[0,1] op_sel_hi:[1,1]
    v_pk_mul_f32 v[158:159], v[156:157], v[8:9] op_sel:[0,1] op_sel_hi:[1,1]
    v_pk_mul_f32 v[164:165], v[162:163], v[8:9] op_sel:[0,1] op_sel_hi:[1,1]
    v_cvt_pk_bf16_f32 v144, v146, v147
    v_cvt_pk_bf16_f32 v150, v152, v153
    v_cvt_pk_bf16_f32 v156, v158, v159
    v_cvt_pk_bf16_f32 v162, v164, v165
    v_lshlrev_b32 v146, 16, v144
    v_and_b32 v147, 0xffff0000, v144
    v_lshlrev_b32 v152, 16, v150
    v_and_b32 v153, 0xffff0000, v150
    v_lshlrev_b32 v158, 16, v156
    v_and_b32 v159, 0xffff0000, v156
    v_lshlrev_b32 v164, 16, v162
    v_and_b32 v165, 0xffff0000, v162
    v_cvt_pk_f16_f32 v40, v146, v147
    v_cvt_pk_f16_f32 v41, v152, v153
    v_cvt_pk_f16_f32 v42, v158, v159
    v_cvt_pk_f16_f32 v43, v164, v165
    ds_write_b128 v73, v[40:43] offset:768
    s_waitcnt vmcnt(0)
    s_mov_b32 s8, s68
    s_mov_b32 s9, s69
    s_mov_b32 s10, 256
    s_mov_b32 s11, 0x00020000
    v_mov_b32 v5, 120064
    v_mov_b32 v6, 1
    s_mov_b64 exec, 1
    ds_add_rtn_u32 v7, v5, v6
    s_lshl_b32 s36, s28, 2
    v_mov_b32 v5, s36
    s_waitcnt lgkmcnt(0)
    v_readfirstlane_b32 s36, v7
    s_cmp_lg_u32 s36, 7
    s_cbranch_scc1 h_s1
    buffer_store_dword v6, v5, s[8:11], 0 offen offset:0 sc1
h_s1:
    s_mov_b64 exec, -1
    v_lshlrev_b32 v144, 16, v44
    v_and_b32 v145, 0xffff0000, v44
    v_lshlrev_b32 v150, 16, v45
    v_and_b32 v151, 0xffff0000, v45
    v_lshlrev_b32 v156, 16, v46
    v_and_b32 v157, 0xffff0000, v46
    v_lshlrev_b32 v162, 16, v47
    v_and_b32 v163, 0xffff0000, v47
    v_pk_mul_f32 v[146:147], v[144:145], v[12:13] op_sel:[0,1] op_sel_hi:[1,1]
    v_pk_mul_f32 v[152:153], v[150:151], v[12:13] op_sel:[0,1] op_sel_hi:[1,1]
    v_pk_mul_f32 v[158:159], v[156:157], v[12:13] op_sel:[0,1] op_sel_hi:[1,1]
    v_pk_mul_f32 v[164:165], v[162:163], v[12:13] op_sel:[0,1] op_sel_hi:[1,1]
    v_cvt_pk_bf16_f32 v144, v146, v147
    v_cvt_pk_bf16_f32 v150, v152, v153
    v_cvt_pk_bf16_f32 v156, v158, v159
    v_cvt_pk_bf16_f32 v162, v164, v165
    v_lshlrev_b32 v146, 16, v144
    v_and_b32 v147, 0xffff0000, v144
    v_lshlrev_b32 v152, 16, v150
    v_and_b32 v153, 0xffff0000, v150
    v_lshlrev_b32 v158, 16, v156
    v_and_b32 v159, 0xffff0000, v156
    v_lshlrev_b32 v164, 16, v162
    v_and_b32 v165, 0xffff0000, v162
    v_cvt_pk_f16_f32 v44, v146, v147
    v_cvt_pk_f16_f32 v45, v152, v153
    v_cvt_pk_f16_f32 v46, v158, v159
    v_cvt_pk_f16_f32 v47, v164, v165
    ds_write_b128 v73, v[44:47] offset:7296
    v_lshlrev_b32 v144, 16, v48
    v_and_b32 v145, 0xffff0000, v48
    v_lshlrev_b32 v150, 16, v49
    v_and_b32 v151, 0xffff0000, v49
    v_lshlrev_b32 v156, 16, v50
    v_and_b32 v157, 0xffff0000, v50
    v_lshlrev_b32 v162, 16, v51
    v_and_b32 v163, 0xffff0000, v51
    v_pk_mul_f32 v[146:147], v[144:145], v[12:13] op_sel:[0,1] op_sel_hi:[1,1]
    v_pk_mul_f32 v[152:153], v[150:151], v[12:13] op_sel:[0,1] op_sel_hi:[1,1]
    v_pk_mul_f32 v[158:159], v[156:157], v[12:13] op_sel:[0,1] op_sel_hi:[1,1]
    v_pk_mul_f32 v[164:165], v[162:163], v[12:13] op_sel:[0,1] op_sel_hi:[1,1]
    v_cvt_pk_bf16_f32 v144, v146, v147
    v_cvt_pk_bf16_f32 v150, v152, v153
    v_cvt_pk_bf16_f32 v156, v158, v159
    v_cvt_pk_bf16_f32 v162, v164, v165
    v_lshlrev_b32 v146, 16, v144
    v_and_b32 v147, 0xffff0000, v144
    v_lshlrev_b32 v152, 16, v150
    v_and_b32 v153, 0xffff0000, v150
    v_lshlrev_b32 v158, 16, v156
    v_and_b32 v159, 0xffff0000, v156
    v_lshlrev_b32 v164, 16, v162
    v_and_b32 v165, 0xffff0000, v162
    v_cvt_pk_f16_f32 v48, v146, v147
    v_cvt_pk_f16_f32 v49, v152, v153
    v_cvt_pk_f16_f32 v50, v158, v159
    v_cvt_pk_f16_f32 v51, v164, v165
    ds_write_b128 v73, v[48:51] offset:7424
    v_lshlrev_b32 v144, 16, v52
    v_and_b32 v145, 0xffff0000, v52
    v_lshlrev_b32 v150, 16, v53
    v_and_b32 v151, 0xffff0000, v53
    v_lshlrev_b32 v156, 16, v54
    v_and_b32 v157, 0xffff0000, v54
    v_lshlrev_b32 v162, 16, v55
    v_and_b32 v163, 0xffff0000, v55
    v_pk_mul_f32 v[146:147], v[144:145], v[12:13] op_sel:[0,1] op_sel_hi:[1,1]
    v_pk_mul_f32 v[152:153], v[150:151], v[12:13] op_sel:[0,1] op_sel_hi:[1,1]
    v_pk_mul_f32 v[158:159], v[156:157], v[12:13] op_sel:[0,1] op_sel_hi:[1,1]
    v_pk_mul_f32 v[164:165], v[162:163], v[12:13] op_sel:[0,1] op_sel_hi:[1,1]
    v_cvt_pk_bf16_f32 v144, v146, v147
    v_cvt_pk_bf16_f32 v150, v152, v153
    v_cvt_pk_bf16_f32 v156, v158, v159
    v_cvt_pk_bf16_f32 v162, v164, v165
    v_lshlrev_b32 v146, 16, v144
    v_and_b32 v147, 0xffff0000, v144
    v_lshlrev_b32 v152, 16, v150
    v_and_b32 v153, 0xffff0000, v150
    v_lshlrev_b32 v158, 16, v156
    v_and_b32 v159, 0xffff0000, v156
    v_lshlrev_b32 v164, 16, v162
    v_and_b32 v165, 0xffff0000, v162
    v_cvt_pk_f16_f32 v52, v146, v147
    v_cvt_pk_f16_f32 v53, v152, v153
    v_cvt_pk_f16_f32 v54, v158, v159
    v_cvt_pk_f16_f32 v55, v164, v165
    ds_write_b128 v73, v[52:55] offset:7552
    v_lshlrev_b32 v144, 16, v56
    v_and_b32 v145, 0xffff0000, v56
    v_lshlrev_b32 v150, 16, v57
    v_and_b32 v151, 0xffff0000, v57
    v_lshlrev_b32 v156, 16, v58
    v_and_b32 v157, 0xffff0000, v58
    v_lshlrev_b32 v162, 16, v59
    v_and_b32 v163, 0xffff0000, v59
    v_pk_mul_f32 v[146:147], v[144:145], v[12:13] op_sel:[0,1] op_sel_hi:[1,1]
    v_pk_mul_f32 v[152:153], v[150:151], v[12:13] op_sel:[0,1] op_sel_hi:[1,1]
    v_pk_mul_f32 v[158:159], v[156:157], v[12:13] op_sel:[0,1] op_sel_hi:[1,1]
    v_pk_mul_f32 v[164:165], v[162:163], v[12:13] op_sel:[0,1] op_sel_hi:[1,1]
    v_cvt_pk_bf16_f32 v144, v146, v147
    v_cvt_pk_bf16_f32 v150, v152, v153
    v_cvt_pk_bf16_f32 v156, v158, v159
    v_cvt_pk_bf16_f32 v162, v164, v165
    v_lshlrev_b32 v146, 16, v144
    v_and_b32 v147, 0xffff0000, v144
    v_lshlrev_b32 v152, 16, v150
    v_and_b32 v153, 0xffff0000, v150
    v_lshlrev_b32 v158, 16, v156
    v_and_b32 v159, 0xffff0000, v156
    v_lshlrev_b32 v164, 16, v162
    v_and_b32 v165, 0xffff0000, v162
    v_cvt_pk_f16_f32 v56, v146, v147
    v_cvt_pk_f16_f32 v57, v152, v153
    v_cvt_pk_f16_f32 v58, v158, v159
    v_cvt_pk_f16_f32 v59, v164, v165
    ds_write_b128 v73, v[56:59] offset:7680
    v_lshlrev_b32 v144, 16, v60
    v_and_b32 v145, 0xffff0000, v60
    v_lshlrev_b32 v150, 16, v61
    v_and_b32 v151, 0xffff0000, v61
    v_lshlrev_b32 v156, 16, v62
    v_and_b32 v157, 0xffff0000, v62
    v_lshlrev_b32 v162, 16, v63
    v_and_b32 v163, 0xffff0000, v63
    v_pk_mul_f32 v[146:147], v[144:145], v[12:13] op_sel:[0,1] op_sel_hi:[1,1]
    v_pk_mul_f32 v[152:153], v[150:151], v[12:13] op_sel:[0,1] op_sel_hi:[1,1]
    v_pk_mul_f32 v[158:159], v[156:157], v[12:13] op_sel:[0,1] op_sel_hi:[1,1]
    v_pk_mul_f32 v[164:165], v[162:163], v[12:13] op_sel:[0,1] op_sel_hi:[1,1]
    v_cvt_pk_bf16_f32 v144, v146, v147
    v_cvt_pk_bf16_f32 v150, v152, v153
    v_cvt_pk_bf16_f32 v156, v158, v159
    v_cvt_pk_bf16_f32 v162, v164, v165
    v_lshlrev_b32 v146, 16, v144
    v_and_b32 v147, 0xffff0000, v144
    v_lshlrev_b32 v152, 16, v150
    v_and_b32 v153, 0xffff0000, v150
    v_lshlrev_b32 v158, 16, v156
    v_and_b32 v159, 0xffff0000, v156
    v_lshlrev_b32 v164, 16, v162
    v_and_b32 v165, 0xffff0000, v162
    v_cvt_pk_f16_f32 v60, v146, v147
    v_cvt_pk_f16_f32 v61, v152, v153
    v_cvt_pk_f16_f32 v62, v158, v159
    v_cvt_pk_f16_f32 v63, v164, v165
    ds_write_b128 v73, v[60:63] offset:7808
    v_lshlrev_b32 v144, 16, v64
    v_and_b32 v145, 0xffff0000, v64
    v_lshlrev_b32 v150, 16, v65
    v_and_b32 v151, 0xffff0000, v65
    v_lshlrev_b32 v156, 16, v66
    v_and_b32 v157, 0xffff0000, v66
    v_lshlrev_b32 v162, 16, v67
    v_and_b32 v163, 0xffff0000, v67
    v_pk_mul_f32 v[146:147], v[144:145], v[12:13] op_sel:[0,1] op_sel_hi:[1,1]
    v_pk_mul_f32 v[152:153], v[150:151], v[12:13] op_sel:[0,1] op_sel_hi:[1,1]
    v_pk_mul_f32 v[158:159], v[156:157], v[12:13] op_sel:[0,1] op_sel_hi:[1,1]
    v_pk_mul_f32 v[164:165], v[162:163], v[12:13] op_sel:[0,1] op_sel_hi:[1,1]
    v_cvt_pk_bf16_f32 v144, v146, v147
    v_cvt_pk_bf16_f32 v150, v152, v153
    v_cvt_pk_bf16_f32 v156, v158, v159
    v_cvt_pk_bf16_f32 v162, v164, v165
    v_lshlrev_b32 v146, 16, v144
    v_and_b32 v147, 0xffff0000, v144
    v_lshlrev_b32 v152, 16, v150
    v_and_b32 v153, 0xffff0000, v150
    v_lshlrev_b32 v158, 16, v156
    v_and_b32 v159, 0xffff0000, v156
    v_lshlrev_b32 v164, 16, v162
    v_and_b32 v165, 0xffff0000, v162
    v_cvt_pk_f16_f32 v64, v146, v147
    v_cvt_pk_f16_f32 v65, v152, v153
    v_cvt_pk_f16_f32 v66, v158, v159
    v_cvt_pk_f16_f32 v67, v164, v165
    ds_write_b128 v73, v[64:67] offset:7936
    v_lshlrev_b32 v144, 16, v68
    v_and_b32 v145, 0xffff0000, v68
    v_lshlrev_b32 v150, 16, v69
    v_and_b32 v151, 0xffff0000, v69
    v_lshlrev_b32 v156, 16, v70
    v_and_b32 v157, 0xffff0000, v70
    v_lshlrev_b32 v162, 16, v71
    v_and_b32 v163, 0xffff0000, v71
    v_pk_mul_f32 v[146:147], v[144:145], v[12:13] op_sel:[0,1] op_sel_hi:[1,1]
    v_pk_mul_f32 v[152:153], v[150:151], v[12:13] op_sel:[0,1] op_sel_hi:[1,1]
    v_pk_mul_f32 v[158:159], v[156:157], v[12:13] op_sel:[0,1] op_sel_hi:[1,1]
    v_pk_mul_f32 v[164:165], v[162:163], v[12:13] op_sel:[0,1] op_sel_hi:[1,1]
    v_cvt_pk_bf16_f32 v144, v146, v147
    v_cvt_pk_bf16_f32 v150, v152, v153
    v_cvt_pk_bf16_f32 v156, v158, v159
    v_cvt_pk_bf16_f32 v162, v164, v165
    v_lshlrev_b32 v146, 16, v144
    v_and_b32 v147, 0xffff0000, v144
    v_lshlrev_b32 v152, 16, v150
    v_and_b32 v153, 0xffff0000, v150
    v_lshlrev_b32 v158, 16, v156
    v_and_b32 v159, 0xffff0000, v156
    v_lshlrev_b32 v164, 16, v162
    v_and_b32 v165, 0xffff0000, v162
    v_cvt_pk_f16_f32 v68, v146, v147
    v_cvt_pk_f16_f32 v69, v152, v153
    v_cvt_pk_f16_f32 v70, v158, v159
    v_cvt_pk_f16_f32 v71, v164, v165
    ds_write_b128 v73, v[68:71] offset:8064
    v_mov_b32 v5, 120072
    v_mov_b32 v6, 1
    s_mov_b64 exec, 1
    ds_add_u32 v5, v6
    s_mov_b64 exec, -1
    s_mov_b32 s37, 0
h_sy:
    ds_read_b32 v6, v5
    s_waitcnt lgkmcnt(0)
    v_readfirstlane_b32 s36, v6
    s_cmp_ge_u32 s36, 4
    s_cbranch_scc1 h_sy_ok
    s_add_u32 s37, s37, 1
    s_cmp_lt_u32 s37, 1600000
    s_cbranch_scc1 h_sy
h_sy_ok:
    ds_read_b64_tr_b16 v[16:17], v200 offset:0
    ds_read_b64_tr_b16 v[18:19], v200 offset:14592
    ds_read_b64_tr_b16 v[20:21], v200 offset:1824
    ds_read_b64_tr_b16 v[22:23], v200 offset:16416
    ds_read_b64_tr_b16 v[24:25], v200 offset:32
    ds_read_b64_tr_b16 v[26:27], v200 offset:14624
    ds_read_b64_tr_b16 v[28:29], v200 offset:1856
    ds_read_b64_tr_b16 v[30:31], v200 offset:16448
    ds_read_b64_tr_b16 v[32:33], v200 offset:64
    ds_read_b64_tr_b16 v[34:35], v200 offset:14656
    ds_read_b64_tr_b16 v[36:37], v200 offset:1888
    ds_read_b64_tr_b16 v[38:39], v200 offset:16480
    ds_read_b64_tr_b16 v[40:41], v200 offset:96
    ds_read_b64_tr_b16 v[42:43], v200 offset:14688
    s_waitcnt lgkmcnt(12)
    ds_write_b128 v75, v[16:19] offset:0
    ds_read_b128 v[144:147], v76 offset:0
    s_waitcnt lgkmcnt(12)
    ds_write_b128 v75, v[20:23] offset:1024
    ds_read_b128 v[148:151], v76 offset:1024
    s_waitcnt lgkmcnt(12)
    ds_write_b128 v75, v[24:27] offset:2048
    ds_read_b128 v[152:155], v76 offset:2048
    s_waitcnt lgkmcnt(12)
    ds_write_b128 v75, v[28:31] offset:3072
    ds_read_b128 v[156:159], v76 offset:3072
    s_waitcnt lgkmcnt(12)
    ds_write_b128 v75, v[32:35] offset:4096
    ds_read_b128 v[160:163], v76 offset:4096
    s_waitcnt lgkmcnt(12)
    ds_write_b128 v75, v[36:39] offset:5120
    ds_read_b128 v[164:167], v76 offset:5120
    s_waitcnt lgkmcnt(12)
    ds_write_b128 v75, v[40:43] offset:6144
    ds_read_b128 v[168:171], v76 offset:6144
    s_waitcnt lgkmcnt(12)
    buffer_store_dwordx4 v[144:147], v77, s[20:23], s52 offen offset:0 sc1
    s_waitcnt lgkmcnt(10)
    buffer_store_dwordx4 v[148:151], v77, s[20:23], s53 offen offset:0 sc1
    s_waitcnt lgkmcnt(8)
    buffer_store_dwordx4 v[152:155], v77, s[20:23], s52 offen offset:1024 sc1
    s_waitcnt lgkmcnt(6)
    buffer_store_dwordx4 v[156:159], v77, s[20:23], s53 offen offset:1024 sc1
    s_waitcnt lgkmcnt(4)
    buffer_store_dwordx4 v[160:163], v77, s[20:23], s52 offen offset:2048 sc1
    s_waitcnt lgkmcnt(2)
    buffer_store_dwordx4 v[164:167], v77, s[20:23], s53 offen offset:2048 sc1
    s_waitcnt lgkmcnt(0)
    buffer_store_dwordx4 v[168:171], v77, s[20:23], s52 offen offset:3072 sc1
    ds_read_b64_tr_b16 v[44:45], v200 offset:1920
    ds_read_b64_tr_b16 v[46:47], v200 offset:16512
    ds_read_b64_tr_b16 v[48:49], v200 offset:128
    ds_read_b64_tr_b16 v[50:51], v200 offset:14720
    ds_read_b64_tr_b16 v[52:53], v200 offset:1952
    ds_read_b64_tr_b16 v[54:55], v200 offset:16544
    ds_read_b64_tr_b16 v[56:57], v200 offset:160
    ds_read_b64_tr_b16 v[58:59], v200 offset:14752
    ds_read_b64_tr_b16 v[60:61], v200 offset:1984
    ds_read_b64_tr_b16 v[62:63], v200 offset:16576
    ds_read_b64_tr_b16 v[64:65], v200 offset:192
    ds_read_b64_tr_b16 v[66:67], v200 offset:14784
    ds_read_b64_tr_b16 v[68:69], v200 offset:2016
    ds_read_b64_tr_b16 v[70:71], v200 offset:16608
    s_waitcnt lgkmcnt(12)
    ds_write_b128 v75, v[44:47] offset:7168
    ds_read_b128 v[172:175], v76 offset:7168
    s_waitcnt lgkmcnt(12)
    ds_write_b128 v75, v[48:51] offset:8192
    ds_read_b128 v[176:179], v76 offset:8192
    s_waitcnt lgkmcnt(12)
    ds_write_b128 v75, v[52:55] offset:9216
    ds_read_b128 v[180:183], v76 offset:9216
    s_waitcnt lgkmcnt(12)
    ds_write_b128 v75, v[56:59] offset:10240
    ds_read_b128 v[184:187], v76 offset:10240
    s_waitcnt lgkmcnt(12)
    ds_write_b128 v75, v[60:63] offset:11264
    ds_read_b128 v[188:191], v76 offset:11264
    s_waitcnt lgkmcnt(12)
    ds_write_b128 v75, v[64:67] offset:12288
    ds_read_b128 v[192:195], v76 offset:12288
    s_waitcnt lgkmcnt(12)
    ds_write_b128 v75, v[68:71] offset:13312
    ds_read_b128 v[196:199], v76 offset:13312
    s_waitcnt lgkmcnt(12)
    buffer_store_dwordx4 v[172:175], v77, s[20:23], s53 offen offset:3072 sc1
    s_waitcnt lgkmcnt(10)
    buffer_store_dwordx4 v[176:179], v77, s[20:23], s54 offen offset:0 sc1
    s_waitcnt lgkmcnt(8)
    buffer_store_dwordx4 v[180:183], v77, s[20:23], s55 offen offset:0 sc1
    s_waitcnt lgkmcnt(6)
    buffer_store_dwordx4 v[184:187], v77, s[20:23], s54 offen offset:1024 sc1
    s_waitcnt lgkmcnt(4)
    buffer_store_dwordx4 v[188:191], v77, s[20:23], s55 offen offset:1024 sc1
    s_waitcnt lgkmcnt(2)
    buffer_store_dwordx4 v[192:195], v77, s[20:23], s54 offen offset:2048 sc1
    s_waitcnt lgkmcnt(0)
    buffer_store_dwordx4 v[196:199], v77, s[20:23], s55 offen offset:2048 sc1
    s_waitcnt vmcnt(0)
    s_mov_b32 s8, s68
    s_mov_b32 s9, s69
    s_mov_b32 s10, 256
    s_mov_b32 s11, 0x00020000
    v_mov_b32 v5, 120068
    v_mov_b32 v6, 1
    s_mov_b64 exec, 1
    ds_add_rtn_u32 v7, v5, v6
    s_lshl_b32 s36, s28, 2
    v_mov_b32 v5, s36
    s_waitcnt lgkmcnt(0)
    v_readfirstlane_b32 s36, v7
    s_cmp_lg_u32 s36, 3
    s_cbranch_scc1 h_end2
    buffer_store_dword v6, v5, s[8:11], 0 offen offset:128 sc1
h_end2:
    s_mov_b64 exec, -1
    s_branch h_fin
h_C:
    s_barrier
    s_and_b32 s36, s28, 3
    s_lshr_b32 s37, s28, 3
    s_lshl_b32 s37, s37, 2
    s_add_u32 s36, s36, s37
    s_cmp_ge_u32 s36, 14
    s_cbranch_scc1 h_Cskip
    s_bfe_u32 s37, s28, 0x10002
    s_mul_i32 s37, s37, 14
    s_add_u32 s36, s36, s37
    v_lshrrev_b32 v3, 2, v1
    v_mul_u32_u24 v3, 3584, v3
    v_and_b32 v5, 3, v1
    v_lshl_add_u32 v3, v5, 4, v3
    s_lshl_b32 s36, s36, 7
    s_bfe_u32 s37, s3, 0x10001
    s_lshl_b32 s37, s37, 6
    s_add_u32 s30, s36, s37
    s_mov_b32 s31, s30
    s_and_b32 s32, s3, 1
    s_cmp_eq_u32 s32, 1
    s_waitcnt lgkmcnt(0)
    s_cselect_b32 s8, s62, s60
    s_cselect_b32 s9, s63, s61
    s_mov_b32 s10, 1605632
    s_mov_b32 s11, 0x00020000
    s_add_u32 s30, s30, 229376
    buffer_load_dwordx4 v[80:83], v3, s[8:11], s30 offen
    s_add_u32 s30, s30, 57344
    buffer_load_dwordx4 v[84:87], v3, s[8:11], s30 offen
    s_add_u32 s30, s30, 57344
    buffer_load_dwordx4 v[88:91], v3, s[8:11], s30 offen
    s_add_u32 s30, s30, 57344
    buffer_load_dwordx4 v[92:95], v3, s[8:11], s30 offen
    s_add_u32 s30, s30, 57344
    buffer_load_dwordx4 v[96:99], v3, s[8:11], s30 offen
    s_add_u32 s30, s30, 57344
    buffer_load_dwordx4 v[100:103], v3, s[8:11], s30 offen
    s_add_u32 s30, s30, 57344
    buffer_load_dwordx4 v[104:107], v3, s[8:11], s30 offen
    s_add_u32 s30, s30, 57344
    buffer_load_dwordx4 v[108:111], v3, s[8:11], s30 offen
    s_add_u32 s30, s30, 57344
    buffer_load_dwordx4 v[112:115], v3, s[8:11], s30 offen
    s_add_u32 s30, s30, 57344
    buffer_load_dwordx4 v[116:119], v3, s[8:11], s30 offen
    s_add_u32 s30, s30, 57344
    buffer_load_dwordx4 v[120:123], v3, s[8:11], s30 offen
    s_add_u32 s30, s30, 57344
    buffer_load_dwordx4 v[124:127], v3, s[8:11], s30 offen
    s_add_u32 s30, s30, 57344
    buffer_load_dwordx4 v[128:131], v3, s[8:11], s30 offen
    s_add_u32 s30, s30, 57344
    buffer_load_dwordx4 v[132:135], v3, s[8:11], s30 offen
    s_add_u32 s30, s30, 57344
    buffer_load_dwordx4 v[136:139], v3, s[8:11], s30 offen
    s_add_u32 s30, s30, 57344
    buffer_load_dwordx4 v[140:143], v3, s[8:11], s30 offen
    s_add_u32 s30, s30, 57344
    buffer_load_dwordx4 v[144:147], v3, s[8:11], s30 offen
    s_add_u32 s30, s30, 57344
    buffer_load_dwordx4 v[148:151], v3, s[8:11], s30 offen
    s_add_u32 s30, s30, 57344
    buffer_load_dwordx4 v[152:155], v3, s[8:11], s30 offen
    s_add_u32 s30, s30, 57344
    buffer_load_dwordx4 v[156:159], v3, s[8:11], s30 offen
    s_add_u32 s30, s30, 57344
    buffer_load_dwordx4 v[160:163], v3, s[8:11], s30 offen
    s_add_u32 s30, s30, 57344
    buffer_load_dwordx4 v[164:167], v3, s[8:11], s30 offen
    s_add_u32 s30, s30, 57344
    buffer_load_dwordx4 v[168:171], v3, s[8:11], s30 offen
    s_add_u32 s30, s30, 57344
    buffer_load_dwordx4 v[172:175], v3, s[8:11], s30 offen
    s_add_u32 s16, s70, 14680064
    s_addc_u32 s17, s71, 0
    s_mov_b32 s18, 79872
    s_mov_b32 s19, 0x00020000
    s_mov_b32 s34, 0x00003f80
    s_mov_b32 s35, 0x3f800000
    v_mov_b32 v8, 0
    v_mov_b32 v9, 0
    v_mov_b32 v10, 0
    v_mov_b32 v11, 0
    v_mov_b32 v12, 0
    v_mov_b32 v13, 0
    v_mov_b32 v14, 0
    v_mov_b32 v15, 0
    s_waitcnt vmcnt(23)
    v_dot2_f32_bf16 v8, v80, s34, v8
    v_dot2_f32_bf16 v9, v80, s35, v9
    v_dot2_f32_bf16 v10, v81, s34, v10
    v_dot2_f32_bf16 v11, v81, s35, v11
    v_dot2_f32_bf16 v12, v82, s34, v12
    v_dot2_f32_bf16 v13, v82, s35, v13
    v_dot2_f32_bf16 v14, v83, s34, v14
    v_dot2_f32_bf16 v15, v83, s35, v15
    s_waitcnt vmcnt(22)
    v_dot2_f32_bf16 v8, v84, s34, v8
    v_dot2_f32_bf16 v9, v84, s35, v9
    v_dot2_f32_bf16 v10, v85, s34, v10
    v_dot2_f32_bf16 v11, v85, s35, v11
    v_dot2_f32_bf16 v12, v86, s34, v12
    v_dot2_f32_bf16 v13, v86, s35, v13
    v_dot2_f32_bf16 v14, v87, s34, v14
    v_dot2_f32_bf16 v15, v87, s35, v15
    s_waitcnt vmcnt(21)
    v_dot2_f32_bf16 v8, v88, s34, v8
    v_dot2_f32_bf16 v9, v88, s35, v9
    v_dot2_f32_bf16 v10, v89, s34, v10
    v_dot2_f32_bf16 v11, v89, s35, v11
    v_dot2_f32_bf16 v12, v90, s34, v12
    v_dot2_f32_bf16 v13, v90, s35, v13
    v_dot2_f32_bf16 v14, v91, s34, v14
    v_dot2_f32_bf16 v15, v91, s35, v15
    s_waitcnt vmcnt(20)
    v_dot2_f32_bf16 v8, v92, s34, v8
    v_dot2_f32_bf16 v9, v92, s35, v9
    v_dot2_f32_bf16 v10, v93, s34, v10
    v_dot2_f32_bf16 v11, v93, s35, v11
    v_dot2_f32_bf16 v12, v94, s34, v12
    v_dot2_f32_bf16 v13, v94, s35, v13
    v_dot2_f32_bf16 v14, v95, s34, v14
    v_dot2_f32_bf16 v15, v95, s35, v15
    s_waitcnt vmcnt(19)
    v_dot2_f32_bf16 v8, v96, s34, v8
    v_dot2_f32_bf16 v9, v96, s35, v9
    v_dot2_f32_bf16 v10, v97, s34, v10
    v_dot2_f32_bf16 v11, v97, s35, v11
    v_dot2_f32_bf16 v12, v98, s34, v12
    v_dot2_f32_bf16 v13, v98, s35, v13
    v_dot2_f32_bf16 v14, v99, s34, v14
    v_dot2_f32_bf16 v15, v99, s35, v15
    s_waitcnt vmcnt(18)
    v_dot2_f32_bf16 v8, v100, s34, v8
    v_dot2_f32_bf16 v9, v100, s35, v9
    v_dot2_f32_bf16 v10, v101, s34, v10
    v_dot2_f32_bf16 v11, v101, s35, v11
    v_dot2_f32_bf16 v12, v102, s34, v12
    v_dot2_f32_bf16 v13, v102, s35, v13
    v_dot2_f32_bf16 v14, v103, s34, v14
    v_dot2_f32_bf16 v15, v103, s35, v15
    s_waitcnt vmcnt(17)
    v_dot2_f32_bf16 v8, v104, s34, v8
    v_dot2_f32_bf16 v9, v104, s35, v9
    v_dot2_f32_bf16 v10, v105, s34, v10
    v_dot2_f32_bf16 v11, v105, s35, v11
    v_dot2_f32_bf16 v12, v106, s34, v12
    v_dot2_f32_bf16 v13, v106, s35, v13
    v_dot2_f32_bf16 v14, v107, s34, v14
    v_dot2_f32_bf16 v15, v107, s35, v15
    s_waitcnt vmcnt(16)
    v_dot2_f32_bf16 v8, v108, s34, v8
    v_dot2_f32_bf16 v9, v108, s35, v9
    v_dot2_f32_bf16 v10, v109, s34, v10
    v_dot2_f32_bf16 v11, v109, s35, v11
    v_dot2_f32_bf16 v12, v110, s34, v12
    v_dot2_f32_bf16 v13, v110, s35, v13
    v_dot2_f32_bf16 v14, v111, s34, v14
    v_dot2_f32_bf16 v15, v111, s35, v15
    s_waitcnt vmcnt(15)
    v_dot2_f32_bf16 v8, v112, s34, v8
    v_dot2_f32_bf16 v9, v112, s35, v9
    v_dot2_f32_bf16 v10, v113, s34, v10
    v_dot2_f32_bf16 v11, v113, s35, v11
    v_dot2_f32_bf16 v12, v114, s34, v12
    v_dot2_f32_bf16 v13, v114, s35, v13
    v_dot2_f32_bf16 v14, v115, s34, v14
    v_dot2_f32_bf16 v15, v115, s35, v15
    s_waitcnt vmcnt(14)
    v_dot2_f32_bf16 v8, v116, s34, v8
    v_dot2_f32_bf16 v9, v116, s35, v9
    v_dot2_f32_bf16 v10, v117, s34, v10
    v_dot2_f32_bf16 v11, v117, s35, v11
    v_dot2_f32_bf16 v12, v118, s34, v12
    v_dot2_f32_bf16 v13, v118, s35, v13
    v_dot2_f32_bf16 v14, v119, s34, v14
    v_dot2_f32_bf16 v15, v119, s35, v15
    s_waitcnt vmcnt(13)
    v_dot2_f32_bf16 v8, v120, s34, v8
    v_dot2_f32_bf16 v9, v120, s35, v9
    v_dot2_f32_bf16 v10, v121, s34, v10
    v_dot2_f32_bf16 v11, v121, s35, v11
    v_dot2_f32_bf16 v12, v122, s34, v12
    v_dot2_f32_bf16 v13, v122, s35, v13
    v_dot2_f32_bf16 v14, v123, s34, v14
    v_dot2_f32_bf16 v15, v123, s35, v15
    s_waitcnt vmcnt(12)
    v_dot2_f32_bf16 v8, v124, s34, v8
    v_dot2_f32_bf16 v9, v124, s35, v9
    v_dot2_f32_bf16 v10, v125, s34, v10
    v_dot2_f32_bf16 v11, v125, s35, v11
    v_dot2_f32_bf16 v12, v126, s34, v12
    v_dot2_f32_bf16 v13, v126, s35, v13
    v_dot2_f32_bf16 v14, v127, s34, v14
    v_dot2_f32_bf16 v15, v127, s35, v15
    s_waitcnt vmcnt(11)
    v_dot2_f32_bf16 v8, v128, s34, v8
    v_dot2_f32_bf16 v9, v128, s35, v9
    v_dot2_f32_bf16 v10, v129, s34, v10
    v_dot2_f32_bf16 v11, v129, s35, v11
    v_dot2_f32_bf16 v12, v130, s34, v12
    v_dot2_f32_bf16 v13, v130, s35, v13
    v_dot2_f32_bf16 v14, v131, s34, v14
    v_dot2_f32_bf16 v15, v131, s35, v15
    s_waitcnt vmcnt(10)
    v_dot2_f32_bf16 v8, v132, s34, v8
    v_dot2_f32_bf16 v9, v132, s35, v9
    v_dot2_f32_bf16 v10, v133, s34, v10
    v_dot2_f32_bf16 v11, v133, s35, v11
    v_dot2_f32_bf16 v12, v134, s34, v12
    v_dot2_f32_bf16 v13, v134, s35, v13
    v_dot2_f32_bf16 v14, v135, s34, v14
    v_dot2_f32_bf16 v15, v135, s35, v15
    s_waitcnt vmcnt(9)
    v_dot2_f32_bf16 v8, v136, s34, v8
    v_dot2_f32_bf16 v9, v136, s35, v9
    v_dot2_f32_bf16 v10, v137, s34, v10
    v_dot2_f32_bf16 v11, v137, s35, v11
    v_dot2_f32_bf16 v12, v138, s34, v12
    v_dot2_f32_bf16 v13, v138, s35, v13
    v_dot2_f32_bf16 v14, v139, s34, v14
    v_dot2_f32_bf16 v15, v139, s35, v15
    s_waitcnt vmcnt(8)
    v_dot2_f32_bf16 v8, v140, s34, v8
    v_dot2_f32_bf16 v9, v140, s35, v9
    v_dot2_f32_bf16 v10, v141, s34, v10
    v_dot2_f32_bf16 v11, v141, s35, v11
    v_dot2_f32_bf16 v12, v142, s34, v12
    v_dot2_f32_bf16 v13, v142, s35, v13
    v_dot2_f32_bf16 v14, v143, s34, v14
    v_dot2_f32_bf16 v15, v143, s35, v15
    s_waitcnt vmcnt(7)
    v_dot2_f32_bf16 v8, v144, s34, v8
    v_dot2_f32_bf16 v9, v144, s35, v9
    v_dot2_f32_bf16 v10, v145, s34, v10
    v_dot2_f32_bf16 v11, v145, s35, v11
    v_dot2_f32_bf16 v12, v146, s34, v12
    v_dot2_f32_bf16 v13, v146, s35, v13
    v_dot2_f32_bf16 v14, v147, s34, v14
    v_dot2_f32_bf16 v15, v147, s35, v15
    s_waitcnt vmcnt(6)
    v_dot2_f32_bf16 v8, v148, s34, v8
    v_dot2_f32_bf16 v9, v148, s35, v9
    v_dot2_f32_bf16 v10, v149, s34, v10
    v_dot2_f32_bf16 v11, v149, s35, v11
    v_dot2_f32_bf16 v12, v150, s34, v12
    v_dot2_f32_bf16 v13, v150, s35, v13
    v_dot2_f32_bf16 v14, v151, s34, v14
    v_dot2_f32_bf16 v15, v151, s35, v15
    s_waitcnt vmcnt(5)
    v_dot2_f32_bf16 v8, v152, s34, v8
    v_dot2_f32_bf16 v9, v152, s35, v9
    v_dot2_f32_bf16 v10, v153, s34, v10
    v_dot2_f32_bf16 v11, v153, s35, v11
    v_dot2_f32_bf16 v12, v154, s34, v12
    v_dot2_f32_bf16 v13, v154, s35, v13
    v_dot2_f32_bf16 v14, v155, s34, v14
    v_dot2_f32_bf16 v15, v155, s35, v15
    s_waitcnt vmcnt(4)
    v_dot2_f32_bf16 v8, v156, s34, v8
    v_dot2_f32_bf16 v9, v156, s35, v9
    v_dot2_f32_bf16 v10, v157, s34, v10
    v_dot2_f32_bf16 v11, v157, s35, v11
    v_dot2_f32_bf16 v12, v158, s34, v12
    v_dot2_f32_bf16 v13, v158, s35, v13
    v_dot2_f32_bf16 v14, v159, s34, v14
    v_dot2_f32_bf16 v15, v159, s35, v15
    s_waitcnt vmcnt(3)
    v_dot2_f32_bf16 v8, v160, s34, v8
    v_dot2_f32_bf16 v9, v160, s35, v9
    v_dot2_f32_bf16 v10, v161, s34, v10
    v_dot2_f32_bf16 v11, v161, s35, v11
    v_dot2_f32_bf16 v12, v162, s34, v12
    v_dot2_f32_bf16 v13, v162, s35, v13
    v_dot2_f32_bf16 v14, v163, s34, v14
    v_dot2_f32_bf16 v15, v163, s35, v15
    s_waitcnt vmcnt(2)
    v_dot2_f32_bf16 v8, v164, s34, v8
    v_dot2_f32_bf16 v9, v164, s35, v9
    v_dot2_f32_bf16 v10, v165, s34, v10
    v_dot2_f32_bf16 v11, v165, s35, v11
    v_dot2_f32_bf16 v12, v166, s34, v12
    v_dot2_f32_bf16 v13, v166, s35, v13
    v_dot2_f32_bf16 v14, v167, s34, v14
    v_dot2_f32_bf16 v15, v167, s35, v15
    s_waitcnt vmcnt(1)
    v_dot2_f32_bf16 v8, v168, s34, v8
    v_dot2_f32_bf16 v9, v168, s35, v9
    v_dot2_f32_bf16 v10, v169, s34, v10
    v_dot2_f32_bf16 v11, v169, s35, v11
    v_dot2_f32_bf16 v12, v170, s34, v12
    v_dot2_f32_bf16 v13, v170, s35, v13
    v_dot2_f32_bf16 v14, v171, s34, v14
    v_dot2_f32_bf16 v15, v171, s35, v15
    s_waitcnt vmcnt(0)
    v_dot2_f32_bf16 v8, v172, s34, v8
    v_dot2_f32_bf16 v9, v172, s35, v9
    v_dot2_f32_bf16 v10, v173, s34, v10
    v_dot2_f32_bf16 v11, v173, s35, v11
    v_dot2_f32_bf16 v12, v174, s34, v12
    v_dot2_f32_bf16 v13, v174, s35, v13
    v_dot2_f32_bf16 v14, v175, s34, v14
    v_dot2_f32_bf16 v15, v175, s35, v15
    s_nop 2
    v_add_f32_dpp v8, v8, v8 row_ror:4 row_mask:0xf bank_mask:0xf
    v_add_f32_dpp v9, v9, v9 row_ror:4 row_mask:0xf bank_mask:0xf
    v_add_f32_dpp v10, v10, v10 row_ror:4 row_mask:0xf bank_mask:0xf
    v_add_f32_dpp v11, v11, v11 row_ror:4 row_mask:0xf bank_mask:0xf
    v_add_f32_dpp v12, v12, v12 row_ror:4 row_mask:0xf bank_mask:0xf
    v_add_f32_dpp v13, v13, v13 row_ror:4 row_mask:0xf bank_mask:0xf
    v_add_f32_dpp v14, v14, v14 row_ror:4 row_mask:0xf bank_mask:0xf
    v_add_f32_dpp v15, v15, v15 row_ror:4 row_mask:0xf bank_mask:0xf
    v_add_f32_dpp v8, v8, v8 row_ror:8 row_mask:0xf bank_mask:0xf
    v_add_f32_dpp v9, v9, v9 row_ror:8 row_mask:0xf bank_mask:0xf
    v_add_f32_dpp v10, v10, v10 row_ror:8 row_mask:0xf bank_mask:0xf
    v_add_f32_dpp v11, v11, v11 row_ror:8 row_mask:0xf bank_mask:0xf
    v_add_f32_dpp v12, v12, v12 row_ror:8 row_mask:0xf bank_mask:0xf
    v_add_f32_dpp v13, v13, v13 row_ror:8 row_mask:0xf bank_mask:0xf
    v_add_f32_dpp v14, v14, v14 row_ror:8 row_mask:0xf bank_mask:0xf
    v_add_f32_dpp v15, v15, v15 row_ror:8 row_mask:0xf bank_mask:0xf
    v_mov_b32 v80, v8
    v_mov_b32 v81, v9
    v_mov_b32 v82, v10
    v_mov_b32 v83, v11
    v_mov_b32 v84, v12
    v_mov_b32 v85, v13
    v_mov_b32 v86, v14
    v_mov_b32 v87, v15
    v_permlane16_swap_b32 v8, v80
    v_permlane16_swap_b32 v9, v81
    v_permlane16_swap_b32 v10, v82
    v_permlane16_swap_b32 v11, v83
    v_permlane16_swap_b32 v12, v84
    v_permlane16_swap_b32 v13, v85
    v_permlane16_swap_b32 v14, v86
    v_permlane16_swap_b32 v15, v87
    v_add_f32 v8, v8, v80
    v_add_f32 v9, v9, v81
    v_add_f32 v10, v10, v82
    v_add_f32 v11, v11, v83
    v_add_f32 v12, v12, v84
    v_add_f32 v13, v13, v85
    v_add_f32 v14, v14, v86
    v_add_f32 v15, v15, v87
    v_mov_b32 v80, v8
    v_mov_b32 v81, v9
    v_mov_b32 v82, v10
    v_mov_b32 v83, v11
    v_mov_b32 v84, v12
    v_mov_b32 v85, v13
    v_mov_b32 v86, v14
    v_mov_b32 v87, v15
    v_permlane32_swap_b32 v8, v80
    v_permlane32_swap_b32 v9, v81
    v_permlane32_swap_b32 v10, v82
    v_permlane32_swap_b32 v11, v83
    v_permlane32_swap_b32 v12, v84
    v_permlane32_swap_b32 v13, v85
    v_permlane32_swap_b32 v14, v86
    v_permlane32_swap_b32 v15, v87
    v_add_f32 v8, v8, v80
    v_add_f32 v9, v9, v81
    v_add_f32 v10, v10, v82
    v_add_f32 v11, v11, v83
    v_add_f32 v12, v12, v84
    v_add_f32 v13, v13, v85
    v_add_f32 v14, v14, v86
    v_add_f32 v15, v15, v87
    s_mul_i32 s37, s32, 7168
    s_lshl_b32 s31, s31, 1
    s_add_u32 s36, s37, s31
    s_add_u32 s36, s36, 65536
    v_lshlrev_b32 v5, 5, v5
    s_mov_b64 exec, 15
    buffer_store_dwordx4 v[8:11], v5, s[16:19], s36 offen sc1
    buffer_store_dwordx4 v[12:15], v5, s[16:19], s36 offen offset:16 sc1
    s_mov_b64 exec, -1
h_Cskip:
    s_waitcnt lgkmcnt(0)
    s_waitcnt vmcnt(0)
    s_mov_b32 s8, s68
    s_mov_b32 s9, s69
    s_mov_b32 s10, 256
    s_mov_b32 s11, 0x00020000
    v_mov_b32 v5, 120064
    v_mov_b32 v6, 1
    s_mov_b64 exec, 1
    ds_add_rtn_u32 v7, v5, v6
    s_lshl_b32 s36, s28, 2
    v_mov_b32 v5, s36
    s_waitcnt lgkmcnt(0)
    v_readfirstlane_b32 s36, v7
    s_cmp_lg_u32 s36, 7
    s_cbranch_scc1 h_c1
    buffer_store_dword v6, v5, s[8:11], 0 offen offset:0 sc1
h_c1:
    s_mov_b64 exec, -1
h_fin:
    s_endpgm
k_exit:
    s_endpgm
.p2align 4
ktab:
    .short 0, 2048, 256, 2304, 512, 2560, 768, 2816, 16, 2064, 272, 2320, 528, 2576, 784, 2832
    .short 32, 2080, 288, 2336, 544, 2592, 800, 2848, 48, 2096, 304, 2352, 560, 2608, 816, 2864
    .short 64, 2112, 320, 2368, 576, 2624, 832, 2880, 80, 2128, 336, 2384, 592, 2640, 848, 2896
    .short 96, 2144, 352, 2400, 608, 2656, 864, 2912, 112, 2160, 368, 2416, 624, 2672, 880, 2928
    .short 128, 2176, 384, 2432, 640, 2688, 896, 2944, 144, 2192, 400, 2448, 656, 2704, 912, 2960
    .short 160, 2208, 416, 2464, 672, 2720, 928, 2976, 176, 2224, 432, 2480, 688, 2736, 944, 2992
    .short 192, 2240, 448, 2496, 704, 2752, 960, 3008, 208, 2256, 464, 2512, 720, 2768, 976, 3024
    .short 224, 2272, 480, 2528, 736, 2784, 992, 3040, 240, 2288, 496, 2544, 752, 2800, 1008, 3056
    .short 4, 2052, 260, 2308, 516, 2564, 772, 2820, 20, 2068, 276, 2324, 532, 2580, 788, 2836
    .short 36, 2084, 292, 2340, 548, 2596, 804, 2852, 52, 2100, 308, 2356, 564, 2612, 820, 2868
    .short 68, 2116, 324, 2372, 580, 2628, 836, 2884, 84, 2132, 340, 2388, 596, 2644, 852, 2900
    .short 100, 2148, 356, 2404, 612, 2660, 868, 2916, 116, 2164, 372, 2420, 628, 2676, 884, 2932
    .short 132, 2180, 388, 2436, 644, 2692, 900, 2948, 148, 2196, 404, 2452, 660, 2708, 916, 2964
    .short 164, 2212, 420, 2468, 676, 2724, 932, 2980, 180, 2228, 436, 2484, 692, 2740, 948, 2996
    .short 196, 2244, 452, 2500, 708, 2756, 964, 3012, 212, 2260, 468, 2516, 724, 2772, 980, 3028
    .short 228, 2276, 484, 2532, 740, 2788, 996, 3044, 244, 2292, 500, 2548, 756, 2804, 1012, 3060
    .short 8, 8, 264, 520, 520, 520, 776, 24, 24, 24, 280, 536, 536, 536, 792, 40
    .short 40, 40, 296, 552, 552, 552, 808, 56, 56, 56, 312, 568, 568, 568, 824, 72
    .short 72, 72, 328, 584, 584, 584, 840, 88, 88, 88, 344, 600, 600, 600, 856, 104
    .short 104, 104, 360, 616, 616, 616, 872, 120, 120, 120, 376, 632, 632, 632, 888, 136
    .short 136, 136, 392, 648, 648, 648, 904, 152, 152, 152, 408, 664, 664, 664, 920, 168
    .short 168, 168, 424, 680, 680, 680, 936, 184, 184, 184, 440, 696, 696, 696, 952, 200
    .short 200, 200, 456, 712, 712, 712, 968, 216, 216, 216, 472, 728, 728, 728, 984, 232
    .short 232, 232, 488, 744, 744, 744, 1000, 248, 248, 248, 504, 760, 760, 760, 1016, 12
    .short 12, 12, 268, 524, 524, 524, 780, 28, 28, 28, 284, 540, 540, 540, 796, 44
    .short 44, 44, 300, 556, 556, 556, 812, 60, 60, 60, 316, 572, 572, 572, 828, 76
    .short 76, 76, 332, 588, 588, 588, 844, 92, 92, 92, 348, 604, 604, 604, 860, 108
    .short 108, 108, 364, 620, 620, 620, 876, 124, 124, 124, 380, 636, 636, 636, 892, 140
    .short 140, 140, 396, 652, 652, 652, 908, 156, 156, 156, 412, 668, 668, 668, 924, 172
    .short 172, 172, 428, 684, 684, 684, 940, 188, 188, 188, 444, 700, 700, 700, 956, 204
    .short 204, 204, 460, 716, 716, 716, 972, 220, 220, 220, 476, 732, 732, 732, 988, 236
    .short 236, 236, 492, 748, 748, 748, 1004, 252, 252, 252, 508, 764, 764, 764, 1020, 1024
    .short 1024, 1024, 1024, 1280, 1280, 1280, 1040, 1040, 1040, 1040, 1040, 1296, 1296, 1296, 1056, 1056
    .short 1056, 1056, 1056, 1312, 1312, 1312, 1072, 1072, 1072, 1072, 1072, 1328, 1328, 1328, 1088, 1088
    .short 1088, 1088, 1088, 1344, 1344, 1344, 1104, 1104, 1104, 1104, 1104, 1360, 1360, 1360, 1120, 1120
    .short 1120, 1120, 1120, 1376, 1376, 1376, 1136, 1136, 1136, 1136, 1136, 1392, 1392, 1392, 1152, 1152
    .short 1152, 1152, 1152, 1408, 1408, 1408, 1168, 1168, 1168, 1168, 1168, 1424, 1424, 1424, 1184, 1184
    .short 1184, 1184, 1184, 1440, 1440, 1440, 1200, 1200, 1200, 1200, 1200, 1456, 1456, 1456, 1216, 1216
    .short 1216, 1216, 1216, 1472, 1472, 1472, 1232, 1232, 1232, 1232, 1232, 1488, 1488, 1488, 1248, 1248
    .short 1248, 1248, 1248, 1504, 1504, 1504, 1264, 1264, 1264, 1264, 1264, 1520, 1520, 1520, 1028, 1028
    .short 1028, 1028, 1028, 1284, 1284, 1284, 1044, 1044, 1044, 1044, 1044, 1300, 1300, 1300, 1060, 1060
    .short 1060, 1060, 1060, 1316, 1316, 1316, 1076, 1076, 1076, 1076, 1076, 1332, 1332, 1332, 1092, 1092
    .short 1092, 1092, 1092, 1348, 1348, 1348, 1108, 1108, 1108, 1108, 1108, 1364, 1364, 1364, 1124, 1124
    .short 1124, 1124, 1124, 1380, 1380, 1380, 1140, 1140, 1140, 1140, 1140, 1396, 1396, 1396, 1156, 1156
    .short 1156, 1156, 1156, 1412, 1412, 1412, 1172, 1172, 1172, 1172, 1172, 1428, 1428, 1428, 1188, 1188
    .short 1188, 1188, 1188, 1444, 1444, 1444, 1204, 1204, 1204, 1204, 1204, 1460, 1460, 1460, 1220, 1220
    .short 1220, 1220, 1220, 1476, 1476, 1476, 1236, 1236, 1236, 1236, 1236, 1492, 1492, 1492, 1252, 1252
    .short 1252, 1252, 1252, 1508, 1508, 1508, 1268, 1268, 1268, 1268, 1268, 1524, 1524, 1524, 1032, 1032
    .short 1032, 1032, 1032, 1288, 1288, 1288, 1048, 1048, 1048, 1048, 1048, 1304, 1304, 1304, 1064, 1064
    .short 1064, 1064, 1064, 1320, 1320, 1320, 1080, 1080, 1080, 1080, 1080, 1336, 1336, 1336, 1096, 1096
    .short 1096, 1096, 1096, 1352, 1352, 1352, 1112, 1112, 1112, 1112, 1112, 1368, 1368, 1368, 1128, 1128
    .short 1128, 1128, 1128, 1384, 1384, 1384, 1144, 1144, 1144, 1144, 1144, 1400, 1400, 1400, 1160, 1160
    .short 1160, 1160, 1160, 1416, 1416, 1416, 1176, 1176, 1176, 1176, 1176, 1432, 1432, 1432, 1192, 1192
    .short 1192, 1192, 1192, 1448, 1448, 1448, 1208, 1208, 1208, 1208, 1208, 1464, 1464, 1464, 1224, 1224
    .short 1224, 1224, 1224, 1480, 1480, 1480, 1240, 1240, 1240, 1240, 1240, 1496, 1496, 1496, 1256, 1256
    .short 1256, 1256, 1256, 1512, 1512, 1512, 1272, 1272, 1272, 1272, 1272, 1528, 1528, 1528, 1036, 1036
    .short 1036, 1036, 1036, 1292, 1292, 1292, 1052, 1052, 1052, 1052, 1052, 1308, 1308, 1308, 1068, 1068
    .short 1068, 1068, 1068, 1324, 1324, 1324, 1084, 1084, 1084, 1084, 1084, 1340, 1340, 1340, 1100, 1100
    .short 1100, 1100, 1100, 1356, 1356, 1356, 1116, 1116, 1116, 1116, 1116, 1372, 1372, 1372, 1132, 1132
    .short 1132, 1132, 1132, 1388, 1388, 1388, 1148, 1148, 1148, 1148, 1148, 1404, 1404, 1404, 1164, 1164
    .short 1164, 1164, 1164, 1420, 1420, 1420, 1180, 1180, 1180, 1180, 1180, 1436, 1436, 1436, 1196, 1196
    .short 1196, 1196, 1196, 1452, 1452, 1452, 1212, 1212, 1212, 1212, 1212, 1468, 1468, 1468, 1228, 1228
    .short 1228, 1228, 1228, 1484, 1484, 1484, 1244, 1244, 1244, 1244, 1244, 1500, 1500, 1500, 1260, 1260
    .short 1260, 1260, 1260, 1516, 1516, 1516, 1276, 1276, 1276, 1276, 1276, 1532, 1532, 1532, 1536, 1536
    .short 1536, 1536, 1536, 1536, 1536, 1552, 1552, 1552, 1552, 1552, 1552, 1552, 1568, 1568, 1568, 1568
    .short 1568, 1568, 1568, 1568, 1568, 1584, 1584, 1584, 1584, 1584, 1584, 1584, 1600, 1600, 1600, 1600
    .short 1600, 1600, 1600, 1600, 1600, 1616, 1616, 1616, 1616, 1616, 1616, 1616, 1632, 1632, 1632, 1632
    .short 1632, 1632, 1632, 1632, 1632, 1648, 1648, 1648, 1648, 1648, 1648, 1648, 1664, 1664, 1664, 1664
    .short 1664, 1664, 1664, 1664, 1664, 1680, 1680, 1680, 1680, 1680, 1680, 1680, 1696, 1696, 1696, 1696
    .short 1696, 1696, 1696, 1696, 1696, 1712, 1712, 1712, 1712, 1712, 1712, 1712, 1728, 1728, 1728, 1728
    .short 1728, 1728, 1728, 1728, 1728, 1744, 1744, 1744, 1744, 1744, 1744, 1744, 1760, 1760, 1760, 1760
    .short 1760, 1760, 1760, 1760, 1760, 1776, 1776, 1776, 1776, 1776, 1776, 1776, 1540, 1540, 1540, 1540
    .short 1540, 1540, 1540, 1540, 1540, 1556, 1556, 1556, 1556, 1556, 1556, 1556, 1572, 1572, 1572, 1572
    .short 1572, 1572, 1572, 1572, 1572, 1588, 1588, 1588, 1588, 1588, 1588, 1588, 1604, 1604, 1604, 1604
    .short 1604, 1604, 1604, 1604, 1604, 1620, 1620, 1620, 1620, 1620, 1620, 1620, 1636, 1636, 1636, 1636
    .short 1636, 1636, 1636, 1636, 1636, 1652, 1652, 1652, 1652, 1652, 1652, 1652, 1668, 1668, 1668, 1668
    .short 1668, 1668, 1668, 1668, 1668, 1684, 1684, 1684, 1684, 1684, 1684, 1684, 1700, 1700, 1700, 1700
    .short 1700, 1700, 1700, 1700, 1700, 1716, 1716, 1716, 1716, 1716, 1716, 1716, 1732, 1732, 1732, 1732
    .short 1732, 1732, 1732, 1732, 1732, 1748, 1748, 1748, 1748, 1748, 1748, 1748, 1764, 1764, 1764, 1764
    .short 1764, 1764, 1764, 1764, 1764, 1780, 1780, 1780, 1780, 1780, 1780, 1780, 1544, 1544, 1544, 1544
    .short 1544, 1544, 1544, 1544, 1544, 1560, 1560, 1560, 1560, 1560, 1560, 1560, 1576, 1576, 1576, 1576
    .short 1576, 1576, 1576, 1576, 1576, 1592, 1592, 1592, 1592, 1592, 1592, 1592, 1608, 1608, 1608, 1608
    .short 1608, 1608, 1608, 1608, 1608, 1624, 1624, 1624, 1624, 1624, 1624, 1624, 1640, 1640, 1640, 1640
    .short 1640, 1640, 1640, 1640, 1640, 1656, 1656, 1656, 1656, 1656, 1656, 1656, 1672, 1672, 1672, 1672
    .short 1672, 1672, 1672, 1672, 1672, 1688, 1688, 1688, 1688, 1688, 1688, 1688, 1704, 1704, 1704, 1704
    .short 1704, 1704, 1704, 1704, 1704, 1720, 1720, 1720, 1720, 1720, 1720, 1720, 1736, 1736, 1736, 1736
    .short 1736, 1736, 1736, 1736, 1736, 1752, 1752, 1752, 1752, 1752, 1752, 1752, 1768, 1768, 1768, 1768
    .short 1768, 1768, 1768, 1768, 1768, 1784, 1784, 1784, 1784, 1784, 1784, 1784, 1548, 1548, 1548, 1548
    .short 1548, 1548, 1548, 1548, 1548, 1564, 1564, 1564, 1564, 1564, 1564, 1564, 1580, 1580, 1580, 1580
    .short 1580, 1580, 1580, 1580, 1580, 1596, 1596, 1596, 1596, 1596, 1596, 1596, 1612, 1612, 1612, 1612
    .short 1612, 1612, 1612, 1612, 1612, 1628, 1628, 1628, 1628, 1628, 1628, 1628, 1644, 1644, 1644, 1644
    .short 1644, 1644, 1644, 1644, 1644, 1660, 1660, 1660, 1660, 1660, 1660, 1660, 1676, 1676, 1676, 1676
    .short 1676, 1676, 1676, 1676, 1676, 1692, 1692, 1692, 1692, 1692, 1692, 1692, 1708, 1708, 1708, 1708
    .short 1708, 1708, 1708, 1708, 1708, 1724, 1724, 1724, 1724, 1724, 1724, 1724, 1740, 1740, 1740, 1740
    .short 1740, 1740, 1740, 1740, 1740, 1756, 1756, 1756, 1756, 1756, 1756, 1756, 1772, 1772, 1772, 1772
    .short 1772, 1772, 1772, 1772, 1772, 1788, 1788, 1788, 1788, 1788, 1788, 1788, 1792, 1792, 1792, 1792
    .short 1792, 1792, 1792, 1792, 1792, 1808, 1808, 1808, 1808, 1808, 1808, 1808, 1824, 1824, 1824, 1824
    .short 1824, 1824, 1824, 1824, 1824, 1840, 1840, 1840, 1840, 1840, 1840, 1840, 1856, 1856, 1856, 1856
    .short 1856, 1856, 1856, 1856, 1856, 1872, 1872, 1872, 1872, 1872, 1872, 1872, 1888, 1888, 1888, 1888
    .short 1888, 1888, 1888, 1888, 1888, 1904, 1904, 1904, 1904, 1904, 1904, 1904, 1920, 1920, 1920, 1920
    .short 1920, 1920, 1920, 1920, 1920, 1936, 1936, 1936, 1936, 1936, 1936, 1936, 1952, 1952, 1952, 1952
    .short 1952, 1952, 1952, 1952, 1952, 1968, 1968, 1968, 1968, 1968, 1968, 1968, 1984, 1984, 1984, 1984
    .short 1984, 1984, 1984, 1984, 1984, 2000, 2000, 2000, 2000, 2000, 2000, 2000, 2016, 2016, 2016, 2016
    .short 2016, 2016, 2016, 2016, 2016, 2032, 2032, 2032, 2032, 2032, 2032, 2032, 1796, 1796, 1796, 1796
    .short 1796, 1796, 1796, 1796, 1796, 1812, 1812, 1812, 1812, 1812, 1812, 1812, 1828, 1828, 1828, 1828
    .short 1828, 1828, 1828, 1828, 1828, 1844, 1844, 1844, 1844, 1844, 1844, 1844, 1860, 1860, 1860, 1860
    .short 1860, 1860, 1860, 1860, 1860, 1876, 1876, 1876, 1876, 1876, 1876, 1876, 1892, 1892, 1892, 1892
    .short 1892, 1892, 1892, 1892, 1892, 1908, 1908, 1908, 1908, 1908, 1908, 1908, 1924, 1924, 1924, 1924
    .short 1924, 1924, 1924, 1924, 1924, 1940, 1940, 1940, 1940, 1940, 1940, 1940, 1956, 1956, 1956, 1956
    .short 1956, 1956, 1956, 1956, 1956, 1972, 1972, 1972, 1972, 1972, 1972, 1972, 1988, 1988, 1988, 1988
    .short 1988, 1988, 1988, 1988, 1988, 2004, 2004, 2004, 2004, 2004, 2004, 2004, 2020, 2020, 2020, 2020
    .short 2020, 2020, 2020, 2020, 2020, 2036, 2036, 2036, 2036, 2036, 2036, 2036, 1800, 1800, 1800, 1800
    .short 1800, 1800, 1800, 1800, 1800, 1816, 1816, 1816, 1816, 1816, 1816, 1816, 1832, 1832, 1832, 1832
    .short 1832, 1832, 1832, 1832, 1832, 1848, 1848, 1848, 1848, 1848, 1848, 1848, 1864, 1864, 1864, 1864
    .short 1864, 1864, 1864, 1864, 1864, 1880, 1880, 1880, 1880, 1880, 1880, 1880, 1896, 1896, 1896, 1896
    .short 1896, 1896, 1896, 1896, 1896, 1912, 1912, 1912, 1912, 1912, 1912, 1912, 1928, 1928, 1928, 1928
    .short 1928, 1928, 1928, 1928, 1928, 1944, 1944, 1944, 1944, 1944, 1944, 1944, 1960, 1960, 1960, 1960
    .short 1960, 1960, 1960, 1960, 1960, 1976, 1976, 1976, 1976, 1976, 1976, 1976, 1992, 1992, 1992, 1992
    .short 1992, 1992, 1992, 1992, 1992, 2008, 2008, 2008, 2008, 2008, 2008, 2008, 2024, 2024, 2024, 2024
    .short 2024, 2024, 2024, 2024, 2024, 2040, 2040, 2040, 2040, 2040, 2040, 2040, 1804, 1804, 1804, 1804
    .short 1804, 1804, 1804, 1804, 1804, 1820, 1820, 1820, 1820, 1820, 1820, 1820, 1836, 1836, 1836, 1836
    .short 1836, 1836, 1836, 1836, 1836, 1852, 1852, 1852, 1852, 1852, 1852, 1852, 1868, 1868, 1868, 1868
    .short 1868, 1868, 1868, 1868, 1868, 1884, 1884, 1884, 1884, 1884, 1884, 1884, 1900, 1900, 1900, 1900
    .short 1900, 1900, 1900, 1900, 1900, 1916, 1916, 1916, 1916, 1916, 1916, 1916, 1932, 1932, 1932, 1932
    .short 1932, 1932, 1932, 1932, 1932, 1948, 1948, 1948, 1948, 1948, 1948, 1948, 1964, 1964, 1964, 1964
    .short 1964, 1964, 1964, 1964, 1964, 1980, 1980, 1980, 1980, 1980, 1980, 1980, 1996, 1996, 1996, 1996
    .short 1996, 1996, 1996, 1996, 1996, 2012, 2012, 2012, 2012, 2012, 2012, 2012, 2028, 2028, 2028, 2028
    .short 2028, 2028, 2028, 2028, 2028, 2044, 2044, 2044, 2044, 2044, 2044, 2044, 2056, 2056, 2056, 2056
kend:
.section .rodata,"a"
.p2align 6
.amdhsa_kernel parallel_sum__ssm_conv_s4__glu_gated_geglu__prompt_kernel
  .amdhsa_next_free_vgpr 256
  .amdhsa_next_free_sgpr 102
  .amdhsa_accum_offset 256
  .amdhsa_group_segment_fixed_size 0
  .amdhsa_kernarg_size 128
  .amdhsa_user_sgpr_count 2
  .amdhsa_user_sgpr_kernarg_segment_ptr 1
  .amdhsa_system_sgpr_workgroup_id_x 1
.end_amdhsa_kernel
```
